```python
import torch

def _softmax(x, axis=-1):
    return torch.softmax(x, dim=axis)
def _gelu(x):
    return torch.nn.functional.gelu(x, approximate="tanh")
def _silu(x):
    return torch.nn.functional.silu(x)
def _sigmoid(x):
    return torch.sigmoid(x)
def _layernorm(x, axis=-1, eps=1e-5):
    m = x.mean(dim=axis, keepdim=True)
    v = x.var(dim=axis, keepdim=True, unbiased=False)
    return (x - m) / torch.sqrt(v + eps)
def _scatter_add(tgt, idx, src, axis=0):
    return tgt.clone().index_add_(axis, idx, src)
def _segment_sum(src, seg, n):
    out = torch.zeros((n,) + src.shape[1:], dtype=src.dtype)
    return out.index_add_(0, seg, src)
def _pad(x, pw):
    flat = tuple(v for pair in reversed(pw) for v in pair)
    return torch.nn.functional.pad(x, flat)

kernel_name = 'parallel_sum__linear_kernel_hedgehog__glu_gated_bilinear__prompt'

def setup_inputs():

    _w = (lambda a: (lambda t: t.to(torch.bfloat16) if t.is_floating_point() else t)(torch.as_tensor(a)))
    def _A_setup():
        B, S, D, H = 1, 2048, 512, 32
        Dh = D // H
        return {
            "x": _w((lambda *s: torch.randn(*s, dtype=torch.bfloat16) * 0.05)(B, S, D)),
            "wqkv": _w((lambda *s: torch.randn(*s, dtype=torch.bfloat16) * 0.2)(D, 3 * D)),
            "w_phi": _w((lambda *s: torch.randn(*s, dtype=torch.bfloat16) * 0.2)(H, Dh, Dh) * (Dh ** -0.5)),
            "wo": _w((lambda *s: torch.randn(*s, dtype=torch.bfloat16) * 0.05)(D, D)),
        }
    _A_in = _A_setup()

    def _B_setup():
        B, S, D, F = 1, 2048, 512, 1792
        return {
            "x": _w((lambda *s: torch.randn(*s, dtype=torch.bfloat16) * 0.05)(B, S, D)),
            "w_gate": _w((lambda *s: torch.randn(*s, dtype=torch.bfloat16) * 0.4)(D, F) * (D ** -0.5)),
            "w_up": _w((lambda *s: torch.randn(*s, dtype=torch.bfloat16) * 0.4)(D, F) * (D ** -0.5)),
            "w_down": _w((lambda *s: torch.randn(*s, dtype=torch.bfloat16) * 0.4)(F, D) * (F ** -0.5)),
        }
    _B_in = _B_setup()

    return {
        "A_x": _A_in["x"],
        "A_wqkv": _A_in["wqkv"],
        "A_w_phi": _A_in["w_phi"],
        "A_wo": _A_in["wo"],
        "B_x": _B_in["x"],
        "B_w_gate": _B_in["w_gate"],
        "B_w_up": _B_in["w_up"],
        "B_w_down": _B_in["w_down"],
    }

def reference(A_x, A_wqkv, A_w_phi, A_wo, B_x, B_w_gate, B_w_up, B_w_down):
    def _A_ref(x, wqkv, w_phi, wo):
        B, S, D = x.shape
        H = 32; Dh = D // H
        qkv = (lambda x, *d: x.permute(*d))((x @ wqkv).reshape(B, S, 3, H, Dh), 2, 0, 3, 1, 4)
        q, k, v = qkv[0], qkv[1], qkv[2]
        pq = torch.einsum("bhsd,hdf->bhsf", q, w_phi)
        pk = torch.einsum("bhsd,hdf->bhsf", k, w_phi)
        phi_q = torch.concatenate([_softmax(pq, axis=-1), _softmax(-pq, axis=-1)], axis=-1)
        phi_k = torch.concatenate([_softmax(pk, axis=-1), _softmax(-pk, axis=-1)], axis=-1)
        kv = torch.einsum("bhsf,bhsd->bhfd", phi_k, v)
        z  = torch.einsum("bhsf->bhf", phi_k)
        num = torch.einsum("bhqf,bhfd->bhqd", phi_q, kv)
        den = torch.einsum("bhqf,bhf->bhq", phi_q, z)[..., None] + 1e-6
        o = num / den
        return (lambda x, *d: x.permute(*d))(o, 0, 2, 1, 3).reshape(B, S, D) @ wo

    def _B_ref(x, w_gate, w_up, w_down):
        g = torch.einsum("bsd,df->bsf", x, w_gate)
        u = torch.einsum("bsd,df->bsf", x, w_up)
        h = g * u
        return torch.einsum("bsf,fd->bsd", h, w_down)

    x = A_x
    xn = _layernorm(x, axis=-1)
    return x + _A_ref(xn, A_wqkv, A_w_phi, A_wo) + _B_ref(xn, B_w_gate, B_w_up, B_w_down)
```

```asm
; @launch grid=(256,1,1) block=(256,1,1) lds=163840
.amdgcn_target "amdgcn-amd-amdhsa--gfx950"
.text
.globl parallel_sum__linear_kernel_hedgehog__glu_gated_bilinear__prompt_kernel
.p2align 8
.type parallel_sum__linear_kernel_hedgehog__glu_gated_bilinear__prompt_kernel,@function
parallel_sum__linear_kernel_hedgehog__glu_gated_bilinear__prompt_kernel:
    s_load_dwordx2 s[4:5], s[0:1], 0
    s_load_dwordx2 s[24:25], s[0:1], 80
    s_cmp_ge_u32 s2, 256
    s_cbranch_scc1 L_exit
    v_lshrrev_b32 v6, 6, v0
    v_and_b32 v0, 63, v0
    v_readfirstlane_b32 s60, v6
    s_and_b32 s75, s2, 7
    s_lshr_b32 s76, s2, 3
    s_lshr_b32 s61, s75, 2
    s_lshl_b32 s61, s61, 3
    s_lshr_b32 s77, s76, 2
    s_add_u32 s61, s61, s77
    s_and_b32 s62, s75, 3
    s_lshl_b32 s62, s62, 2
    s_and_b32 s77, s76, 3
    s_add_u32 s62, s62, s77
    s_lshl_b32 s77, s61, 4
    s_add_u32 s77, s77, s62
    s_lshl_b32 s77, s77, 13
    s_lshl_b32 s78, s60, 8
    s_add_u32 s77, s77, s78
    v_and_b32 v7, 7, v0
    v_lshrrev_b32 v8, 3, v0
    v_lshlrev_b32 v9, 10, v7
    v_lshl_add_u32 v9, v8, 4, v9
    s_mov_b32 s30, 0x200000
    s_mov_b32 s31, 0x20000
    s_mov_b32 s42, 14680064
    s_mov_b32 s43, 0x20000
    s_waitcnt lgkmcnt(0)
    s_mov_b32 s28, s4
    s_and_b32 s29, s5, 0xffff
    buffer_load_dwordx4 v[60:63], v9, s[28:31], s77 offen
    buffer_load_dwordx4 v[64:67], v9, s[28:31], s77 offen offset:128
    s_load_dwordx8 s[8:15], s[0:1], 8
    s_load_dwordx8 s[16:23], s[0:1], 40
    s_mov_b32 s40, s24
    s_and_b32 s41, s25, 0xffff
    buffer_load_dword v220, off, s[40:43], 0 sc1
    s_getpc_b64 s[56:57]
L_pc:
    s_and_b32 s57, s57, 0xffff
    s_mov_b32 s58, L_exit-L_pc
    s_mov_b32 s59, 0x20000
    s_lshl_b32 s3, s76, 11
    v_and_b32 v2, 15, v0
    v_lshlrev_b32 v2, 7, v2
    buffer_load_dword v250, v2, s[56:59], s3 offen
    v_lshlrev_b32 v1, 4, v0
    s_lshr_b32 s63, s62, 1
    s_lshr_b32 s66, s75, 1
    s_lshl_b32 s66, s66, 3
    s_lshr_b32 s79, s76, 2
    s_add_u32 s66, s66, s79
    s_mul_i32 s79, s79, 1
    s_add_u32 s67, s76, s79
    s_and_b32 s67, s67, 3
    s_and_b32 s79, s75, 1
    s_lshl_b32 s79, s79, 2
    s_add_u32 s67, s67, s79
    s_lshr_b32 s64, s60, 1
    s_and_b32 s65, s60, 1
    s_lshl_b32 s87, s60, 12
    s_lshl_b32 s88, s60, 11
    s_lshl_b32 s93, s60, 13
    s_add_u32 s93, s93, 122880
    s_mov_b32 s97, 0x8000
    s_mul_i32 s81, s61, 1
    s_and_b32 s81, s81, 7
    s_min_u32 s81, s81, 7
    v_and_b32 v10, 2, v8
    v_lshrrev_b32 v11, 1, v7
    v_xor_b32 v10, v10, v11
    v_and_b32 v11, 1, v0
    v_lshlrev_b32 v11, 4, v11
    v_lshl_add_u32 v221, v10, 5, v11
    s_mul_i32 s78, s65, 114688
    s_lshl_b32 s79, s64, 5
    v_xor_b32 v10, s79, v221
    v_mul_u32_u24 v11, 3584, v8
    v_add3_u32 v2, v10, v11, s78
    v_add_u32 v3, 27648, v2
    v_add_u32 v4, 55296, v2
    v_add_u32 v5, 82944, v2
    s_lshl_b32 s78, s67, 7
    v_lshlrev_b32 v11, 10, v8
    v_add3_u32 v24, v221, v11, s78
    v_add_u32 v25, 7168, v24
    s_lshl_b32 s86, s61, 2
    s_add_u32 s86, s86, s60
    s_lshl_b32 s86, s86, 15
    s_add_u32 s86, s86, 3145728
    s_waitcnt lgkmcnt(0)
    s_mov_b32 s32, s8
    s_and_b32 s33, s9, 0xffff
    s_mov_b32 s34, 1572864
    s_mov_b32 s35, 0x20000
    s_lshl_b32 s78, s2, 2
    s_add_u32 s78, s78, s60
    s_mul_i32 s78, s78, 1536
    v_lshlrev_b32 v229, 3, v1
    s_mov_b64 exec, 0xfff
    buffer_load_dword v230, v229, s[32:35], s78 offen
    s_mov_b64 exec, -1
    s_cmp_lt_u32 s60, 2
    s_cselect_b32 s36, s16, s18
    s_cselect_b32 s37, s17, s19
    s_and_b32 s37, s37, 0xffff
    s_mov_b32 s38, 1835008
    s_mov_b32 s39, 0x20000
    s_mov_b32 s44, s20
    s_and_b32 s45, s21, 0xffff
    s_mov_b32 s46, 1835008
    s_mov_b32 s47, 0x20000
    s_mov_b32 s48, s12
    s_and_b32 s49, s13, 0xffff
    s_mov_b32 s50, 524288
    s_mov_b32 s51, 0x20000
    s_mov_b32 s52, s22
    s_and_b32 s53, s23, 0xffff
    s_mov_b32 s54, 2097152
    s_mov_b32 s55, 0x20000
    s_mov_b32 s56, s10
    s_and_b32 s57, s11, 0xffff
    s_mov_b32 s58, 16384
    s_mov_b32 s59, 0x20000
    s_mul_i32 s80, s63, 448
    s_and_b32 s78, s63, 1
    s_and_b32 s79, s62, 1
    s_cbranch_scc1 L_typeB
    s_cmp_eq_u32 s78, 0
    s_cselect_b32 s73, 384, 0
    s_cselect_b32 s74, 256, 64
    s_add_u32 s73, s73, s80
    s_add_u32 s74, s74, s80
    s_mul_i32 s78, s60, 49152
    s_lshl_b32 s79, s63, 7
    s_add_u32 s78, s78, s79
    v_lshrrev_b32 v222, 4, v0
    v_bfe_u32 v223, v0, 1, 3
    v_lshlrev_b32 v224, 1, v222
    v_xor_b32 v223, v223, v224
    v_and_b32 v224, 3, v223
    v_lshrrev_b32 v223, 2, v223
    v_lshlrev_b32 v223, 10, v223
    v_lshl_add_u32 v223, v224, 5, v223
    v_and_b32_e64 v224, 1, v0
    v_lshl_add_u32 v223, v224, 4, v223
    v_mul_u32_u24 v222, 3072, v222
    s_add_u32 s78, s78, 1024
    v_add3_u32 v6, v222, v223, s78
    v_add_u32 v7, 11264, v6
    v_add_u32 v8, 22528, v6
    v_add_u32 v9, 33792, v6
    v_lshrrev_b32 v222, 2, v0
    v_mul_u32_u24 v222, 3584, v222
    v_bfe_u32 v223, v0, 1, 1
    v_xor_b32 v223, s64, v223
    v_lshlrev_b32 v223, 5, v223
    v_lshl_add_u32 v223, v224, 4, v223
    s_mul_i32 s78, s65, 114688
    v_add3_u32 v10, v222, v223, s78
    v_add_u32 v11, 56320, v10
    v_and_b32 v86, 7, v0
    v_lshrrev_b32 v87, 3, v0
    v_lshlrev_b32 v96, 5, v86
    v_add_u32 v96, 155648, v96
    s_lshl_b32 s78, s60, 3
    v_add_u32 v98, s78, v96
    s_lshr_b32 s78, s62, 2
    s_lshl_b32 s79, s61, 2
    s_add_u32 s78, s78, s79
    s_lshl_b32 s78, s78, 15
    s_and_b32 s79, s62, 3
    s_lshl_b32 s79, s79, 7
    s_add_u32 s78, s78, s79
    s_lshl_b32 s79, s60, 13
    s_add_u32 s78, s78, s79
    s_add_u32 s78, s78, 3145728
    s_add_u32 s79, s78, 4096
    v_lshlrev_b32 v97, 9, v87
    v_lshl_add_u32 v97, v86, 4, v97
    s_waitcnt vmcnt(3)
    s_lshl_b32 s77, s2, 1
    s_add_u32 s77, s77, s65
    s_mul_i32 s77, s77, 3584
    s_mov_b64 exec, 0xfffffff
    buffer_load_dword v231, v229, s[36:39], s77 offen
    s_mov_b64 exec, -1
    v_lshlrev_b32 v68, 16, v60
    v_and_b32 v69, 0xffff0000, v60
    v_lshlrev_b32 v70, 16, v61
    v_and_b32 v71, 0xffff0000, v61
    v_lshlrev_b32 v72, 16, v62
    v_and_b32 v73, 0xffff0000, v62
    v_lshlrev_b32 v74, 16, v63
    v_and_b32 v75, 0xffff0000, v63
    v_lshlrev_b32 v76, 16, v64
    v_and_b32 v77, 0xffff0000, v64
    v_lshlrev_b32 v78, 16, v65
    v_and_b32 v79, 0xffff0000, v65
    v_lshlrev_b32 v80, 16, v66
    v_and_b32 v81, 0xffff0000, v66
    v_lshlrev_b32 v82, 16, v67
    v_and_b32 v83, 0xffff0000, v67
    v_add_f32 v84, v68, v69
    v_mul_f32 v85, v68, v68
    v_fmac_f32 v85, v69, v69
    v_add_f32 v84, v84, v70
    v_fmac_f32 v85, v70, v70
    v_add_f32 v84, v84, v71
    v_fmac_f32 v85, v71, v71
    v_add_f32 v84, v84, v72
    v_fmac_f32 v85, v72, v72
    v_add_f32 v84, v84, v73
    v_fmac_f32 v85, v73, v73
    v_add_f32 v84, v84, v74
    v_fmac_f32 v85, v74, v74
    v_add_f32 v84, v84, v75
    v_fmac_f32 v85, v75, v75
    v_add_f32 v84, v84, v76
    v_fmac_f32 v85, v76, v76
    v_add_f32 v84, v84, v77
    v_fmac_f32 v85, v77, v77
    v_add_f32 v84, v84, v78
    v_fmac_f32 v85, v78, v78
    v_add_f32 v84, v84, v79
    v_fmac_f32 v85, v79, v79
    v_add_f32 v84, v84, v80
    v_fmac_f32 v85, v80, v80
    v_add_f32 v84, v84, v81
    v_fmac_f32 v85, v81, v81
    v_add_f32 v84, v84, v82
    v_fmac_f32 v85, v82, v82
    v_add_f32 v84, v84, v83
    v_fmac_f32 v85, v83, v83
    s_nop 0
    v_add_f32_dpp v84, v84, v84 row_ror:8 row_mask:0xf bank_mask:0xf
    v_add_f32_dpp v85, v85, v85 row_ror:8 row_mask:0xf bank_mask:0xf
    v_mov_b32 v86, v84
    v_mov_b32 v87, v85
    s_nop 0
    v_permlane16_swap_b32 v86, v84
    v_permlane16_swap_b32 v87, v85
    v_add_f32 v84, v84, v86
    v_add_f32 v85, v85, v87
    v_mov_b32 v86, v84
    v_mov_b32 v87, v85
    s_nop 0
    v_permlane32_swap_b32 v86, v84
    v_permlane32_swap_b32 v87, v85
    v_add_f32 v84, v84, v86
    v_add_f32 v85, v85, v87
    ds_write_b64 v98, v[84:85]
    s_waitcnt lgkmcnt(0)
    s_barrier
    ds_read_b128 v[88:91], v96
    ds_read_b128 v[92:95], v96 offset:16
    s_waitcnt lgkmcnt(0)
    v_add_f32 v84, v88, v90
    v_add_f32 v85, v89, v91
    v_add_f32 v86, v92, v94
    v_add_f32 v87, v93, v95
    v_add_f32 v84, v84, v86
    v_add_f32 v85, v85, v87
    v_mul_f32 v84, 0x3b000000, v84
    v_mul_f32 v86, v84, v84
    v_mul_f32 v85, 0x3b000000, v85
    v_sub_f32 v85, v85, v86
    v_max_f32 v85, 0, v85
    v_cvt_pk_bf16_f32 v86, v84, v85
    v_lshlrev_b32 v84, 16, v86
    v_and_b32 v85, 0xffff0000, v86
    v_sub_f32 v68, v68, v84
    v_sub_f32 v69, v69, v84
    v_add_f32 v85, 0x3727c5ac, v85
    v_cvt_pk_bf16_f32 v60, v68, v69
    v_sub_f32 v70, v70, v84
    v_sub_f32 v71, v71, v84
    v_cvt_pk_bf16_f32 v86, v85, v85
    v_cvt_pk_bf16_f32 v61, v70, v71
    v_sub_f32 v72, v72, v84
    v_sub_f32 v73, v73, v84
    v_lshlrev_b32 v85, 16, v86
    v_cvt_pk_bf16_f32 v62, v72, v73
    v_sub_f32 v74, v74, v84
    v_sub_f32 v75, v75, v84
    v_sqrt_f32 v85, v85
    v_cvt_pk_bf16_f32 v63, v74, v75
    v_sub_f32 v76, v76, v84
    v_sub_f32 v77, v77, v84
    v_cvt_pk_bf16_f32 v86, v85, v85
    v_cvt_pk_bf16_f32 v64, v76, v77
    v_sub_f32 v78, v78, v84
    v_sub_f32 v79, v79, v84
    v_lshlrev_b32 v85, 16, v86
    v_cvt_pk_bf16_f32 v65, v78, v79
    v_sub_f32 v80, v80, v84
    v_sub_f32 v81, v81, v84
    v_rcp_f32 v85, v85
    v_cvt_pk_bf16_f32 v66, v80, v81
    v_sub_f32 v82, v82, v84
    v_sub_f32 v83, v83, v84
    v_cvt_pk_bf16_f32 v67, v82, v83
    v_lshlrev_b32 v68, 16, v60
    v_and_b32 v69, 0xffff0000, v60
    v_lshlrev_b32 v70, 16, v61
    v_and_b32 v71, 0xffff0000, v61
    v_lshlrev_b32 v72, 16, v62
    v_and_b32 v73, 0xffff0000, v62
    v_lshlrev_b32 v74, 16, v63
    v_and_b32 v75, 0xffff0000, v63
    v_lshlrev_b32 v76, 16, v64
    v_and_b32 v77, 0xffff0000, v64
    v_lshlrev_b32 v78, 16, v65
    v_and_b32 v79, 0xffff0000, v65
    v_lshlrev_b32 v80, 16, v66
    v_and_b32 v81, 0xffff0000, v66
    v_lshlrev_b32 v82, 16, v67
    v_and_b32 v83, 0xffff0000, v67
    v_mul_f32 v68, v68, v85
    v_mul_f32 v69, v69, v85
    v_mul_f32 v70, v70, v85
    v_mul_f32 v71, v71, v85
    v_cvt_pk_bf16_f32 v60, v68, v69
    v_mul_f32 v72, v72, v85
    v_mul_f32 v73, v73, v85
    v_cvt_pk_bf16_f32 v61, v70, v71
    v_mul_f32 v74, v74, v85
    v_mul_f32 v75, v75, v85
    v_cvt_pk_bf16_f32 v62, v72, v73
    v_mul_f32 v76, v76, v85
    v_mul_f32 v77, v77, v85
    v_cvt_pk_bf16_f32 v63, v74, v75
    v_mul_f32 v78, v78, v85
    v_mul_f32 v79, v79, v85
    v_cvt_pk_bf16_f32 v64, v76, v77
    v_mul_f32 v80, v80, v85
    v_mul_f32 v81, v81, v85
    v_cvt_pk_bf16_f32 v65, v78, v79
    v_mul_f32 v82, v82, v85
    v_mul_f32 v83, v83, v85
    v_cvt_pk_bf16_f32 v66, v80, v81
    v_cvt_pk_bf16_f32 v67, v82, v83
    buffer_store_dwordx4 v[60:63], v97, s[40:43], s78 offen sc1
    buffer_store_dwordx4 v[64:67], v97, s[40:43], s79 offen sc1
    s_waitcnt vmcnt(5)
    v_readfirstlane_b32 s68, v220
    v_and_b32 v255, 3, v0
    v_lshlrev_b32 v255, 7, v255
    s_lshl_b32 s78, s60, 9
    s_mul_i32 s68, s68, 0x9e3779b9
    s_add_u32 s68, s68, 0x7f4a7c14
    v_add_u32 v255, s78, v255
    s_lshl_b32 s75, s61, 11
    s_add_u32 s75, s75, 131072
    s_waitcnt vmcnt(0)
    s_barrier
    s_cmp_lg_u32 s60, 0
    s_cbranch_scc1 L_fl_1
    s_lshl_b32 s79, s61, 4
    s_add_u32 s79, s79, s62
    s_lshl_b32 s79, s79, 7
    v_mov_b32 v254, s68
    s_add_u32 s79, s79, 131072
    s_mov_b64 exec, 1
    buffer_store_dword v254, off, s[40:43], s79 sc1
    s_mov_b64 exec, -1
L_fl_1:
    s_add_u32 s69, s81, 0
    s_and_b32 s69, s69, 7
    s_lshl_b32 s70, s69, 12
    s_add_u32 s70, s70, s86
    s_mul_i32 s71, s69, 196608
    s_add_u32 m0, s87, 0
    s_nop 0
    buffer_load_dwordx4 v6, s[32:35], s71 offen offset:0 lds
    buffer_load_dwordx4 v7, s[32:35], s71 offen offset:1024 lds
    buffer_load_dwordx4 v8, s[32:35], s71 offen offset:2048 lds
    buffer_load_dwordx4 v9, s[32:35], s71 offen offset:3072 lds
    s_add_u32 s69, s81, 1
    s_and_b32 s69, s69, 7
    s_lshl_b32 s70, s69, 12
    s_add_u32 s70, s70, s86
    s_mul_i32 s71, s69, 196608
    s_add_u32 m0, s87, 40960
    s_nop 0
    buffer_load_dwordx4 v6, s[32:35], s71 offen offset:0 lds
    buffer_load_dwordx4 v7, s[32:35], s71 offen offset:1024 lds
    buffer_load_dwordx4 v8, s[32:35], s71 offen offset:2048 lds
    buffer_load_dwordx4 v9, s[32:35], s71 offen offset:3072 lds
    s_lshl_b32 s77, s63, 11
    s_lshl_b32 s78, s65, 10
    s_mov_b32 m0, s93
    s_add_u32 s77, s77, s78
    buffer_load_dwordx4 v1, s[56:59], s77 offen lds
    s_mov_b32 s95, 0x3fb8aa3b
    s_mov_b32 s82, 0x0000ffff
    s_mov_b32 s83, 0x0000ffff
    s_mul_i32 s89, s60, 458752
    s_lshl_b32 s90, s60, 17
    s_lshl_b32 s96, s61, 1
    s_add_u32 s96, s96, s64
    s_mul_i32 s96, s96, 294912
    s_add_u32 s96, s96, 5242880
    s_mul_i32 s27, s60, 4096
    s_add_u32 s27, s27, 24576
    s_lshr_b32 s26, s66, 1
    s_lshl_b32 s26, s26, 11
    v_and_b32 v222, 3, v0
    v_lshlrev_b32 v222, 3, v222
    v_bfe_u32 v223, v0, 2, 2
    v_bfe_u32 v224, v0, 4, 1
    v_lshrrev_b32 v225, 5, v0
    v_lshl_add_u32 v226, v225, 3, v223
    v_and_b32 v227, 2, v223
    s_lshl_b32 s78, s65, 1
    v_xor_b32 v227, s78, v227
    v_xor_b32_e64 v227, v227, v224
    v_lshl_add_u32 v227, v227, 5, v222
    v_lshl_add_u32 v227, v226, 7, v227
    v_lshl_add_u32 v12, v224, 13, v227
    v_xor_b32 v13, 32, v12
    v_add_u32 v14, 81920, v12
    v_add_u32 v15, 81920, v13
    s_lshl_b32 s79, s64, 13
    s_add_u32 s79, s79, 24576
    v_add_u32 v22, s79, v1
    v_add_u32 v23, 81920, v22
    v_xor_b32 v228, s64, v224
    v_add_u32 v228, s78, v228
    v_lshlrev_b32 v227, 1, v223
    v_xor_b32_e64 v228, v228, v227
    v_lshl_add_u32 v228, v228, 5, v222
    v_lshl_add_u32 v16, v226, 8, v228
    v_xor_b32 v17, 128, v16
    v_xor_b32_e64 v228, s65, v224
    v_lshl_add_u32 v228, v228, 5, v222
    v_lshl_add_u32 v228, v226, 6, v228
    v_lshl_add_u32 v228, v224, 12, v228
    v_add_u32 v18, 16384, v228
    v_add_u32 v19, 81920, v16
    v_add_u32 v20, 81920, v17
    v_add_u32 v21, 81920, v18
    v_lshl_add_u32 v226, v225, 2, v223
    v_and_b32 v227, 2, v223
    v_xor_b32 v227, s78, v227
    v_add_u32 v227, v227, v224
    v_lshl_add_u32 v227, v227, 5, v222
    v_lshl_add_u32 v227, v226, 7, v227
    v_add_u32 v26, s93, v227
    v_xor_b32 v27, 64, v26
    v_add_u32 v52, s27, v227
    v_xor_b32 v53, 64, v52
    v_add_u32 v54, 81920, v52
    v_add_u32 v55, 81920, v53
    s_add_u32 s79, s87, 40960
    v_add_u32 v56, s79, v227
    v_xor_b32 v57, 64, v56
    s_add_u32 s79, s88, 155648
    v_add_u32 v58, s79, v227
    v_xor_b32 v59, 64, v58
    s_lshl_b32 s84, s73, 5
    s_lshl_b32 s79, s65, 10
    s_add_u32 s84, s84, s79
    s_add_u32 s84, s84, s96
    s_lshl_b32 s85, s74, 5
    s_lshl_b32 s79, s65, 11
    s_add_u32 s85, s85, s79
    s_add_u32 s85, s85, s96
    s_lshl_b32 s79, s66, 1
    s_add_u32 s91, s79, s64
    s_xor_b32 s92, s91, 1
    s_mul_i32 s91, s91, 147456
    s_mul_i32 s92, s92, 147456
    s_mul_i32 s79, s60, 28672
    s_add_u32 s79, s79, 5242880
    s_add_u32 s91, s91, s79
    s_add_u32 s92, s92, s79
    v_lshlrev_b32_e64 v226, 5, v226
    v_lshl_add_u32 v226, v224, 4, v226
    v_bfe_u32 v227, v0, 1, 1
    v_lshl_add_u32 v226, v227, 3, v226
    v_add_u32 v226, s93, v226
    s_lshl_b32 s79, s64, 9
    v_add_u32_e64 v226, s79, v226
    v_xor_b32 v227, 512, v226
    v_bfe_i32 v228, v0, 2, 1
    v_and_b32 v228, 0x80008000, v228
    buffer_load_dword v220, v255, s[40:43], s75 offen sc1
    v_and_b32 v244, 3, v0
    v_lshlrev_b32 v244, 3, v244
    v_bfe_u32 v245, v0, 2, 2
    v_bfe_u32 v246, v0, 4, 1
    v_lshrrev_b32 v247, 5, v0
    v_and_b32 v248, 31, v0
    v_lshlrev_b32 v242, 14, v247
    v_lshl_add_u32 v242, v248, 4, v242
    v_bfe_u32 v249, v0, 1, 3
    v_xor_b32 v249, v249, v247
    v_lshlrev_b32 v249, 3, v249
    v_lshl_add_u32 v249, v248, 6, v249
    v_add_u32 v233, s93, v249
    v_xor_b32 v234, 16, v233
    v_xor_b32 v235, 32, v233
    v_xor_b32 v236, 48, v233
    v_lshl_add_u32 v248, v247, 2, v245
    v_lshrrev_b32 v249, 1, v248
    v_lshlrev_b32 v249, 3, v249
    v_lshl_add_u32 v244, v246, 5, v244
    v_xor_b32 v249, v249, v244
    v_lshl_add_u32 v249, v248, 6, v249
    v_add_u32 v237, s93, v249
    v_xor_b32 v238, 32, v237
    v_add_u32 v238, 512, v238
    v_mov_b32 v239, 0x3f803f80
    v_add_u32 v240, s93, v1
    s_xor_b32 s78, s60, 2
    s_lshl_b32 s78, s78, 13
    s_add_u32 s78, s78, 122880
    v_xor_b32 v241, 256, v1
    v_add_u32 v241, s78, v241
    s_lshl_b32 s0, s63, 2
    s_lshl_b32 s78, s65, 1
    s_add_u32 s0, s0, s78
    s_add_u32 s0, s0, s64
    s_lshl_b32 s0, s0, 16
    s_lshl_b32 s78, s61, 10
    s_add_u32 s0, s0, s78
    s_add_u32 s0, s0, 1048576
    s_add_u32 s80, s0, 32768
    s_add_u32 s1, s84, 147456
    s_waitcnt vmcnt(0)
    v_cmp_ne_u32 vcc, s68, v220
    s_cbranch_vccz L_pd_3
    s_mov_b32 s94, 0
L_pl_2:
    buffer_load_dword v220, v255, s[40:43], s75 offen sc1
    s_add_u32 s94, s94, 1
    s_waitcnt vmcnt(0)
    v_cmp_ne_u32 vcc, s68, v220
    s_cbranch_vccz L_pd_3
    s_cmp_lt_u32 s94, s97
    s_cbranch_scc1 L_pl_2
    s_mov_b32 s97, 0
L_pd_3:
    s_add_u32 s69, s81, 0
    s_and_b32 s69, s69, 7
    s_lshl_b32 s70, s69, 12
    s_add_u32 s70, s70, s86
    s_mul_i32 s71, s69, 196608
    s_add_u32 m0, s87, 24576
    s_nop 0
    buffer_load_dwordx4 v1, s[40:43], s70 offen offset:0 sc1 lds
    buffer_load_dwordx4 v1, s[40:43], s70 offen offset:1024 sc1 lds
    buffer_load_dwordx4 v1, s[40:43], s70 offen offset:2048 sc1 lds
    buffer_load_dwordx4 v1, s[40:43], s70 offen offset:3072 sc1 lds
    s_add_u32 s69, s81, 1
    s_and_b32 s69, s69, 7
    s_lshl_b32 s70, s69, 12
    s_add_u32 s70, s70, s86
    s_mul_i32 s71, s69, 196608
    s_add_u32 m0, s87, 65536
    s_nop 0
    buffer_load_dwordx4 v1, s[40:43], s70 offen offset:0 sc1 lds
    buffer_load_dwordx4 v1, s[40:43], s70 offen offset:1024 sc1 lds
    buffer_load_dwordx4 v1, s[40:43], s70 offen offset:2048 sc1 lds
    buffer_load_dwordx4 v1, s[40:43], s70 offen offset:3072 sc1 lds
    s_waitcnt vmcnt(4)
    s_barrier
    ds_read_b64_tr_b16 v[28:29], v16 offset:0
    ds_read_b64_tr_b16 v[30:31], v16 offset:1024
    ds_read_b128 a[0:3], v22 offset:0
    ds_read_b128 a[4:7], v22 offset:4096
    ds_read_b64_tr_b16 v[32:33], v17 offset:0
    ds_read_b64_tr_b16 v[34:35], v17 offset:1024
    ds_read_b64_tr_b16 v[36:37], v16 offset:4096
    ds_read_b64_tr_b16 v[38:39], v16 offset:5120
    s_add_u32 s69, s81, 2
    s_and_b32 s69, s69, 7
    s_lshl_b32 s70, s69, 12
    s_add_u32 s70, s70, s86
    s_mul_i32 s71, s69, 196608
    s_add_u32 m0, s87, 81920
    s_waitcnt lgkmcnt(4)
    v_mfma_f32_32x32x16_bf16 v[60:75], v[28:31], a[0:3], 0
    ds_read_b64_tr_b16 v[40:41], v17 offset:4096
    ds_read_b64_tr_b16 v[42:43], v17 offset:5120
    buffer_load_dwordx4 v6, s[32:35], s71 offen offset:0 lds
    v_mfma_f32_32x32x16_bf16 v[76:91], v[28:31], a[4:7], 0
    ds_read_b128 a[8:11], v22 offset:1024
    ds_read_b128 a[12:15], v22 offset:5120
    buffer_load_dwordx4 v7, s[32:35], s71 offen offset:1024 lds
    s_waitcnt lgkmcnt(6)
    v_mfma_f32_32x32x16_bf16 v[92:107], a[0:3], v[32:35], 0
    ds_read_b64_tr_b16 v[28:29], v16 offset:8192
    ds_read_b64_tr_b16 v[30:31], v16 offset:9216
    v_mfma_f32_32x32x16_bf16 v[108:123], a[4:7], v[32:35], 0
    buffer_load_dwordx4 v8, s[32:35], s71 offen offset:2048 lds
    s_waitcnt lgkmcnt(2)
    v_mfma_f32_32x32x16_bf16 v[60:75], v[36:39], a[8:11], v[60:75]
    ds_read_b64_tr_b16 v[32:33], v17 offset:8192
    ds_read_b64_tr_b16 v[34:35], v17 offset:9216
    buffer_load_dwordx4 v9, s[32:35], s71 offen offset:3072 lds
    s_add_u32 m0, s87, 106496
    v_mfma_f32_32x32x16_bf16 v[76:91], v[36:39], a[12:15], v[76:91]
    ds_read_b128 a[16:19], v22 offset:2048
    ds_read_b128 a[20:23], v22 offset:6144
    v_mfma_f32_32x32x16_bf16 v[92:107], a[8:11], v[40:43], v[92:107]
    ds_read_b64_tr_b16 v[36:37], v16 offset:12288
    ds_read_b64_tr_b16 v[38:39], v16 offset:13312
    buffer_load_dwordx4 v1, s[40:43], s70 offen offset:0 sc1 lds
    v_mfma_f32_32x32x16_bf16 v[108:123], a[12:15], v[40:43], v[108:123]
    buffer_load_dwordx4 v1, s[40:43], s70 offen offset:1024 sc1 lds
    s_waitcnt lgkmcnt(2)
    v_mfma_f32_32x32x16_bf16 v[60:75], v[28:31], a[16:19], v[60:75]
    ds_read_b64_tr_b16 v[40:41], v17 offset:12288
    ds_read_b64_tr_b16 v[42:43], v17 offset:13312
    v_mfma_f32_32x32x16_bf16 v[76:91], v[28:31], a[20:23], v[76:91]
    ds_read_b128 a[24:27], v22 offset:3072
    ds_read_b128 a[28:31], v22 offset:7168
    buffer_load_dwordx4 v1, s[40:43], s70 offen offset:2048 sc1 lds
    v_mfma_f32_32x32x16_bf16 v[92:107], a[16:19], v[32:35], v[92:107]
    buffer_load_dwordx4 v1, s[40:43], s70 offen offset:3072 sc1 lds
    v_mfma_f32_32x32x16_bf16 v[108:123], a[20:23], v[32:35], v[108:123]
    s_waitcnt lgkmcnt(0)
    s_waitcnt vmcnt(8)
    s_barrier
    v_mfma_f32_32x32x16_bf16 v[60:75], v[36:39], a[24:27], v[60:75]
    ds_read_b64_tr_b16 v[28:29], v16 offset:40960
    ds_read_b64_tr_b16 v[30:31], v16 offset:41984
    ds_read_b128 a[32:35], v22 offset:40960
    ds_read_b128 a[36:39], v22 offset:45056
    v_mfma_f32_32x32x16_bf16 v[76:91], v[36:39], a[28:31], v[76:91]
    ds_read_b64_tr_b16 v[32:33], v17 offset:40960
    ds_read_b64_tr_b16 v[34:35], v17 offset:41984
    v_mfma_f32_32x32x16_bf16 v[92:107], a[24:27], v[40:43], v[92:107]
    ds_read_b64_tr_b16 v[36:37], v16 offset:45056
    ds_read_b64_tr_b16 v[38:39], v16 offset:46080
    v_mfma_f32_32x32x16_bf16 v[108:123], a[28:31], v[40:43], v[108:123]
    s_add_u32 s69, s81, 3
    s_and_b32 s69, s69, 7
    s_lshl_b32 s70, s69, 12
    s_add_u32 s70, s70, s86
    s_mul_i32 s71, s69, 196608
    s_add_u32 m0, s87, 0
    s_waitcnt lgkmcnt(4)
    v_mfma_f32_32x32x16_bf16 v[60:75], v[28:31], a[32:35], v[60:75]
    ds_read_b64_tr_b16 v[40:41], v17 offset:45056
    ds_read_b64_tr_b16 v[42:43], v17 offset:46080
    buffer_load_dwordx4 v6, s[32:35], s71 offen offset:0 lds
    v_mfma_f32_32x32x16_bf16 v[76:91], v[28:31], a[36:39], v[76:91]
    ds_read_b128 a[40:43], v22 offset:41984
    ds_read_b128 a[44:47], v22 offset:46080
    buffer_load_dwordx4 v7, s[32:35], s71 offen offset:1024 lds
    s_waitcnt lgkmcnt(6)
    v_mfma_f32_32x32x16_bf16 v[92:107], a[32:35], v[32:35], v[92:107]
    ds_read_b64_tr_b16 v[28:29], v16 offset:49152
    ds_read_b64_tr_b16 v[30:31], v16 offset:50176
    v_mfma_f32_32x32x16_bf16 v[108:123], a[36:39], v[32:35], v[108:123]
    buffer_load_dwordx4 v8, s[32:35], s71 offen offset:2048 lds
    s_waitcnt lgkmcnt(2)
    v_mfma_f32_32x32x16_bf16 v[60:75], v[36:39], a[40:43], v[60:75]
    ds_read_b64_tr_b16 v[32:33], v17 offset:49152
    ds_read_b64_tr_b16 v[34:35], v17 offset:50176
    buffer_load_dwordx4 v9, s[32:35], s71 offen offset:3072 lds
    s_add_u32 m0, s87, 24576
    v_mfma_f32_32x32x16_bf16 v[76:91], v[36:39], a[44:47], v[76:91]
    ds_read_b128 a[48:51], v22 offset:43008
    ds_read_b128 a[52:55], v22 offset:47104
    ds_read_b64_tr_b16 v[44:45], v226 offset:0
    ds_read_b64_tr_b16 v[46:47], v226 offset:256
    ds_read_b64_tr_b16 v[48:49], v227 offset:0
    ds_read_b64_tr_b16 v[50:51], v227 offset:256
    v_mfma_f32_32x32x16_bf16 v[92:107], a[40:43], v[40:43], v[92:107]
    ds_read_b64_tr_b16 v[36:37], v16 offset:53248
    ds_read_b64_tr_b16 v[38:39], v16 offset:54272
    buffer_load_dwordx4 v1, s[40:43], s70 offen offset:0 sc1 lds
    v_mfma_f32_32x32x16_bf16 v[108:123], a[44:47], v[40:43], v[108:123]
    buffer_load_dwordx4 v1, s[40:43], s70 offen offset:1024 sc1 lds
    s_waitcnt lgkmcnt(6)
    v_mfma_f32_32x32x16_bf16 v[60:75], v[28:31], a[48:51], v[60:75]
    ds_read_b64_tr_b16 v[40:41], v17 offset:53248
    ds_read_b64_tr_b16 v[42:43], v17 offset:54272
    v_mfma_f32_32x32x16_bf16 v[76:91], v[28:31], a[52:55], v[76:91]
    ds_read_b128 a[56:59], v22 offset:44032
    ds_read_b128 a[60:63], v22 offset:48128
    s_waitcnt lgkmcnt(6)
    v_xor_b32 v44, v44, v228
    v_xor_b32 v45, v45, v228
    v_xor_b32 v46, v46, v228
    v_xor_b32 v47, v47, v228
    v_xor_b32 v48, v48, v228
    v_xor_b32 v49, v49, v228
    v_xor_b32 v50, v50, v228
    v_xor_b32 v51, v51, v228
    buffer_load_dwordx4 v1, s[40:43], s70 offen offset:2048 sc1 lds
    v_mfma_f32_32x32x16_bf16 v[92:107], a[48:51], v[32:35], v[92:107]
    buffer_load_dwordx4 v1, s[40:43], s70 offen offset:3072 sc1 lds
    v_mfma_f32_32x32x16_bf16 v[108:123], a[52:55], v[32:35], v[108:123]
    s_waitcnt lgkmcnt(0)
    s_waitcnt vmcnt(8)
    s_barrier
    v_mfma_f32_32x32x16_bf16 v[60:75], v[36:39], a[56:59], v[60:75]
    ds_read_b64_tr_b16 v[28:29], v19 offset:0
    ds_read_b64_tr_b16 v[30:31], v19 offset:1024
    ds_read_b128 a[64:67], v23 offset:0
    ds_read_b128 a[68:71], v23 offset:4096
    v_mfma_f32_32x32x16_bf16 v[76:91], v[36:39], a[60:63], v[76:91]
    ds_read_b64_tr_b16 v[32:33], v20 offset:0
    ds_read_b64_tr_b16 v[34:35], v20 offset:1024
    v_mfma_f32_32x32x16_bf16 v[92:107], a[56:59], v[40:43], v[92:107]
    ds_read_b64_tr_b16 v[36:37], v19 offset:4096
    ds_read_b64_tr_b16 v[38:39], v19 offset:5120
    v_mfma_f32_32x32x16_bf16 v[108:123], a[60:63], v[40:43], v[108:123]
    s_add_u32 s69, s81, 4
    s_and_b32 s69, s69, 7
    s_lshl_b32 s70, s69, 12
    s_add_u32 s70, s70, s86
    s_mul_i32 s71, s69, 196608
    s_add_u32 m0, s87, 40960
    s_waitcnt lgkmcnt(4)
    v_mfma_f32_32x32x16_bf16 v[60:75], v[28:31], a[64:67], v[60:75]
    ds_read_b64_tr_b16 v[40:41], v20 offset:4096
    ds_read_b64_tr_b16 v[42:43], v20 offset:5120
    buffer_load_dwordx4 v6, s[32:35], s71 offen offset:0 lds
    v_mfma_f32_32x32x16_bf16 v[76:91], v[28:31], a[68:71], v[76:91]
    ds_read_b128 a[72:75], v23 offset:1024
    ds_read_b128 a[76:79], v23 offset:5120
    buffer_load_dwordx4 v7, s[32:35], s71 offen offset:1024 lds
    s_waitcnt lgkmcnt(6)
    v_mfma_f32_32x32x16_bf16 v[92:107], a[64:67], v[32:35], v[92:107]
    ds_read_b64_tr_b16 v[28:29], v19 offset:8192
    ds_read_b64_tr_b16 v[30:31], v19 offset:9216
    v_mfma_f32_32x32x16_bf16 v[108:123], a[68:71], v[32:35], v[108:123]
    buffer_load_dwordx4 v8, s[32:35], s71 offen offset:2048 lds
    s_waitcnt lgkmcnt(2)
    v_mfma_f32_32x32x16_bf16 v[60:75], v[36:39], a[72:75], v[60:75]
    ds_read_b64_tr_b16 v[32:33], v20 offset:8192
    ds_read_b64_tr_b16 v[34:35], v20 offset:9216
    buffer_load_dwordx4 v9, s[32:35], s71 offen offset:3072 lds
    s_add_u32 m0, s87, 65536
    v_mfma_f32_32x32x16_bf16 v[76:91], v[36:39], a[76:79], v[76:91]
    ds_read_b128 a[80:83], v23 offset:2048
    ds_read_b128 a[84:87], v23 offset:6144
    v_mfma_f32_32x32x16_bf16 v[92:107], a[72:75], v[40:43], v[92:107]
    ds_read_b64_tr_b16 v[36:37], v19 offset:12288
    ds_read_b64_tr_b16 v[38:39], v19 offset:13312
    buffer_load_dwordx4 v1, s[40:43], s70 offen offset:0 sc1 lds
    v_mfma_f32_32x32x16_bf16 v[108:123], a[76:79], v[40:43], v[108:123]
    buffer_load_dwordx4 v1, s[40:43], s70 offen offset:1024 sc1 lds
    s_waitcnt lgkmcnt(2)
    v_mfma_f32_32x32x16_bf16 v[60:75], v[28:31], a[80:83], v[60:75]
    ds_read_b64_tr_b16 v[40:41], v20 offset:12288
    ds_read_b64_tr_b16 v[42:43], v20 offset:13312
    v_mfma_f32_32x32x16_bf16 v[76:91], v[28:31], a[84:87], v[76:91]
    ds_read_b128 a[88:91], v23 offset:3072
    ds_read_b128 a[92:95], v23 offset:7168
    buffer_load_dwordx4 v1, s[40:43], s70 offen offset:2048 sc1 lds
    v_mfma_f32_32x32x16_bf16 v[92:107], a[80:83], v[32:35], v[92:107]
    buffer_load_dwordx4 v1, s[40:43], s70 offen offset:3072 sc1 lds
    v_mfma_f32_32x32x16_bf16 v[108:123], a[84:87], v[32:35], v[108:123]
    s_xor_b32 s78, s2, 0
    s_lshl_b32 s78, s78, 2
    s_add_u32 s78, s78, s60
    s_mul_i32 s79, s78, 1792
    s_lshl_b32 s78, s78, 9
    v_lshlrev_b32 v229, 3, v1
    s_mov_b64 exec, 0x3fff
    buffer_load_dword v246, v229, s[44:47], s79 offen
    s_mov_b64 exec, 0xf
    buffer_load_dword v247, v229, s[48:51], s78 offen
    s_mov_b64 exec, -1
    s_waitcnt lgkmcnt(0)
    s_waitcnt vmcnt(10)
    s_barrier
    v_mfma_f32_32x32x16_bf16 v[60:75], v[36:39], a[88:91], v[60:75]
    ds_read_b64_tr_b16 v[28:29], v16 offset:0
    ds_read_b64_tr_b16 v[30:31], v16 offset:1024
    ds_read_b128 a[96:99], v22 offset:0
    ds_read_b128 a[100:103], v22 offset:4096
    v_mfma_f32_32x32x16_bf16 v[76:91], v[36:39], a[92:95], v[76:91]
    ds_read_b64_tr_b16 v[32:33], v17 offset:0
    ds_read_b64_tr_b16 v[34:35], v17 offset:1024
    v_mfma_f32_32x32x16_bf16 v[92:107], a[88:91], v[40:43], v[92:107]
    ds_read_b64_tr_b16 v[36:37], v16 offset:4096
    ds_read_b64_tr_b16 v[38:39], v16 offset:5120
    v_mfma_f32_32x32x16_bf16 v[108:123], a[92:95], v[40:43], v[108:123]
    s_add_u32 s69, s81, 5
    s_and_b32 s69, s69, 7
    s_lshl_b32 s70, s69, 12
    s_add_u32 s70, s70, s86
    s_mul_i32 s71, s69, 196608
    s_add_u32 m0, s87, 81920
    s_waitcnt lgkmcnt(4)
    v_mfma_f32_32x32x16_bf16 v[60:75], v[28:31], a[96:99], v[60:75]
    ds_read_b64_tr_b16 v[40:41], v17 offset:4096
    ds_read_b64_tr_b16 v[42:43], v17 offset:5120
    buffer_load_dwordx4 v6, s[32:35], s71 offen offset:0 lds
    v_mfma_f32_32x32x16_bf16 v[76:91], v[28:31], a[100:103], v[76:91]
    ds_read_b128 a[104:107], v22 offset:1024
    ds_read_b128 a[108:111], v22 offset:5120
    buffer_load_dwordx4 v7, s[32:35], s71 offen offset:1024 lds
    s_waitcnt lgkmcnt(6)
    v_mfma_f32_32x32x16_bf16 v[92:107], a[96:99], v[32:35], v[92:107]
    ds_read_b64_tr_b16 v[28:29], v16 offset:8192
    ds_read_b64_tr_b16 v[30:31], v16 offset:9216
    v_mfma_f32_32x32x16_bf16 v[108:123], a[100:103], v[32:35], v[108:123]
    buffer_load_dwordx4 v8, s[32:35], s71 offen offset:2048 lds
    s_waitcnt lgkmcnt(2)
    v_mfma_f32_32x32x16_bf16 v[60:75], v[36:39], a[104:107], v[60:75]
    ds_read_b64_tr_b16 v[32:33], v17 offset:8192
    ds_read_b64_tr_b16 v[34:35], v17 offset:9216
    buffer_load_dwordx4 v9, s[32:35], s71 offen offset:3072 lds
    s_add_u32 m0, s87, 106496
    v_mfma_f32_32x32x16_bf16 v[76:91], v[36:39], a[108:111], v[76:91]
    ds_read_b128 a[112:115], v22 offset:2048
    ds_read_b128 a[116:119], v22 offset:6144
    v_mfma_f32_32x32x16_bf16 v[92:107], a[104:107], v[40:43], v[92:107]
    ds_read_b64_tr_b16 v[36:37], v16 offset:12288
    ds_read_b64_tr_b16 v[38:39], v16 offset:13312
    buffer_load_dwordx4 v1, s[40:43], s70 offen offset:0 sc1 lds
    v_mfma_f32_32x32x16_bf16 v[108:123], a[108:111], v[40:43], v[108:123]
    buffer_load_dwordx4 v1, s[40:43], s70 offen offset:1024 sc1 lds
    s_waitcnt lgkmcnt(2)
    v_mfma_f32_32x32x16_bf16 v[60:75], v[28:31], a[112:115], v[60:75]
    ds_read_b64_tr_b16 v[40:41], v17 offset:12288
    ds_read_b64_tr_b16 v[42:43], v17 offset:13312
    v_mfma_f32_32x32x16_bf16 v[76:91], v[28:31], a[116:119], v[76:91]
    ds_read_b128 a[120:123], v22 offset:3072
    ds_read_b128 a[124:127], v22 offset:7168
    buffer_load_dwordx4 v1, s[40:43], s70 offen offset:2048 sc1 lds
    v_mfma_f32_32x32x16_bf16 v[92:107], a[112:115], v[32:35], v[92:107]
    buffer_load_dwordx4 v1, s[40:43], s70 offen offset:3072 sc1 lds
    v_mfma_f32_32x32x16_bf16 v[108:123], a[116:119], v[32:35], v[108:123]
    s_waitcnt lgkmcnt(0)
    s_waitcnt vmcnt(10)
    s_barrier
    v_mfma_f32_32x32x16_bf16 v[60:75], v[36:39], a[120:123], v[60:75]
    ds_read_b64_tr_b16 v[28:29], v16 offset:40960
    ds_read_b64_tr_b16 v[30:31], v16 offset:41984
    ds_read_b128 a[128:131], v22 offset:40960
    ds_read_b128 a[132:135], v22 offset:45056
    v_mfma_f32_32x32x16_bf16 v[76:91], v[36:39], a[124:127], v[76:91]
    ds_read_b64_tr_b16 v[32:33], v17 offset:40960
    ds_read_b64_tr_b16 v[34:35], v17 offset:41984
    v_mfma_f32_32x32x16_bf16 v[92:107], a[120:123], v[40:43], v[92:107]
    ds_read_b64_tr_b16 v[36:37], v16 offset:45056
    ds_read_b64_tr_b16 v[38:39], v16 offset:46080
    v_mfma_f32_32x32x16_bf16 v[108:123], a[124:127], v[40:43], v[108:123]
    s_add_u32 s69, s81, 6
    s_and_b32 s69, s69, 7
    s_lshl_b32 s70, s69, 12
    s_add_u32 s70, s70, s86
    s_mul_i32 s71, s69, 196608
    s_add_u32 m0, s87, 0
    s_waitcnt lgkmcnt(4)
    v_mfma_f32_32x32x16_bf16 v[60:75], v[28:31], a[128:131], v[60:75]
    ds_read_b64_tr_b16 v[40:41], v17 offset:45056
    ds_read_b64_tr_b16 v[42:43], v17 offset:46080
    buffer_load_dwordx4 v6, s[32:35], s71 offen offset:0 lds
    v_mfma_f32_32x32x16_bf16 v[76:91], v[28:31], a[132:135], v[76:91]
    ds_read_b128 a[136:139], v22 offset:41984
    ds_read_b128 a[140:143], v22 offset:46080
    buffer_load_dwordx4 v7, s[32:35], s71 offen offset:1024 lds
    s_waitcnt lgkmcnt(6)
    v_mfma_f32_32x32x16_bf16 v[92:107], a[128:131], v[32:35], v[92:107]
    ds_read_b64_tr_b16 v[28:29], v16 offset:49152
    ds_read_b64_tr_b16 v[30:31], v16 offset:50176
    v_mfma_f32_32x32x16_bf16 v[108:123], a[132:135], v[32:35], v[108:123]
    buffer_load_dwordx4 v8, s[32:35], s71 offen offset:2048 lds
    s_waitcnt lgkmcnt(2)
    v_mfma_f32_32x32x16_bf16 v[60:75], v[36:39], a[136:139], v[60:75]
    ds_read_b64_tr_b16 v[32:33], v17 offset:49152
    ds_read_b64_tr_b16 v[34:35], v17 offset:50176
    buffer_load_dwordx4 v9, s[32:35], s71 offen offset:3072 lds
    s_add_u32 m0, s87, 24576
    v_mfma_f32_32x32x16_bf16 v[76:91], v[36:39], a[140:143], v[76:91]
    ds_read_b128 a[144:147], v22 offset:43008
    ds_read_b128 a[148:151], v22 offset:47104
    v_mfma_f32_32x32x16_bf16 v[92:107], a[136:139], v[40:43], v[92:107]
    ds_read_b64_tr_b16 v[36:37], v16 offset:53248
    ds_read_b64_tr_b16 v[38:39], v16 offset:54272
    buffer_load_dwordx4 v1, s[40:43], s70 offen offset:0 sc1 lds
    v_mfma_f32_32x32x16_bf16 v[108:123], a[140:143], v[40:43], v[108:123]
    buffer_load_dwordx4 v1, s[40:43], s70 offen offset:1024 sc1 lds
    s_waitcnt lgkmcnt(2)
    v_mfma_f32_32x32x16_bf16 v[60:75], v[28:31], a[144:147], v[60:75]
    ds_read_b64_tr_b16 v[40:41], v17 offset:53248
    ds_read_b64_tr_b16 v[42:43], v17 offset:54272
    v_mfma_f32_32x32x16_bf16 v[76:91], v[28:31], a[148:151], v[76:91]
    ds_read_b128 a[152:155], v22 offset:44032
    ds_read_b128 a[156:159], v22 offset:48128
    buffer_load_dwordx4 v1, s[40:43], s70 offen offset:2048 sc1 lds
    v_mfma_f32_32x32x16_bf16 v[92:107], a[144:147], v[32:35], v[92:107]
    buffer_load_dwordx4 v1, s[40:43], s70 offen offset:3072 sc1 lds
    v_mfma_f32_32x32x16_bf16 v[108:123], a[148:151], v[32:35], v[108:123]
    s_waitcnt lgkmcnt(0)
    s_waitcnt vmcnt(8)
    s_barrier
    v_mfma_f32_32x32x16_bf16 v[60:75], v[36:39], a[152:155], v[60:75]
    ds_read_b64_tr_b16 v[28:29], v19 offset:0
    ds_read_b64_tr_b16 v[30:31], v19 offset:1024
    ds_read_b128 a[160:163], v23 offset:0
    ds_read_b128 a[164:167], v23 offset:4096
    v_mfma_f32_32x32x16_bf16 v[76:91], v[36:39], a[156:159], v[76:91]
    ds_read_b64_tr_b16 v[32:33], v20 offset:0
    ds_read_b64_tr_b16 v[34:35], v20 offset:1024
    v_mfma_f32_32x32x16_bf16 v[92:107], a[152:155], v[40:43], v[92:107]
    ds_read_b64_tr_b16 v[36:37], v19 offset:4096
    ds_read_b64_tr_b16 v[38:39], v19 offset:5120
    v_mfma_f32_32x32x16_bf16 v[108:123], a[156:159], v[40:43], v[108:123]
    s_add_u32 s69, s81, 7
    s_and_b32 s69, s69, 7
    s_lshl_b32 s70, s69, 12
    s_add_u32 s70, s70, s86
    s_mul_i32 s71, s69, 196608
    s_add_u32 m0, s87, 40960
    s_waitcnt lgkmcnt(4)
    v_mfma_f32_32x32x16_bf16 v[60:75], v[28:31], a[160:163], v[60:75]
    ds_read_b64_tr_b16 v[40:41], v20 offset:4096
    ds_read_b64_tr_b16 v[42:43], v20 offset:5120
    buffer_load_dwordx4 v6, s[32:35], s71 offen offset:0 lds
    v_mfma_f32_32x32x16_bf16 v[76:91], v[28:31], a[164:167], v[76:91]
    ds_read_b128 a[168:171], v23 offset:1024
    ds_read_b128 a[172:175], v23 offset:5120
    buffer_load_dwordx4 v7, s[32:35], s71 offen offset:1024 lds
    s_waitcnt lgkmcnt(6)
    v_mfma_f32_32x32x16_bf16 v[92:107], a[160:163], v[32:35], v[92:107]
    ds_read_b64_tr_b16 v[28:29], v19 offset:8192
    ds_read_b64_tr_b16 v[30:31], v19 offset:9216
    v_mfma_f32_32x32x16_bf16 v[108:123], a[164:167], v[32:35], v[108:123]
    buffer_load_dwordx4 v8, s[32:35], s71 offen offset:2048 lds
    s_waitcnt lgkmcnt(2)
    v_mfma_f32_32x32x16_bf16 v[60:75], v[36:39], a[168:171], v[60:75]
    ds_read_b64_tr_b16 v[32:33], v20 offset:8192
    ds_read_b64_tr_b16 v[34:35], v20 offset:9216
    buffer_load_dwordx4 v9, s[32:35], s71 offen offset:3072 lds
    s_add_u32 m0, s87, 65536
    v_mfma_f32_32x32x16_bf16 v[76:91], v[36:39], a[172:175], v[76:91]
    ds_read_b128 a[176:179], v23 offset:2048
    ds_read_b128 a[180:183], v23 offset:6144
    v_mfma_f32_32x32x16_bf16 v[92:107], a[168:171], v[40:43], v[92:107]
    ds_read_b64_tr_b16 v[36:37], v19 offset:12288
    ds_read_b64_tr_b16 v[38:39], v19 offset:13312
    buffer_load_dwordx4 v1, s[40:43], s70 offen offset:0 sc1 lds
    v_mfma_f32_32x32x16_bf16 v[108:123], a[172:175], v[40:43], v[108:123]
    buffer_load_dwordx4 v1, s[40:43], s70 offen offset:1024 sc1 lds
    s_waitcnt lgkmcnt(2)
    v_mfma_f32_32x32x16_bf16 v[60:75], v[28:31], a[176:179], v[60:75]
    ds_read_b64_tr_b16 v[40:41], v20 offset:12288
    ds_read_b64_tr_b16 v[42:43], v20 offset:13312
    v_mfma_f32_32x32x16_bf16 v[76:91], v[28:31], a[180:183], v[76:91]
    ds_read_b128 a[184:187], v23 offset:3072
    ds_read_b128 a[188:191], v23 offset:7168
    buffer_load_dwordx4 v1, s[40:43], s70 offen offset:2048 sc1 lds
    v_mfma_f32_32x32x16_bf16 v[92:107], a[176:179], v[32:35], v[92:107]
    buffer_load_dwordx4 v1, s[40:43], s70 offen offset:3072 sc1 lds
    v_mfma_f32_32x32x16_bf16 v[108:123], a[180:183], v[32:35], v[108:123]
    s_waitcnt lgkmcnt(0)
    s_waitcnt vmcnt(8)
    s_barrier
    v_mfma_f32_32x32x16_bf16 v[60:75], v[36:39], a[184:187], v[60:75]
    ds_read_b64_tr_b16 v[28:29], v16 offset:0
    ds_read_b64_tr_b16 v[30:31], v16 offset:1024
    ds_read_b128 a[192:195], v22 offset:0
    ds_read_b128 a[196:199], v22 offset:4096
    v_mfma_f32_32x32x16_bf16 v[76:91], v[36:39], a[188:191], v[76:91]
    ds_read_b64_tr_b16 v[32:33], v17 offset:0
    ds_read_b64_tr_b16 v[34:35], v17 offset:1024
    v_mfma_f32_32x32x16_bf16 v[92:107], a[184:187], v[40:43], v[92:107]
    ds_read_b64_tr_b16 v[36:37], v16 offset:4096
    ds_read_b64_tr_b16 v[38:39], v16 offset:5120
    v_mfma_f32_32x32x16_bf16 v[108:123], a[188:191], v[40:43], v[108:123]
    s_add_u32 s69, s81, 0
    s_and_b32 s69, s69, 7
    s_mul_i32 s72, s69, 229376
    s_add_u32 s3, s72, s73
    s_add_u32 s72, s72, s74
    s_add_u32 m0, s87, 81920
    s_waitcnt lgkmcnt(4)
    v_mfma_f32_32x32x16_bf16 v[60:75], v[28:31], a[192:195], v[60:75]
    ds_read_b64_tr_b16 v[40:41], v17 offset:4096
    ds_read_b64_tr_b16 v[42:43], v17 offset:5120
    buffer_load_dwordx4 v2, s[36:39], s72 offen offset:0 lds
    v_mfma_f32_32x32x16_bf16 v[76:91], v[28:31], a[196:199], v[76:91]
    ds_read_b128 a[200:203], v22 offset:1024
    ds_read_b128 a[204:207], v22 offset:5120
    s_waitcnt lgkmcnt(6)
    v_mfma_f32_32x32x16_bf16 v[92:107], a[192:195], v[32:35], v[92:107]
    ds_read_b64_tr_b16 v[28:29], v16 offset:8192
    ds_read_b64_tr_b16 v[30:31], v16 offset:9216
    buffer_load_dwordx4 v3, s[36:39], s72 offen offset:1024 lds
    v_mfma_f32_32x32x16_bf16 v[108:123], a[196:199], v[32:35], v[108:123]
    s_waitcnt lgkmcnt(2)
    v_mfma_f32_32x32x16_bf16 v[60:75], v[36:39], a[200:203], v[60:75]
    ds_read_b64_tr_b16 v[32:33], v17 offset:8192
    ds_read_b64_tr_b16 v[34:35], v17 offset:9216
    buffer_load_dwordx4 v4, s[36:39], s72 offen offset:2048 lds
    v_mfma_f32_32x32x16_bf16 v[76:91], v[36:39], a[204:207], v[76:91]
    ds_read_b128 a[208:211], v22 offset:2048
    ds_read_b128 a[212:215], v22 offset:6144
    v_mfma_f32_32x32x16_bf16 v[92:107], a[200:203], v[40:43], v[92:107]
    ds_read_b64_tr_b16 v[36:37], v16 offset:12288
    ds_read_b64_tr_b16 v[38:39], v16 offset:13312
    buffer_load_dwordx4 v5, s[36:39], s72 offen offset:3072 lds
    s_add_u32 m0, s88, 98304
    v_mfma_f32_32x32x16_bf16 v[108:123], a[204:207], v[40:43], v[108:123]
    s_waitcnt lgkmcnt(2)
    v_mfma_f32_32x32x16_bf16 v[60:75], v[28:31], a[208:211], v[60:75]
    ds_read_b64_tr_b16 v[40:41], v17 offset:12288
    ds_read_b64_tr_b16 v[42:43], v17 offset:13312
    buffer_load_dwordx4 v10, s[36:39], s3 offen offset:0 lds
    v_mfma_f32_32x32x16_bf16 v[76:91], v[28:31], a[212:215], v[76:91]
    ds_read_b128 a[216:219], v22 offset:3072
    ds_read_b128 a[220:223], v22 offset:7168
    v_mfma_f32_32x32x16_bf16 v[92:107], a[208:211], v[32:35], v[92:107]
    buffer_load_dwordx4 v11, s[36:39], s3 offen offset:1024 lds
    v_mfma_f32_32x32x16_bf16 v[108:123], a[212:215], v[32:35], v[108:123]
    s_waitcnt lgkmcnt(0)
    s_waitcnt vmcnt(6)
    s_barrier
    v_mfma_f32_32x32x16_bf16 v[60:75], v[36:39], a[216:219], v[60:75]
    ds_read_b64_tr_b16 v[28:29], v16 offset:40960
    ds_read_b64_tr_b16 v[30:31], v16 offset:41984
    ds_read_b128 a[224:227], v22 offset:40960
    ds_read_b128 a[228:231], v22 offset:45056
    v_mfma_f32_32x32x16_bf16 v[76:91], v[36:39], a[220:223], v[76:91]
    ds_read_b64_tr_b16 v[32:33], v17 offset:40960
    ds_read_b64_tr_b16 v[34:35], v17 offset:41984
    v_mfma_f32_32x32x16_bf16 v[92:107], a[216:219], v[40:43], v[92:107]
    ds_read_b64_tr_b16 v[36:37], v16 offset:45056
    ds_read_b64_tr_b16 v[38:39], v16 offset:46080
    v_mfma_f32_32x32x16_bf16 v[108:123], a[220:223], v[40:43], v[108:123]
    s_add_u32 s69, s81, 1
    s_and_b32 s69, s69, 7
    s_mul_i32 s72, s69, 229376
    s_add_u32 s3, s72, s73
    s_add_u32 s72, s72, s74
    s_add_u32 m0, s87, 0
    s_waitcnt lgkmcnt(4)
    v_mfma_f32_32x32x16_bf16 v[60:75], v[28:31], a[224:227], v[60:75]
    ds_read_b64_tr_b16 v[40:41], v17 offset:45056
    ds_read_b64_tr_b16 v[42:43], v17 offset:46080
    buffer_load_dwordx4 v2, s[36:39], s72 offen offset:0 lds
    v_mfma_f32_32x32x16_bf16 v[76:91], v[28:31], a[228:231], v[76:91]
    ds_read_b128 a[232:235], v22 offset:41984
    ds_read_b128 a[236:239], v22 offset:46080
    s_waitcnt lgkmcnt(6)
    v_mfma_f32_32x32x16_bf16 v[92:107], a[224:227], v[32:35], v[92:107]
    ds_read_b64_tr_b16 v[28:29], v16 offset:49152
    ds_read_b64_tr_b16 v[30:31], v16 offset:50176
    buffer_load_dwordx4 v3, s[36:39], s72 offen offset:1024 lds
    v_mfma_f32_32x32x16_bf16 v[108:123], a[228:231], v[32:35], v[108:123]
    s_waitcnt lgkmcnt(2)
    v_mfma_f32_32x32x16_bf16 v[60:75], v[36:39], a[232:235], v[60:75]
    ds_read_b64_tr_b16 v[32:33], v17 offset:49152
    ds_read_b64_tr_b16 v[34:35], v17 offset:50176
    buffer_load_dwordx4 v4, s[36:39], s72 offen offset:2048 lds
    v_mfma_f32_32x32x16_bf16 v[76:91], v[36:39], a[236:239], v[76:91]
    ds_read_b128 a[240:243], v22 offset:43008
    ds_read_b128 a[244:247], v22 offset:47104
    v_mfma_f32_32x32x16_bf16 v[92:107], a[232:235], v[40:43], v[92:107]
    ds_read_b64_tr_b16 v[36:37], v16 offset:53248
    ds_read_b64_tr_b16 v[38:39], v16 offset:54272
    buffer_load_dwordx4 v5, s[36:39], s72 offen offset:3072 lds
    s_add_u32 m0, s88, 16384
    v_mfma_f32_32x32x16_bf16 v[108:123], a[236:239], v[40:43], v[108:123]
    s_waitcnt lgkmcnt(2)
    v_mfma_f32_32x32x16_bf16 v[60:75], v[28:31], a[240:243], v[60:75]
    ds_read_b64_tr_b16 v[40:41], v17 offset:53248
    ds_read_b64_tr_b16 v[42:43], v17 offset:54272
    buffer_load_dwordx4 v10, s[36:39], s3 offen offset:0 lds
    v_mfma_f32_32x32x16_bf16 v[76:91], v[28:31], a[244:247], v[76:91]
    ds_read_b128 a[248:251], v22 offset:44032
    ds_read_b128 a[252:255], v22 offset:48128
    v_mfma_f32_32x32x16_bf16 v[92:107], a[240:243], v[32:35], v[92:107]
    buffer_load_dwordx4 v11, s[36:39], s3 offen offset:1024 lds
    v_mfma_f32_32x32x16_bf16 v[108:123], a[244:247], v[32:35], v[108:123]
    s_waitcnt lgkmcnt(0)
    s_waitcnt vmcnt(6)
    s_barrier
    v_mfma_f32_32x32x16_bf16 v[60:75], v[36:39], a[248:251], v[60:75]
    ds_read_b64_tr_b16 v[28:29], v14 offset:0
    ds_read_b64_tr_b16 v[30:31], v14 offset:512
    v_mfma_f32_32x32x16_bf16 v[76:91], v[36:39], a[252:255], v[76:91]
    ds_read_b64_tr_b16 v[32:33], v15 offset:0
    ds_read_b64_tr_b16 v[34:35], v15 offset:512
    v_mfma_f32_32x32x16_bf16 v[92:107], a[248:251], v[40:43], v[92:107]
    ds_read_b64_tr_b16 v[36:37], v21 offset:0
    ds_read_b64_tr_b16 v[38:39], v21 offset:256
    v_mfma_f32_32x32x16_bf16 v[108:123], a[252:255], v[40:43], v[108:123]
    s_nop 2
    v_cvt_pk_bf16_f32 v60, v60, v61
    s_add_u32 m0, s87, 40960
    s_add_u32 s77, s89, 0
    buffer_load_dwordx4 v24, s[44:47], s77 offen lds
    buffer_load_dwordx4 v25, s[44:47], s77 offen offset:1024 lds
    v_cvt_pk_bf16_f32 v61, v62, v63
    v_cvt_pk_bf16_f32 v62, v64, v65
    v_cvt_pk_bf16_f32 v63, v66, v67
    v_cvt_pk_bf16_f32 v64, v68, v69
    v_cvt_pk_bf16_f32 v65, v70, v71
    v_cvt_pk_bf16_f32 v66, v72, v73
    v_cvt_pk_bf16_f32 v67, v74, v75
    v_cvt_pk_bf16_f32 v68, v76, v77
    v_cvt_pk_bf16_f32 v69, v78, v79
    v_cvt_pk_bf16_f32 v70, v80, v81
    v_cvt_pk_bf16_f32 v71, v82, v83
    v_cvt_pk_bf16_f32 v72, v84, v85
    v_cvt_pk_bf16_f32 v73, v86, v87
    v_cvt_pk_bf16_f32 v74, v88, v89
    v_cvt_pk_bf16_f32 v75, v90, v91
    v_mfma_f32_32x32x16_bf16 v[156:171], v[44:47], v[60:63], 0
    v_mfma_f32_32x32x16_bf16 v[172:187], v[48:51], v[64:67], 0
    v_mfma_f32_32x32x16_bf16 v[188:203], v[44:47], v[68:71], 0
    v_mfma_f32_32x32x16_bf16 v[204:219], v[48:51], v[72:75], 0
    v_cvt_pk_bf16_f32 v92, v92, v93
    v_cvt_pk_bf16_f32 v93, v94, v95
    v_cvt_pk_bf16_f32 v94, v96, v97
    v_cvt_pk_bf16_f32 v95, v98, v99
    v_cvt_pk_bf16_f32 v96, v100, v101
    v_cvt_pk_bf16_f32 v97, v102, v103
    v_cvt_pk_bf16_f32 v98, v104, v105
    v_cvt_pk_bf16_f32 v99, v106, v107
    v_cvt_pk_bf16_f32 v100, v108, v109
    v_cvt_pk_bf16_f32 v101, v110, v111
    v_cvt_pk_bf16_f32 v102, v112, v113
    v_cvt_pk_bf16_f32 v103, v114, v115
    v_cvt_pk_bf16_f32 v104, v116, v117
    v_cvt_pk_bf16_f32 v105, v118, v119
    v_cvt_pk_bf16_f32 v106, v120, v121
    s_add_u32 m0, s87, 43008
    s_add_u32 s77, s89, 16384
    buffer_load_dwordx4 v24, s[44:47], s77 offen lds
    buffer_load_dwordx4 v25, s[44:47], s77 offen offset:1024 lds
    v_cvt_pk_bf16_f32 v107, v122, v123
    v_max3_f32 v220, v156, v157, v158
    v_max3_f32 v222, v172, v173, v174
    v_max3_f32 v224, v188, v189, v190
    v_max3_f32 v226, v204, v205, v206
    v_max3_f32 v220, v220, v159, v160
    v_max3_f32 v222, v222, v175, v176
    v_max3_f32 v224, v224, v191, v192
    v_max3_f32 v226, v226, v207, v208
    v_max3_f32 v220, v220, v161, v162
    v_max3_f32 v222, v222, v177, v178
    v_max3_f32 v224, v224, v193, v194
    v_max3_f32 v226, v226, v209, v210
    v_max3_f32 v220, v220, v163, v164
    v_max3_f32 v222, v222, v179, v180
    v_max3_f32 v224, v224, v195, v196
    v_max3_f32 v226, v226, v211, v212
    v_max3_f32 v220, v220, v165, v166
    v_max3_f32 v222, v222, v181, v182
    v_max3_f32 v224, v224, v197, v198
    v_max3_f32 v226, v226, v213, v214
    v_max3_f32 v220, v220, v167, v168
    v_max3_f32 v222, v222, v183, v184
    v_max3_f32 v224, v224, v199, v200
    v_max3_f32 v226, v226, v215, v216
    v_max3_f32 v220, v220, v169, v170
    v_max3_f32 v222, v222, v185, v186
    v_max3_f32 v224, v224, v201, v202
    v_max3_f32 v226, v226, v217, v218
    v_max_f32 v220, v220, v171
    v_max_f32 v222, v222, v187
    v_max_f32 v224, v224, v203
    v_max_f32 v226, v226, v219
    v_mul_f32 v220, s95, v220
    v_mul_f32 v222, s95, v222
    v_mul_f32 v224, s95, v224
    v_mul_f32_e64 v226, s95, v226
    v_pk_fma_f32 v[156:157], v[156:157], s[94:95], v[220:221] op_sel:[0,1,0] op_sel_hi:[1,1,0] neg_lo:[0,0,1] neg_hi:[0,0,1]
    s_add_u32 m0, s27, 81920
    s_add_u32 s77, s89, 32768
    buffer_load_dwordx4 v24, s[44:47], s77 offen lds
    buffer_load_dwordx4 v25, s[44:47], s77 offen offset:1024 lds
    v_pk_fma_f32 v[172:173], v[172:173], s[94:95], v[222:223] op_sel:[0,1,0] op_sel_hi:[1,1,0] neg_lo:[0,0,1] neg_hi:[0,0,1]
    v_pk_fma_f32 v[188:189], v[188:189], s[94:95], v[224:225] op_sel:[0,1,0] op_sel_hi:[1,1,0] neg_lo:[0,0,1] neg_hi:[0,0,1]
    v_pk_fma_f32 v[204:205], v[204:205], s[94:95], v[226:227] op_sel:[0,1,0] op_sel_hi:[1,1,0] neg_lo:[0,0,1] neg_hi:[0,0,1]
    v_pk_fma_f32 v[158:159], v[158:159], s[94:95], v[220:221] op_sel:[0,1,0] op_sel_hi:[1,1,0] neg_lo:[0,0,1] neg_hi:[0,0,1]
    v_pk_fma_f32 v[174:175], v[174:175], s[94:95], v[222:223] op_sel:[0,1,0] op_sel_hi:[1,1,0] neg_lo:[0,0,1] neg_hi:[0,0,1]
    v_pk_fma_f32 v[190:191], v[190:191], s[94:95], v[224:225] op_sel:[0,1,0] op_sel_hi:[1,1,0] neg_lo:[0,0,1] neg_hi:[0,0,1]
    v_pk_fma_f32 v[206:207], v[206:207], s[94:95], v[226:227] op_sel:[0,1,0] op_sel_hi:[1,1,0] neg_lo:[0,0,1] neg_hi:[0,0,1]
    v_pk_fma_f32 v[160:161], v[160:161], s[94:95], v[220:221] op_sel:[0,1,0] op_sel_hi:[1,1,0] neg_lo:[0,0,1] neg_hi:[0,0,1]
    v_pk_fma_f32 v[176:177], v[176:177], s[94:95], v[222:223] op_sel:[0,1,0] op_sel_hi:[1,1,0] neg_lo:[0,0,1] neg_hi:[0,0,1]
    v_pk_fma_f32 v[192:193], v[192:193], s[94:95], v[224:225] op_sel:[0,1,0] op_sel_hi:[1,1,0] neg_lo:[0,0,1] neg_hi:[0,0,1]
    v_pk_fma_f32 v[208:209], v[208:209], s[94:95], v[226:227] op_sel:[0,1,0] op_sel_hi:[1,1,0] neg_lo:[0,0,1] neg_hi:[0,0,1]
    v_pk_fma_f32 v[162:163], v[162:163], s[94:95], v[220:221] op_sel:[0,1,0] op_sel_hi:[1,1,0] neg_lo:[0,0,1] neg_hi:[0,0,1]
    v_pk_fma_f32 v[178:179], v[178:179], s[94:95], v[222:223] op_sel:[0,1,0] op_sel_hi:[1,1,0] neg_lo:[0,0,1] neg_hi:[0,0,1]
    v_pk_fma_f32 v[194:195], v[194:195], s[94:95], v[224:225] op_sel:[0,1,0] op_sel_hi:[1,1,0] neg_lo:[0,0,1] neg_hi:[0,0,1]
    v_pk_fma_f32 v[210:211], v[210:211], s[94:95], v[226:227] op_sel:[0,1,0] op_sel_hi:[1,1,0] neg_lo:[0,0,1] neg_hi:[0,0,1]
    v_pk_fma_f32 v[164:165], v[164:165], s[94:95], v[220:221] op_sel:[0,1,0] op_sel_hi:[1,1,0] neg_lo:[0,0,1] neg_hi:[0,0,1]
    v_pk_fma_f32 v[180:181], v[180:181], s[94:95], v[222:223] op_sel:[0,1,0] op_sel_hi:[1,1,0] neg_lo:[0,0,1] neg_hi:[0,0,1]
    v_pk_fma_f32 v[196:197], v[196:197], s[94:95], v[224:225] op_sel:[0,1,0] op_sel_hi:[1,1,0] neg_lo:[0,0,1] neg_hi:[0,0,1]
    v_pk_fma_f32 v[212:213], v[212:213], s[94:95], v[226:227] op_sel:[0,1,0] op_sel_hi:[1,1,0] neg_lo:[0,0,1] neg_hi:[0,0,1]
    s_add_u32 m0, s27, 83968
    s_add_u32 s77, s89, 49152
    buffer_load_dwordx4 v24, s[44:47], s77 offen lds
    buffer_load_dwordx4 v25, s[44:47], s77 offen offset:1024 lds
    v_pk_fma_f32 v[166:167], v[166:167], s[94:95], v[220:221] op_sel:[0,1,0] op_sel_hi:[1,1,0] neg_lo:[0,0,1] neg_hi:[0,0,1]
    v_pk_fma_f32 v[182:183], v[182:183], s[94:95], v[222:223] op_sel:[0,1,0] op_sel_hi:[1,1,0] neg_lo:[0,0,1] neg_hi:[0,0,1]
    v_pk_fma_f32 v[198:199], v[198:199], s[94:95], v[224:225] op_sel:[0,1,0] op_sel_hi:[1,1,0] neg_lo:[0,0,1] neg_hi:[0,0,1]
    v_pk_fma_f32 v[214:215], v[214:215], s[94:95], v[226:227] op_sel:[0,1,0] op_sel_hi:[1,1,0] neg_lo:[0,0,1] neg_hi:[0,0,1]
    v_pk_fma_f32 v[168:169], v[168:169], s[94:95], v[220:221] op_sel:[0,1,0] op_sel_hi:[1,1,0] neg_lo:[0,0,1] neg_hi:[0,0,1]
    v_pk_fma_f32 v[184:185], v[184:185], s[94:95], v[222:223] op_sel:[0,1,0] op_sel_hi:[1,1,0] neg_lo:[0,0,1] neg_hi:[0,0,1]
    v_pk_fma_f32 v[200:201], v[200:201], s[94:95], v[224:225] op_sel:[0,1,0] op_sel_hi:[1,1,0] neg_lo:[0,0,1] neg_hi:[0,0,1]
    v_pk_fma_f32 v[216:217], v[216:217], s[94:95], v[226:227] op_sel:[0,1,0] op_sel_hi:[1,1,0] neg_lo:[0,0,1] neg_hi:[0,0,1]
    v_pk_fma_f32 v[170:171], v[170:171], s[94:95], v[220:221] op_sel:[0,1,0] op_sel_hi:[1,1,0] neg_lo:[0,0,1] neg_hi:[0,0,1]
    v_pk_fma_f32 v[186:187], v[186:187], s[94:95], v[222:223] op_sel:[0,1,0] op_sel_hi:[1,1,0] neg_lo:[0,0,1] neg_hi:[0,0,1]
    v_pk_fma_f32 v[202:203], v[202:203], s[94:95], v[224:225] op_sel:[0,1,0] op_sel_hi:[1,1,0] neg_lo:[0,0,1] neg_hi:[0,0,1]
    v_pk_fma_f32 v[218:219], v[218:219], s[94:95], v[226:227] op_sel:[0,1,0] op_sel_hi:[1,1,0] neg_lo:[0,0,1] neg_hi:[0,0,1]
    v_exp_f32 v156, v156
    v_exp_f32 v172, v172
    v_exp_f32 v188, v188
    v_exp_f32 v204, v204
    v_exp_f32 v157, v157
    v_exp_f32 v173, v173
    v_exp_f32 v189, v189
    s_add_u32 m0, s27, 0
    s_add_u32 s77, s89, 327680
    buffer_load_dwordx4 v24, s[44:47], s77 offen lds
    buffer_load_dwordx4 v25, s[44:47], s77 offen offset:1024 lds
    v_exp_f32 v205, v205
    v_exp_f32 v158, v158
    v_exp_f32 v174, v174
    v_exp_f32 v190, v190
    v_exp_f32 v206, v206
    v_exp_f32 v159, v159
    v_exp_f32 v175, v175
    v_exp_f32 v191, v191
    v_exp_f32 v207, v207
    v_exp_f32 v160, v160
    v_exp_f32 v176, v176
    v_exp_f32 v192, v192
    v_exp_f32 v208, v208
    v_exp_f32 v161, v161
    v_exp_f32 v177, v177
    v_exp_f32 v193, v193
    v_exp_f32 v209, v209
    v_exp_f32 v162, v162
    v_exp_f32 v178, v178
    s_add_u32 m0, s27, 2048
    s_add_u32 s77, s89, 344064
    buffer_load_dwordx4 v24, s[44:47], s77 offen lds
    buffer_load_dwordx4 v25, s[44:47], s77 offen offset:1024 lds
    v_exp_f32 v194, v194
    v_exp_f32 v210, v210
    v_exp_f32 v163, v163
    v_exp_f32 v179, v179
    v_exp_f32 v195, v195
    v_exp_f32 v211, v211
    v_exp_f32 v164, v164
    v_exp_f32 v180, v180
    v_exp_f32 v196, v196
    v_exp_f32 v212, v212
    v_exp_f32 v165, v165
    v_exp_f32 v181, v181
    v_exp_f32 v197, v197
    v_exp_f32 v213, v213
    v_exp_f32 v166, v166
    v_exp_f32 v182, v182
    v_exp_f32 v198, v198
    v_exp_f32 v214, v214
    v_exp_f32 v167, v167
    s_add_u32 m0, s27, 40960
    s_add_u32 s77, s89, 360448
    buffer_load_dwordx4 v24, s[44:47], s77 offen lds
    buffer_load_dwordx4 v25, s[44:47], s77 offen offset:1024 lds
    v_exp_f32 v183, v183
    v_exp_f32 v199, v199
    v_exp_f32 v215, v215
    v_exp_f32 v168, v168
    v_exp_f32 v184, v184
    v_exp_f32 v200, v200
    v_exp_f32 v216, v216
    v_exp_f32 v169, v169
    v_exp_f32 v185, v185
    v_exp_f32 v201, v201
    v_exp_f32 v217, v217
    v_exp_f32 v170, v170
    v_exp_f32 v186, v186
    v_exp_f32 v202, v202
    v_exp_f32 v218, v218
    v_exp_f32 v171, v171
    v_exp_f32 v187, v187
    v_exp_f32 v203, v203
    v_exp_f32_e64 v219, v219
    s_add_u32 m0, s27, 43008
    s_add_u32 s77, s89, 376832
    buffer_load_dwordx4 v24, s[44:47], s77 offen lds
    buffer_load_dwordx4 v25, s[44:47], s77 offen offset:1024 lds
    v_pk_add_f32 v[220:221], v[156:157], v[158:159]
    v_pk_add_f32 v[222:223], v[172:173], v[174:175]
    v_pk_add_f32 v[224:225], v[188:189], v[190:191]
    v_pk_add_f32 v[226:227], v[204:205], v[206:207]
    v_pk_add_f32 v[220:221], v[220:221], v[160:161]
    v_pk_add_f32 v[222:223], v[222:223], v[176:177]
    v_pk_add_f32 v[224:225], v[224:225], v[192:193]
    v_pk_add_f32 v[226:227], v[226:227], v[208:209]
    v_pk_add_f32 v[220:221], v[220:221], v[162:163]
    v_pk_add_f32 v[222:223], v[222:223], v[178:179]
    v_pk_add_f32 v[224:225], v[224:225], v[194:195]
    v_pk_add_f32 v[226:227], v[226:227], v[210:211]
    v_pk_add_f32 v[220:221], v[220:221], v[164:165]
    v_pk_add_f32 v[222:223], v[222:223], v[180:181]
    v_pk_add_f32 v[224:225], v[224:225], v[196:197]
    v_pk_add_f32 v[226:227], v[226:227], v[212:213]
    v_pk_add_f32 v[220:221], v[220:221], v[166:167]
    v_pk_add_f32 v[222:223], v[222:223], v[182:183]
    v_pk_add_f32 v[224:225], v[224:225], v[198:199]
    s_add_u32 m0, s88, 155648
    s_add_u32 s77, s89, 65536
    buffer_load_dwordx4 v24, s[44:47], s77 offen lds
    buffer_load_dwordx4 v25, s[44:47], s77 offen offset:1024 lds
    v_pk_add_f32 v[226:227], v[226:227], v[214:215]
    v_pk_add_f32 v[220:221], v[220:221], v[168:169]
    v_pk_add_f32 v[222:223], v[222:223], v[184:185]
    v_pk_add_f32 v[224:225], v[224:225], v[200:201]
    v_pk_add_f32 v[226:227], v[226:227], v[216:217]
    v_pk_add_f32 v[220:221], v[220:221], v[170:171]
    v_pk_add_f32 v[222:223], v[222:223], v[186:187]
    v_pk_add_f32 v[224:225], v[224:225], v[202:203]
    v_pk_add_f32 v[226:227], v[226:227], v[218:219]
    v_add_f32 v220, v220, v221
    v_add_f32 v222, v222, v223
    v_add_f32 v224, v224, v225
    v_add_f32 v226, v226, v227
    v_rcp_f32 v220, v220
    v_rcp_f32 v222, v222
    v_rcp_f32 v224, v224
    v_rcp_f32 v226, v226
    v_pk_mul_f32 v[156:157], v[156:157], v[220:221] op_sel_hi:[1,0]
    v_pk_mul_f32 v[158:159], v[158:159], v[220:221] op_sel_hi:[1,0]
    v_pk_mul_f32 v[160:161], v[160:161], v[220:221] op_sel_hi:[1,0]
    v_pk_mul_f32 v[162:163], v[162:163], v[220:221] op_sel_hi:[1,0]
    v_pk_mul_f32 v[164:165], v[164:165], v[220:221] op_sel_hi:[1,0]
    v_pk_mul_f32 v[166:167], v[166:167], v[220:221] op_sel_hi:[1,0]
    v_pk_mul_f32 v[168:169], v[168:169], v[220:221] op_sel_hi:[1,0]
    v_pk_mul_f32 v[170:171], v[170:171], v[220:221] op_sel_hi:[1,0]
    v_cvt_pk_bf16_f32 v156, v156, v157
    v_cvt_pk_bf16_f32 v157, v158, v159
    v_cvt_pk_bf16_f32 v158, v160, v161
    v_cvt_pk_bf16_f32 v159, v162, v163
    v_cvt_pk_bf16_f32 v160, v164, v165
    v_cvt_pk_bf16_f32 v161, v166, v167
    v_cvt_pk_bf16_f32 v162, v168, v169
    v_cvt_pk_bf16_f32 v163, v170, v171
    v_pk_mul_f32 v[172:173], v[172:173], v[222:223] op_sel_hi:[1,0]
    v_pk_mul_f32 v[174:175], v[174:175], v[222:223] op_sel_hi:[1,0]
    v_pk_mul_f32 v[176:177], v[176:177], v[222:223] op_sel_hi:[1,0]
    v_pk_mul_f32 v[178:179], v[178:179], v[222:223] op_sel_hi:[1,0]
    v_pk_mul_f32 v[180:181], v[180:181], v[222:223] op_sel_hi:[1,0]
    v_pk_mul_f32 v[182:183], v[182:183], v[222:223] op_sel_hi:[1,0]
    v_pk_mul_f32 v[184:185], v[184:185], v[222:223] op_sel_hi:[1,0]
    v_pk_mul_f32 v[186:187], v[186:187], v[222:223] op_sel_hi:[1,0]
    v_cvt_pk_bf16_f32 v172, v172, v173
    v_cvt_pk_bf16_f32 v173, v174, v175
    v_cvt_pk_bf16_f32 v174, v176, v177
    v_cvt_pk_bf16_f32 v175, v178, v179
    v_cvt_pk_bf16_f32 v176, v180, v181
    v_cvt_pk_bf16_f32 v177, v182, v183
    v_cvt_pk_bf16_f32 v178, v184, v185
    v_cvt_pk_bf16_f32 v179, v186, v187
    v_pk_mul_f32 v[188:189], v[188:189], v[224:225] op_sel_hi:[1,0]
    v_pk_mul_f32 v[190:191], v[190:191], v[224:225] op_sel_hi:[1,0]
    v_pk_mul_f32 v[192:193], v[192:193], v[224:225] op_sel_hi:[1,0]
    v_pk_mul_f32 v[194:195], v[194:195], v[224:225] op_sel_hi:[1,0]
    v_pk_mul_f32 v[196:197], v[196:197], v[224:225] op_sel_hi:[1,0]
    v_pk_mul_f32 v[198:199], v[198:199], v[224:225] op_sel_hi:[1,0]
    v_pk_mul_f32 v[200:201], v[200:201], v[224:225] op_sel_hi:[1,0]
    v_pk_mul_f32 v[202:203], v[202:203], v[224:225] op_sel_hi:[1,0]
    v_cvt_pk_bf16_f32 v188, v188, v189
    v_cvt_pk_bf16_f32 v189, v190, v191
    v_cvt_pk_bf16_f32 v190, v192, v193
    v_cvt_pk_bf16_f32 v191, v194, v195
    v_cvt_pk_bf16_f32 v192, v196, v197
    v_cvt_pk_bf16_f32 v193, v198, v199
    v_cvt_pk_bf16_f32 v194, v200, v201
    v_cvt_pk_bf16_f32 v195, v202, v203
    v_pk_mul_f32 v[204:205], v[204:205], v[226:227] op_sel_hi:[1,0]
    v_pk_mul_f32 v[206:207], v[206:207], v[226:227] op_sel_hi:[1,0]
    v_pk_mul_f32 v[208:209], v[208:209], v[226:227] op_sel_hi:[1,0]
    v_pk_mul_f32 v[210:211], v[210:211], v[226:227] op_sel_hi:[1,0]
    v_pk_mul_f32 v[212:213], v[212:213], v[226:227] op_sel_hi:[1,0]
    v_pk_mul_f32 v[214:215], v[214:215], v[226:227] op_sel_hi:[1,0]
    v_pk_mul_f32 v[216:217], v[216:217], v[226:227] op_sel_hi:[1,0]
    v_pk_mul_f32 v[218:219], v[218:219], v[226:227] op_sel_hi:[1,0]
    v_cvt_pk_bf16_f32 v204, v204, v205
    v_cvt_pk_bf16_f32 v205, v206, v207
    v_cvt_pk_bf16_f32 v206, v208, v209
    v_cvt_pk_bf16_f32 v207, v210, v211
    v_cvt_pk_bf16_f32 v208, v212, v213
    v_cvt_pk_bf16_f32 v209, v214, v215
    v_cvt_pk_bf16_f32 v210, v216, v217
    v_cvt_pk_bf16_f32 v211, v218, v219
    ds_write_b64 v233, v[172:173] offset:2048
    ds_write_b64 v234, v[174:175] offset:2048
    ds_write_b64 v235, v[176:177] offset:2048
    ds_write_b64 v236, v[178:179] offset:2048
    ds_write_b64 v233, v[204:205] offset:6144
    ds_write_b64 v234, v[206:207] offset:6144
    ds_write_b64 v235, v[208:209] offset:6144
    ds_write_b64 v236, v[210:211] offset:6144
    ds_write_b64 v233, v[156:157] offset:0
    ds_write_b64 v234, v[158:159] offset:0
    ds_write_b64 v235, v[160:161] offset:0
    ds_write_b64 v236, v[162:163] offset:0
    ds_write_b64 v233, v[188:189] offset:4096
    ds_write_b64 v234, v[190:191] offset:4096
    ds_write_b64 v235, v[192:193] offset:4096
    ds_write_b64 v236, v[194:195] offset:4096
    v_cndmask_b32 v180, v92, v239, s[82:83]
    v_cndmask_b32 v181, v93, v239, s[82:83]
    v_cndmask_b32 v182, v94, v239, s[82:83]
    v_cndmask_b32 v183, v95, v239, s[82:83]
    v_cndmask_b32 v184, v96, v239, s[82:83]
    v_cndmask_b32 v185, v97, v239, s[82:83]
    v_cndmask_b32 v186, v98, v239, s[82:83]
    v_cndmask_b32 v187, v99, v239, s[82:83]
    s_waitcnt lgkmcnt(12)
    ds_read_b64_tr_b16 v[172:173], v237 offset:2048
    ds_read_b64_tr_b16 v[174:175], v238 offset:2048
    ds_read_b64_tr_b16 v[176:177], v237 offset:3072
    ds_read_b64_tr_b16 v[178:179], v238 offset:3072
    v_cndmask_b32 v212, v100, v239, s[82:83]
    v_cndmask_b32 v213, v101, v239, s[82:83]
    v_cndmask_b32 v214, v102, v239, s[82:83]
    v_cndmask_b32 v215, v103, v239, s[82:83]
    v_cndmask_b32 v216, v104, v239, s[82:83]
    v_cndmask_b32 v217, v105, v239, s[82:83]
    v_cndmask_b32 v218, v106, v239, s[82:83]
    v_cndmask_b32 v219, v107, v239, s[82:83]
    s_waitcnt lgkmcnt(12)
    ds_read_b64_tr_b16 v[204:205], v237 offset:6144
    ds_read_b64_tr_b16 v[206:207], v238 offset:6144
    ds_read_b64_tr_b16 v[208:209], v237 offset:7168
    ds_read_b64_tr_b16 v[210:211], v238 offset:7168
    v_cndmask_b32 v164, v239, v92, s[82:83]
    v_cndmask_b32 v165, v239, v93, s[82:83]
    v_cndmask_b32 v166, v239, v94, s[82:83]
    v_cndmask_b32 v167, v239, v95, s[82:83]
    v_cndmask_b32 v168, v239, v96, s[82:83]
    v_cndmask_b32 v169, v239, v97, s[82:83]
    v_cndmask_b32 v170, v239, v98, s[82:83]
    v_cndmask_b32 v171, v239, v99, s[82:83]
    s_waitcnt lgkmcnt(12)
    ds_read_b64_tr_b16 v[156:157], v237 offset:0
    ds_read_b64_tr_b16 v[158:159], v238 offset:0
    ds_read_b64_tr_b16 v[160:161], v237 offset:1024
    ds_read_b64_tr_b16 v[162:163], v238 offset:1024
    v_cndmask_b32 v196, v239, v100, s[82:83]
    v_cndmask_b32 v197, v239, v101, s[82:83]
    v_cndmask_b32 v198, v239, v102, s[82:83]
    v_cndmask_b32 v199, v239, v103, s[82:83]
    v_cndmask_b32 v200, v239, v104, s[82:83]
    v_cndmask_b32 v201, v239, v105, s[82:83]
    v_cndmask_b32 v202, v239, v106, s[82:83]
    v_cndmask_b32 v203, v239, v107, s[82:83]
    s_waitcnt lgkmcnt(12)
    ds_read_b64_tr_b16 v[188:189], v237 offset:4096
    ds_read_b64_tr_b16 v[190:191], v238 offset:4096
    ds_read_b64_tr_b16 v[192:193], v237 offset:5120
    ds_read_b64_tr_b16 v[194:195], v238 offset:5120
    s_waitcnt lgkmcnt(12)
    v_mfma_f32_32x32x16_bf16 v[108:123], v[172:175], v[180:183], 0
    v_mfma_f32_32x32x16_bf16 v[108:123], v[176:179], v[184:187], v[108:123]
    s_waitcnt lgkmcnt(8)
    v_mfma_f32_32x32x16_bf16 v[108:123], v[204:207], v[212:215], v[108:123]
    v_mfma_f32_32x32x16_bf16 v[108:123], v[208:211], v[216:219], v[108:123]
    s_waitcnt lgkmcnt(4)
    v_mfma_f32_32x32x16_bf16 v[76:91], v[156:159], v[164:167], 0
    v_mfma_f32_32x32x16_bf16 v[76:91], v[160:163], v[168:171], v[76:91]
    s_waitcnt lgkmcnt(0)
    v_mfma_f32_32x32x16_bf16 v[76:91], v[188:191], v[196:199], v[76:91]
    v_mfma_f32_32x32x16_bf16 v[76:91], v[192:195], v[200:203], v[76:91]
    s_nop 5
    ds_write_b128 v240, v[108:111] offset:0
    ds_write_b128 v240, v[112:115] offset:1024
    ds_write_b128 v240, v[116:119] offset:2048
    ds_write_b128 v240, v[120:123] offset:3072
    s_waitcnt lgkmcnt(0)
    s_barrier
    ds_read_b128 v[108:111], v241 offset:0
    ds_read_b128 v[112:115], v241 offset:1024
    ds_read_b128 v[116:119], v241 offset:2048
    ds_read_b128 v[120:123], v241 offset:3072
    s_waitcnt lgkmcnt(3)
    v_pk_add_f32 v[76:77], v[76:77], v[108:109]
    v_pk_add_f32 v[78:79], v[78:79], v[110:111]
    buffer_store_dwordx4 v[76:79], v242, s[40:43], s0 offen offset:0 sc1
    s_waitcnt lgkmcnt(2)
    v_pk_add_f32 v[80:81], v[80:81], v[112:113]
    v_pk_add_f32 v[82:83], v[82:83], v[114:115]
    buffer_store_dwordx4 v[80:83], v242, s[40:43], s0 offen offset:512 sc1
    s_waitcnt lgkmcnt(1)
    v_pk_add_f32 v[84:85], v[84:85], v[116:117]
    v_pk_add_f32 v[86:87], v[86:87], v[118:119]
    buffer_store_dwordx4 v[84:87], v242, s[40:43], s80 offen offset:0 sc1
    s_waitcnt lgkmcnt(0)
    v_pk_add_f32 v[88:89], v[88:89], v[120:121]
    v_pk_add_f32 v[90:91], v[90:91], v[122:123]
    buffer_store_dwordx4 v[88:91], v242, s[40:43], s80 offen offset:512 sc1
    s_waitcnt vmcnt(20)
    ds_read_b64_tr_b16 v[60:61], v56 offset:0
    ds_read_b64_tr_b16 v[62:63], v56 offset:1024
    ds_read_b64_tr_b16 v[64:65], v57 offset:0
    ds_read_b64_tr_b16 v[66:67], v57 offset:1024
    s_waitcnt vmcnt(18)
    ds_read_b64_tr_b16 v[68:69], v56 offset:2048
    ds_read_b64_tr_b16 v[70:71], v56 offset:3072
    ds_read_b64_tr_b16 v[72:73], v57 offset:2048
    ds_read_b64_tr_b16 v[74:75], v57 offset:3072
    s_add_u32 s69, s81, 2
    s_and_b32 s69, s69, 7
    s_mul_i32 s72, s69, 229376
    s_add_u32 s3, s72, s73
    s_add_u32 s72, s72, s74
    s_add_u32 m0, s87, 40960
    v_mfma_f32_32x32x16_bf16 v[156:171], v[28:31], a[0:3], 0
    ds_read_b64_tr_b16 v[40:41], v14 offset:2048
    ds_read_b64_tr_b16 v[42:43], v14 offset:2560
    v_mfma_f32_32x32x16_bf16 v[172:187], v[28:31], a[4:7], 0
    v_mfma_f32_32x32x16_bf16 v[188:203], v[32:35], a[0:3], 0
    ds_read_b64_tr_b16 v[28:29], v15 offset:2048
    ds_read_b64_tr_b16 v[30:31], v15 offset:2560
    s_waitcnt lgkmcnt(4)
    buffer_load_dwordx4 v2, s[36:39], s72 offen offset:0 lds
    v_mfma_f32_32x32x16_bf16 v[204:219], v[32:35], a[4:7], 0
    v_mfma_f32_32x32x16_bf16 v[124:139], v[36:39], a[0:3], 0
    ds_read_b64_tr_b16 v[32:33], v21 offset:1024
    ds_read_b64_tr_b16 v[34:35], v21 offset:1280
    v_mfma_f32_32x32x16_bf16 v[140:155], v[36:39], a[4:7], 0
    buffer_load_dwordx4 v3, s[36:39], s72 offen offset:1024 lds
    s_waitcnt lgkmcnt(4)
    v_mfma_f32_32x32x16_bf16 v[156:171], v[40:43], a[8:11], v[156:171]
    ds_read_b64_tr_b16 v[36:37], v14 offset:4096
    ds_read_b64_tr_b16 v[38:39], v14 offset:4608
    v_mfma_f32_32x32x16_bf16 v[172:187], v[40:43], a[12:15], v[172:187]
    s_waitcnt lgkmcnt(4)
    v_mfma_f32_32x32x16_bf16 v[188:203], v[28:31], a[8:11], v[188:203]
    ds_read_b64_tr_b16 v[40:41], v15 offset:4096
    ds_read_b64_tr_b16 v[42:43], v15 offset:4608
    buffer_load_dwordx4 v4, s[36:39], s72 offen offset:2048 lds
    v_mfma_f32_32x32x16_bf16 v[204:219], v[28:31], a[12:15], v[204:219]
    s_waitcnt lgkmcnt(4)
    v_mfma_f32_32x32x16_bf16 v[124:139], v[32:35], a[8:11], v[124:139]
    ds_read_b64_tr_b16 v[28:29], v21 offset:2048
    ds_read_b64_tr_b16 v[30:31], v21 offset:2304
    v_mfma_f32_32x32x16_bf16 v[140:155], v[32:35], a[12:15], v[140:155]
    buffer_load_dwordx4 v5, s[36:39], s72 offen offset:3072 lds
    s_add_u32 m0, s88, 57344
    s_waitcnt lgkmcnt(4)
    v_mfma_f32_32x32x16_bf16 v[156:171], v[36:39], a[16:19], v[156:171]
    ds_read_b64_tr_b16 v[32:33], v14 offset:6144
    ds_read_b64_tr_b16 v[34:35], v14 offset:6656
    v_mfma_f32_32x32x16_bf16 v[172:187], v[36:39], a[20:23], v[172:187]
    s_waitcnt lgkmcnt(4)
    v_mfma_f32_32x32x16_bf16 v[188:203], v[40:43], a[16:19], v[188:203]
    ds_read_b64_tr_b16 v[36:37], v15 offset:6144
    ds_read_b64_tr_b16 v[38:39], v15 offset:6656
    buffer_load_dwordx4 v10, s[36:39], s3 offen offset:0 lds
    v_mfma_f32_32x32x16_bf16 v[204:219], v[40:43], a[20:23], v[204:219]
    s_waitcnt lgkmcnt(4)
    v_mfma_f32_32x32x16_bf16 v[124:139], v[28:31], a[16:19], v[124:139]
    ds_read_b64_tr_b16 v[40:41], v21 offset:3072
    ds_read_b64_tr_b16 v[42:43], v21 offset:3328
    v_mfma_f32_32x32x16_bf16 v[140:155], v[28:31], a[20:23], v[140:155]
    buffer_load_dwordx4 v11, s[36:39], s3 offen offset:1024 lds
    s_waitcnt lgkmcnt(4)
    v_mfma_f32_32x32x16_bf16 v[156:171], v[32:35], a[24:27], v[156:171]
    v_mfma_f32_32x32x16_bf16 v[172:187], v[32:35], a[28:31], v[172:187]
    s_waitcnt lgkmcnt(0)
    s_waitcnt vmcnt(6)
    s_barrier
    s_cmp_lg_u32 s60, 0
    s_cbranch_scc1 L_fl_4
    s_lshl_b32 s79, s63, 4
    s_add_u32 s79, s79, s61
    s_lshl_b32 s79, s79, 7
    v_mov_b32 v254, s68
    s_add_u32 s79, s79, 393216
    s_mov_b64 exec, 1
    buffer_store_dword v254, off, s[40:43], s79 sc1
    s_mov_b64 exec, -1
L_fl_4:
    v_mfma_f32_32x32x16_bf16 v[188:203], v[36:39], a[24:27], v[188:203]
    ds_read_b64_tr_b16 v[28:29], v12 offset:0
    ds_read_b64_tr_b16 v[30:31], v12 offset:512
    v_mfma_f32_32x32x16_bf16 v[204:219], v[36:39], a[28:31], v[204:219]
    ds_read_b64_tr_b16 v[32:33], v13 offset:0
    ds_read_b64_tr_b16 v[34:35], v13 offset:512
    v_mfma_f32_32x32x16_bf16 v[124:139], v[40:43], a[24:27], v[124:139]
    ds_read_b64_tr_b16 v[36:37], v18 offset:0
    ds_read_b64_tr_b16 v[38:39], v18 offset:256
    v_mfma_f32_32x32x16_bf16 v[140:155], v[40:43], a[28:31], v[140:155]
    s_add_u32 s69, s81, 3
    s_and_b32 s69, s69, 7
    s_mul_i32 s72, s69, 229376
    s_add_u32 s3, s72, s73
    s_add_u32 s72, s72, s74
    s_add_u32 m0, s87, 81920
    s_waitcnt lgkmcnt(4)
    v_mfma_f32_32x32x16_bf16 v[156:171], v[28:31], a[32:35], v[156:171]
    ds_read_b64_tr_b16 v[40:41], v12 offset:2048
    ds_read_b64_tr_b16 v[42:43], v12 offset:2560
    buffer_load_dwordx4 v2, s[36:39], s72 offen offset:0 lds
    v_mfma_f32_32x32x16_bf16 v[172:187], v[28:31], a[36:39], v[172:187]
    ds_read_b64_tr_b16 v[92:93], v54 offset:0
    ds_read_b64_tr_b16 v[94:95], v54 offset:1024
    buffer_load_dwordx4 v3, s[36:39], s72 offen offset:1024 lds
    s_waitcnt lgkmcnt(6)
    v_mfma_f32_32x32x16_bf16 v[188:203], v[32:35], a[32:35], v[188:203]
    ds_read_b64_tr_b16 v[28:29], v13 offset:2048
    ds_read_b64_tr_b16 v[30:31], v13 offset:2560
    buffer_load_dwordx4 v4, s[36:39], s72 offen offset:2048 lds
    v_mfma_f32_32x32x16_bf16 v[204:219], v[32:35], a[36:39], v[204:219]
    ds_read_b64_tr_b16 v[96:97], v55 offset:0
    ds_read_b64_tr_b16 v[98:99], v55 offset:1024
    s_waitcnt lgkmcnt(8)
    v_mfma_f32_32x32x16_bf16 v[124:139], v[36:39], a[32:35], v[124:139]
    ds_read_b64_tr_b16 v[32:33], v18 offset:1024
    ds_read_b64_tr_b16 v[34:35], v18 offset:1280
    buffer_load_dwordx4 v5, s[36:39], s72 offen offset:3072 lds
    s_add_u32 m0, s88, 98304
    v_mfma_f32_32x32x16_bf16 v[140:155], v[36:39], a[36:39], v[140:155]
    ds_read_b64_tr_b16 v[100:101], v54 offset:2048
    ds_read_b64_tr_b16 v[102:103], v54 offset:3072
    buffer_load_dwordx4 v10, s[36:39], s3 offen offset:0 lds
    s_waitcnt lgkmcnt(10)
    v_mfma_f32_32x32x16_bf16 v[156:171], v[40:43], a[40:43], v[156:171]
    ds_read_b64_tr_b16 v[36:37], v12 offset:4096
    ds_read_b64_tr_b16 v[38:39], v12 offset:4608
    v_mfma_f32_32x32x16_bf16 v[172:187], v[40:43], a[44:47], v[172:187]
    ds_read_b64_tr_b16 v[104:105], v55 offset:2048
    ds_read_b64_tr_b16 v[106:107], v55 offset:3072
    buffer_load_dwordx4 v11, s[36:39], s3 offen offset:1024 lds
    s_waitcnt lgkmcnt(10)
    v_mfma_f32_32x32x16_bf16 v[188:203], v[28:31], a[40:43], v[188:203]
    ds_read_b64_tr_b16 v[40:41], v13 offset:4096
    ds_read_b64_tr_b16 v[42:43], v13 offset:4608
    s_add_u32 m0, s93, 0
    s_add_u32 s77, s89, 81920
    buffer_load_dwordx4 v24, s[44:47], s77 offen lds
    buffer_load_dwordx4 v25, s[44:47], s77 offen offset:1024 lds
    v_mfma_f32_32x32x16_bf16 v[204:219], v[28:31], a[44:47], v[204:219]
    ds_read_b64_tr_b16 v[108:109], v52 offset:0
    ds_read_b64_tr_b16 v[110:111], v52 offset:1024
    s_waitcnt lgkmcnt(10)
    v_mfma_f32_32x32x16_bf16 v[124:139], v[32:35], a[40:43], v[124:139]
    ds_read_b64_tr_b16 v[28:29], v18 offset:2048
    ds_read_b64_tr_b16 v[30:31], v18 offset:2304
    v_mfma_f32_32x32x16_bf16 v[140:155], v[32:35], a[44:47], v[140:155]
    ds_read_b64_tr_b16 v[112:113], v53 offset:0
    ds_read_b64_tr_b16 v[114:115], v53 offset:1024
    s_add_u32 m0, s93, 2048
    s_add_u32 s77, s89, 98304
    buffer_load_dwordx4 v24, s[44:47], s77 offen lds
    buffer_load_dwordx4 v25, s[44:47], s77 offen offset:1024 lds
    s_waitcnt lgkmcnt(10)
    v_mfma_f32_32x32x16_bf16 v[156:171], v[36:39], a[48:51], v[156:171]
    ds_read_b64_tr_b16 v[32:33], v12 offset:6144
    ds_read_b64_tr_b16 v[34:35], v12 offset:6656
    v_mfma_f32_32x32x16_bf16 v[172:187], v[36:39], a[52:55], v[172:187]
    s_waitcnt lgkmcnt(8)
    v_mfma_f32_32x32x16_bf16 v[188:203], v[40:43], a[48:51], v[188:203]
    ds_read_b64_tr_b16 v[36:37], v13 offset:6144
    ds_read_b64_tr_b16 v[38:39], v13 offset:6656
    s_add_u32 m0, s93, 4096
    s_add_u32 s77, s89, 114688
    buffer_load_dwordx4 v24, s[44:47], s77 offen lds
    buffer_load_dwordx4 v25, s[44:47], s77 offen offset:1024 lds
    v_mfma_f32_32x32x16_bf16 v[204:219], v[40:43], a[52:55], v[204:219]
    s_waitcnt lgkmcnt(6)
    v_mfma_f32_32x32x16_bf16 v[124:139], v[28:31], a[48:51], v[124:139]
    ds_read_b64_tr_b16 v[40:41], v18 offset:3072
    ds_read_b64_tr_b16 v[42:43], v18 offset:3328
    v_mfma_f32_32x32x16_bf16 v[140:155], v[28:31], a[52:55], v[140:155]
    s_add_u32 m0, s93, 6144
    s_add_u32 s77, s89, 393216
    buffer_load_dwordx4 v24, s[44:47], s77 offen lds
    buffer_load_dwordx4 v25, s[44:47], s77 offen offset:1024 lds
    s_waitcnt lgkmcnt(4)
    v_mfma_f32_32x32x16_bf16 v[156:171], v[32:35], a[56:59], v[156:171]
    v_mfma_f32_32x32x16_bf16 v[172:187], v[32:35], a[60:63], v[172:187]
    s_waitcnt lgkmcnt(0)
    s_waitcnt vmcnt(14)
    s_barrier
    v_mfma_f32_32x32x16_bf16 v[188:203], v[36:39], a[56:59], v[188:203]
    ds_read_b64_tr_b16 v[28:29], v12 offset:40960
    ds_read_b64_tr_b16 v[30:31], v12 offset:41472
    v_mfma_f32_32x32x16_bf16 v[204:219], v[36:39], a[60:63], v[204:219]
    ds_read_b64_tr_b16 v[32:33], v13 offset:40960
    ds_read_b64_tr_b16 v[34:35], v13 offset:41472
    v_mfma_f32_32x32x16_bf16 v[124:139], v[40:43], a[56:59], v[124:139]
    ds_read_b64_tr_b16 v[36:37], v18 offset:40960
    ds_read_b64_tr_b16 v[38:39], v18 offset:41216
    v_mfma_f32_32x32x16_bf16 v[140:155], v[40:43], a[60:63], v[140:155]
    s_add_u32 s69, s81, 4
    s_and_b32 s69, s69, 7
    s_mul_i32 s72, s69, 229376
    s_add_u32 s3, s72, s73
    s_add_u32 s72, s72, s74
    s_add_u32 m0, s87, 0
    s_waitcnt lgkmcnt(4)
    v_mfma_f32_32x32x16_bf16 v[156:171], v[28:31], a[64:67], v[156:171]
    ds_read_b64_tr_b16 v[40:41], v12 offset:43008
    ds_read_b64_tr_b16 v[42:43], v12 offset:43520
    buffer_load_dwordx4 v2, s[36:39], s72 offen offset:0 lds
    v_mfma_f32_32x32x16_bf16 v[172:187], v[28:31], a[68:71], v[172:187]
    ds_read_b64_tr_b16 v[116:117], v52 offset:2048
    ds_read_b64_tr_b16 v[118:119], v52 offset:3072
    buffer_load_dwordx4 v3, s[36:39], s72 offen offset:1024 lds
    s_waitcnt lgkmcnt(6)
    v_mfma_f32_32x32x16_bf16 v[188:203], v[32:35], a[64:67], v[188:203]
    ds_read_b64_tr_b16 v[28:29], v13 offset:43008
    ds_read_b64_tr_b16 v[30:31], v13 offset:43520
    v_mfma_f32_32x32x16_bf16 v[204:219], v[32:35], a[68:71], v[204:219]
    ds_read_b64_tr_b16 v[120:121], v53 offset:2048
    ds_read_b64_tr_b16 v[122:123], v53 offset:3072
    buffer_load_dwordx4 v4, s[36:39], s72 offen offset:2048 lds
    s_waitcnt lgkmcnt(8)
    v_mfma_f32_32x32x16_bf16 v[124:139], v[36:39], a[64:67], v[124:139]
    ds_read_b64_tr_b16 v[32:33], v18 offset:41984
    ds_read_b64_tr_b16 v[34:35], v18 offset:42240
    v_mfma_f32_32x32x16_bf16 v[140:155], v[36:39], a[68:71], v[140:155]
    ds_read_b64_tr_b16 a[0:1], v52 offset:40960
    ds_read_b64_tr_b16 a[2:3], v52 offset:41984
    buffer_load_dwordx4 v5, s[36:39], s72 offen offset:3072 lds
    s_add_u32 m0, s88, 16384
    s_waitcnt lgkmcnt(10)
    v_mfma_f32_32x32x16_bf16 v[156:171], v[40:43], a[72:75], v[156:171]
    ds_read_b64_tr_b16 v[36:37], v12 offset:45056
    ds_read_b64_tr_b16 v[38:39], v12 offset:45568
    buffer_load_dwordx4 v10, s[36:39], s3 offen offset:0 lds
    v_mfma_f32_32x32x16_bf16 v[172:187], v[40:43], a[76:79], v[172:187]
    ds_read_b64_tr_b16 a[4:5], v53 offset:40960
    ds_read_b64_tr_b16 a[6:7], v53 offset:41984
    s_waitcnt lgkmcnt(10)
    v_mfma_f32_32x32x16_bf16 v[188:203], v[28:31], a[72:75], v[188:203]
    ds_read_b64_tr_b16 v[40:41], v13 offset:45056
    ds_read_b64_tr_b16 v[42:43], v13 offset:45568
    buffer_load_dwordx4 v11, s[36:39], s3 offen offset:1024 lds
    v_mfma_f32_32x32x16_bf16 v[204:219], v[28:31], a[76:79], v[204:219]
    ds_read_b64_tr_b16 a[8:9], v52 offset:43008
    ds_read_b64_tr_b16 a[10:11], v52 offset:44032
    s_waitcnt lgkmcnt(10)
    v_mfma_f32_32x32x16_bf16 v[124:139], v[32:35], a[72:75], v[124:139]
    ds_read_b64_tr_b16 v[28:29], v18 offset:43008
    ds_read_b64_tr_b16 v[30:31], v18 offset:43264
    s_add_u32 m0, s27, 81920
    s_add_u32 s77, s89, 409600
    buffer_load_dwordx4 v24, s[44:47], s77 offen lds
    buffer_load_dwordx4 v25, s[44:47], s77 offen offset:1024 lds
    v_mfma_f32_32x32x16_bf16 v[140:155], v[32:35], a[76:79], v[140:155]
    ds_read_b64_tr_b16 a[12:13], v53 offset:43008
    ds_read_b64_tr_b16 a[14:15], v53 offset:44032
    s_waitcnt lgkmcnt(10)
    v_mfma_f32_32x32x16_bf16 v[156:171], v[36:39], a[80:83], v[156:171]
    ds_read_b64_tr_b16 v[32:33], v12 offset:47104
    ds_read_b64_tr_b16 v[34:35], v12 offset:47616
    v_mfma_f32_32x32x16_bf16 v[172:187], v[36:39], a[84:87], v[172:187]
    s_add_u32 m0, s27, 83968
    s_add_u32 s77, s89, 425984
    buffer_load_dwordx4 v24, s[44:47], s77 offen lds
    buffer_load_dwordx4 v25, s[44:47], s77 offen offset:1024 lds
    s_waitcnt lgkmcnt(8)
    v_mfma_f32_32x32x16_bf16 v[188:203], v[40:43], a[80:83], v[188:203]
    ds_read_b64_tr_b16 v[36:37], v13 offset:47104
    ds_read_b64_tr_b16 v[38:39], v13 offset:47616
    v_mfma_f32_32x32x16_bf16 v[204:219], v[40:43], a[84:87], v[204:219]
    s_waitcnt lgkmcnt(6)
    v_mfma_f32_32x32x16_bf16 v[124:139], v[28:31], a[80:83], v[124:139]
    ds_read_b64_tr_b16 v[40:41], v18 offset:44032
    ds_read_b64_tr_b16 v[42:43], v18 offset:44288
    s_add_u32 m0, s27, 0
    s_add_u32 s77, s89, 442368
    buffer_load_dwordx4 v24, s[44:47], s77 offen lds
    buffer_load_dwordx4 v25, s[44:47], s77 offen offset:1024 lds
    v_mfma_f32_32x32x16_bf16 v[140:155], v[28:31], a[84:87], v[140:155]
    s_waitcnt lgkmcnt(4)
    v_mfma_f32_32x32x16_bf16 v[156:171], v[32:35], a[88:91], v[156:171]
    v_mfma_f32_32x32x16_bf16 v[172:187], v[32:35], a[92:95], v[172:187]
    s_waitcnt lgkmcnt(0)
    s_waitcnt vmcnt(20)
    s_barrier
    v_mfma_f32_32x32x16_bf16 v[188:203], v[36:39], a[88:91], v[188:203]
    ds_read_b64_tr_b16 v[28:29], v14 offset:0
    ds_read_b64_tr_b16 v[30:31], v14 offset:512
    v_mfma_f32_32x32x16_bf16 v[204:219], v[36:39], a[92:95], v[204:219]
    ds_read_b64_tr_b16 v[32:33], v15 offset:0
    ds_read_b64_tr_b16 v[34:35], v15 offset:512
    v_mfma_f32_32x32x16_bf16 v[124:139], v[40:43], a[88:91], v[124:139]
    ds_read_b64_tr_b16 v[36:37], v21 offset:0
    ds_read_b64_tr_b16 v[38:39], v21 offset:256
    v_mfma_f32_32x32x16_bf16 v[140:155], v[40:43], a[92:95], v[140:155]
    s_add_u32 s69, s81, 5
    s_and_b32 s69, s69, 7
    s_mul_i32 s72, s69, 229376
    s_add_u32 s3, s72, s73
    s_add_u32 s72, s72, s74
    s_add_u32 m0, s87, 40960
    s_waitcnt lgkmcnt(4)
    v_mfma_f32_32x32x16_bf16 v[156:171], v[28:31], a[96:99], v[156:171]
    ds_read_b64_tr_b16 v[40:41], v14 offset:2048
    ds_read_b64_tr_b16 v[42:43], v14 offset:2560
    buffer_load_dwordx4 v2, s[36:39], s72 offen offset:0 lds
    v_mfma_f32_32x32x16_bf16 v[172:187], v[28:31], a[100:103], v[172:187]
    ds_read_b64_tr_b16 a[16:17], v58 offset:0
    ds_read_b64_tr_b16 a[18:19], v58 offset:1024
    buffer_load_dwordx4 v3, s[36:39], s72 offen offset:1024 lds
    s_waitcnt lgkmcnt(6)
    v_mfma_f32_32x32x16_bf16 v[188:203], v[32:35], a[96:99], v[188:203]
    ds_read_b64_tr_b16 v[28:29], v15 offset:2048
    ds_read_b64_tr_b16 v[30:31], v15 offset:2560
    v_mfma_f32_32x32x16_bf16 v[204:219], v[32:35], a[100:103], v[204:219]
    ds_read_b64_tr_b16 a[20:21], v59 offset:0
    ds_read_b64_tr_b16 a[22:23], v59 offset:1024
    buffer_load_dwordx4 v4, s[36:39], s72 offen offset:2048 lds
    s_waitcnt lgkmcnt(8)
    v_mfma_f32_32x32x16_bf16 v[124:139], v[36:39], a[96:99], v[124:139]
    ds_read_b64_tr_b16 v[32:33], v21 offset:1024
    ds_read_b64_tr_b16 v[34:35], v21 offset:1280
    v_mfma_f32_32x32x16_bf16 v[140:155], v[36:39], a[100:103], v[140:155]
    s_waitcnt vmcnt(21)
    ds_read_b64_tr_b16 a[24:25], v26 offset:0
    ds_read_b64_tr_b16 a[26:27], v26 offset:1024
    buffer_load_dwordx4 v5, s[36:39], s72 offen offset:3072 lds
    s_add_u32 m0, s88, 57344
    s_waitcnt lgkmcnt(10)
    v_mfma_f32_32x32x16_bf16 v[156:171], v[40:43], a[104:107], v[156:171]
    ds_read_b64_tr_b16 v[36:37], v14 offset:4096
    ds_read_b64_tr_b16 v[38:39], v14 offset:4608
    buffer_load_dwordx4 v10, s[36:39], s3 offen offset:0 lds
    v_mfma_f32_32x32x16_bf16 v[172:187], v[40:43], a[108:111], v[172:187]
    ds_read_b64_tr_b16 a[28:29], v27 offset:0
    ds_read_b64_tr_b16 a[30:31], v27 offset:1024
    s_waitcnt lgkmcnt(10)
    v_mfma_f32_32x32x16_bf16 v[188:203], v[28:31], a[104:107], v[188:203]
    ds_read_b64_tr_b16 v[40:41], v15 offset:4096
    ds_read_b64_tr_b16 v[42:43], v15 offset:4608
    buffer_load_dwordx4 v11, s[36:39], s3 offen offset:1024 lds
    v_mfma_f32_32x32x16_bf16 v[204:219], v[28:31], a[108:111], v[204:219]
    s_waitcnt vmcnt(22)
    ds_read_b64_tr_b16 v[76:77], v26 offset:2048
    ds_read_b64_tr_b16 v[78:79], v26 offset:3072
    s_waitcnt lgkmcnt(10)
    v_mfma_f32_32x32x16_bf16 v[124:139], v[32:35], a[104:107], v[124:139]
    ds_read_b64_tr_b16 v[28:29], v21 offset:2048
    ds_read_b64_tr_b16 v[30:31], v21 offset:2304
    s_add_u32 m0, s27, 2048
    s_add_u32 s77, s89, 131072
    buffer_load_dwordx4 v24, s[44:47], s77 offen lds
    buffer_load_dwordx4 v25, s[44:47], s77 offen offset:1024 lds
    v_mfma_f32_32x32x16_bf16 v[140:155], v[32:35], a[108:111], v[140:155]
    ds_read_b64_tr_b16 v[80:81], v27 offset:2048
    ds_read_b64_tr_b16 v[82:83], v27 offset:3072
    s_waitcnt lgkmcnt(10)
    v_mfma_f32_32x32x16_bf16 v[156:171], v[36:39], a[112:115], v[156:171]
    ds_read_b64_tr_b16 v[32:33], v14 offset:6144
    ds_read_b64_tr_b16 v[34:35], v14 offset:6656
    v_mfma_f32_32x32x16_bf16 v[172:187], v[36:39], a[116:119], v[172:187]
    s_add_u32 m0, s27, 40960
    s_add_u32 s77, s89, 147456
    buffer_load_dwordx4 v24, s[44:47], s77 offen lds
    buffer_load_dwordx4 v25, s[44:47], s77 offen offset:1024 lds
    s_waitcnt lgkmcnt(8)
    v_mfma_f32_32x32x16_bf16 v[188:203], v[40:43], a[112:115], v[188:203]
    ds_read_b64_tr_b16 v[36:37], v15 offset:6144
    ds_read_b64_tr_b16 v[38:39], v15 offset:6656
    v_mfma_f32_32x32x16_bf16 v[204:219], v[40:43], a[116:119], v[204:219]
    s_waitcnt lgkmcnt(6)
    v_mfma_f32_32x32x16_bf16 v[124:139], v[28:31], a[112:115], v[124:139]
    ds_read_b64_tr_b16 v[40:41], v21 offset:3072
    ds_read_b64_tr_b16 v[42:43], v21 offset:3328
    s_add_u32 m0, s27, 43008
    s_add_u32 s77, s89, 163840
    buffer_load_dwordx4 v24, s[44:47], s77 offen lds
    buffer_load_dwordx4 v25, s[44:47], s77 offen offset:1024 lds
    v_mfma_f32_32x32x16_bf16 v[140:155], v[28:31], a[116:119], v[140:155]
    s_waitcnt lgkmcnt(4)
    v_mfma_f32_32x32x16_bf16 v[156:171], v[32:35], a[120:123], v[156:171]
    v_mfma_f32_32x32x16_bf16 v[172:187], v[32:35], a[124:127], v[172:187]
    s_waitcnt lgkmcnt(0)
    s_waitcnt vmcnt(18)
    s_barrier
    v_mfma_f32_32x32x16_bf16 v[188:203], v[36:39], a[120:123], v[188:203]
    ds_read_b64_tr_b16 v[28:29], v12 offset:0
    ds_read_b64_tr_b16 v[30:31], v12 offset:512
    v_mfma_f32_32x32x16_bf16 v[204:219], v[36:39], a[124:127], v[204:219]
    ds_read_b64_tr_b16 v[32:33], v13 offset:0
    ds_read_b64_tr_b16 v[34:35], v13 offset:512
    v_mfma_f32_32x32x16_bf16 v[124:139], v[40:43], a[120:123], v[124:139]
    ds_read_b64_tr_b16 v[36:37], v18 offset:0
    ds_read_b64_tr_b16 v[38:39], v18 offset:256
    v_mfma_f32_32x32x16_bf16 v[140:155], v[40:43], a[124:127], v[140:155]
    s_add_u32 s69, s81, 6
    s_and_b32 s69, s69, 7
    s_mul_i32 s72, s69, 229376
    s_add_u32 s3, s72, s73
    s_add_u32 s72, s72, s74
    s_add_u32 m0, s87, 81920
    s_waitcnt lgkmcnt(4)
    v_mfma_f32_32x32x16_bf16 v[156:171], v[28:31], a[128:131], v[156:171]
    ds_read_b64_tr_b16 v[40:41], v12 offset:2048
    ds_read_b64_tr_b16 v[42:43], v12 offset:2560
    buffer_load_dwordx4 v2, s[36:39], s72 offen offset:0 lds
    v_mfma_f32_32x32x16_bf16 v[172:187], v[28:31], a[132:135], v[172:187]
    ds_read_b64_tr_b16 v[84:85], v26 offset:4096
    ds_read_b64_tr_b16 v[86:87], v26 offset:5120
    buffer_load_dwordx4 v3, s[36:39], s72 offen offset:1024 lds
    s_waitcnt lgkmcnt(6)
    v_mfma_f32_32x32x16_bf16 v[188:203], v[32:35], a[128:131], v[188:203]
    ds_read_b64_tr_b16 v[28:29], v13 offset:2048
    ds_read_b64_tr_b16 v[30:31], v13 offset:2560
    v_mfma_f32_32x32x16_bf16 v[204:219], v[32:35], a[132:135], v[204:219]
    ds_read_b64_tr_b16 v[88:89], v27 offset:4096
    ds_read_b64_tr_b16 v[90:91], v27 offset:5120
    buffer_load_dwordx4 v4, s[36:39], s72 offen offset:2048 lds
    s_waitcnt lgkmcnt(8)
    v_mfma_f32_32x32x16_bf16 v[124:139], v[36:39], a[128:131], v[124:139]
    ds_read_b64_tr_b16 v[32:33], v18 offset:1024
    ds_read_b64_tr_b16 v[34:35], v18 offset:1280
    v_mfma_f32_32x32x16_bf16 v[140:155], v[36:39], a[132:135], v[140:155]
    ds_read_b64_tr_b16 a[32:33], v26 offset:6144
    ds_read_b64_tr_b16 a[34:35], v26 offset:7168
    buffer_load_dwordx4 v5, s[36:39], s72 offen offset:3072 lds
    s_add_u32 m0, s88, 98304
    s_waitcnt lgkmcnt(10)
    v_mfma_f32_32x32x16_bf16 v[156:171], v[40:43], a[136:139], v[156:171]
    ds_read_b64_tr_b16 v[36:37], v12 offset:4096
    ds_read_b64_tr_b16 v[38:39], v12 offset:4608
    buffer_load_dwordx4 v10, s[36:39], s3 offen offset:0 lds
    v_mfma_f32_32x32x16_bf16 v[172:187], v[40:43], a[140:143], v[172:187]
    ds_read_b64_tr_b16 a[36:37], v27 offset:6144
    ds_read_b64_tr_b16 a[38:39], v27 offset:7168
    s_waitcnt lgkmcnt(10)
    v_mfma_f32_32x32x16_bf16 v[188:203], v[28:31], a[136:139], v[188:203]
    ds_read_b64_tr_b16 v[40:41], v13 offset:4096
    ds_read_b64_tr_b16 v[42:43], v13 offset:4608
    buffer_load_dwordx4 v11, s[36:39], s3 offen offset:1024 lds
    v_mfma_f32_32x32x16_bf16 v[204:219], v[28:31], a[140:143], v[204:219]
    s_waitcnt vmcnt(22)
    ds_read_b64_tr_b16 a[40:41], v54 offset:0
    ds_read_b64_tr_b16 a[42:43], v54 offset:1024
    s_add_u32 s70, s26, 196608
    s_add_u32 s1, s26, 262144
    v_and_b32 v250, 1, v0
    v_lshlrev_b32 v250, 8, v250
    s_lshl_b32 s78, s60, 9
    v_add_u32 v245, s78, v250
    v_add_u32 v250, 128, v245
    buffer_load_dword v253, v250, s[40:43], s70 offen sc1
    s_waitcnt lgkmcnt(10)
    v_mfma_f32_32x32x16_bf16 v[124:139], v[32:35], a[136:139], v[124:139]
    ds_read_b64_tr_b16 v[28:29], v18 offset:2048
    ds_read_b64_tr_b16 v[30:31], v18 offset:2304
    s_add_u32 m0, s88, 155648
    s_add_u32 s77, s89, 180224
    buffer_load_dwordx4 v24, s[44:47], s77 offen lds
    buffer_load_dwordx4 v25, s[44:47], s77 offen offset:1024 lds
    v_mfma_f32_32x32x16_bf16 v[140:155], v[32:35], a[140:143], v[140:155]
    ds_read_b64_tr_b16 a[44:45], v55 offset:0
    ds_read_b64_tr_b16 a[46:47], v55 offset:1024
    s_waitcnt lgkmcnt(10)
    v_mfma_f32_32x32x16_bf16 v[156:171], v[36:39], a[144:147], v[156:171]
    ds_read_b64_tr_b16 v[32:33], v12 offset:6144
    ds_read_b64_tr_b16 v[34:35], v12 offset:6656
    v_mfma_f32_32x32x16_bf16 v[172:187], v[36:39], a[148:151], v[172:187]
    s_add_u32 m0, s93, 0
    s_add_u32 s77, s89, 196608
    buffer_load_dwordx4 v24, s[44:47], s77 offen lds
    buffer_load_dwordx4 v25, s[44:47], s77 offen offset:1024 lds
    s_waitcnt lgkmcnt(8)
    v_mfma_f32_32x32x16_bf16 v[188:203], v[40:43], a[144:147], v[188:203]
    ds_read_b64_tr_b16 v[36:37], v13 offset:6144
    ds_read_b64_tr_b16 v[38:39], v13 offset:6656
    v_mfma_f32_32x32x16_bf16 v[204:219], v[40:43], a[148:151], v[204:219]
    s_waitcnt lgkmcnt(6)
    v_mfma_f32_32x32x16_bf16 v[124:139], v[28:31], a[144:147], v[124:139]
    ds_read_b64_tr_b16 v[40:41], v18 offset:3072
    ds_read_b64_tr_b16 v[42:43], v18 offset:3328
    s_add_u32 m0, s93, 2048
    s_add_u32 s77, s89, 212992
    buffer_load_dwordx4 v24, s[44:47], s77 offen lds
    buffer_load_dwordx4 v25, s[44:47], s77 offen offset:1024 lds
    v_mfma_f32_32x32x16_bf16 v[140:155], v[28:31], a[148:151], v[140:155]
    s_waitcnt lgkmcnt(4)
    v_mfma_f32_32x32x16_bf16 v[156:171], v[32:35], a[152:155], v[156:171]
    v_mfma_f32_32x32x16_bf16 v[172:187], v[32:35], a[156:159], v[172:187]
    s_waitcnt lgkmcnt(0)
    s_waitcnt vmcnt(19)
    s_barrier
    v_mfma_f32_32x32x16_bf16 v[188:203], v[36:39], a[152:155], v[188:203]
    ds_read_b64_tr_b16 v[28:29], v12 offset:40960
    ds_read_b64_tr_b16 v[30:31], v12 offset:41472
    v_mfma_f32_32x32x16_bf16 v[204:219], v[36:39], a[156:159], v[204:219]
    ds_read_b64_tr_b16 v[32:33], v13 offset:40960
    ds_read_b64_tr_b16 v[34:35], v13 offset:41472
    v_mfma_f32_32x32x16_bf16 v[124:139], v[40:43], a[152:155], v[124:139]
    ds_read_b64_tr_b16 v[36:37], v18 offset:40960
    ds_read_b64_tr_b16 v[38:39], v18 offset:41216
    v_mfma_f32_32x32x16_bf16 v[140:155], v[40:43], a[156:159], v[140:155]
    s_waitcnt vmcnt(6)
    v_cmp_ne_u32 vcc, s68, v253
    s_cbranch_vccz L_pd_6
    s_mov_b32 s94, 0
L_pl_5:
    buffer_load_dword v253, v250, s[40:43], s70 offen sc1
    s_add_u32 s94, s94, 1
    s_waitcnt vmcnt(0)
    v_cmp_ne_u32 vcc, s68, v253
    s_cbranch_vccz L_pd_6
    s_cmp_lt_u32 s94, s97
    s_cbranch_scc1 L_pl_5
    s_mov_b32 s97, 0
L_pd_6:
    s_add_u32 s69, s81, 7
    s_and_b32 s69, s69, 7
    s_mul_i32 s72, s69, 229376
    s_add_u32 s3, s72, s73
    s_add_u32 s72, s72, s74
    s_add_u32 m0, s87, 0
    s_waitcnt lgkmcnt(4)
    v_mfma_f32_32x32x16_bf16 v[156:171], v[28:31], a[160:163], v[156:171]
    ds_read_b64_tr_b16 v[40:41], v12 offset:43008
    ds_read_b64_tr_b16 v[42:43], v12 offset:43520
    buffer_load_dwordx4 v2, s[36:39], s72 offen offset:0 lds
    v_mfma_f32_32x32x16_bf16 v[172:187], v[28:31], a[164:167], v[172:187]
    ds_read_b64_tr_b16 a[48:49], v54 offset:2048
    ds_read_b64_tr_b16 a[50:51], v54 offset:3072
    s_waitcnt lgkmcnt(6)
    v_mfma_f32_32x32x16_bf16 v[188:203], v[32:35], a[160:163], v[188:203]
    ds_read_b64_tr_b16 v[28:29], v13 offset:43008
    ds_read_b64_tr_b16 v[30:31], v13 offset:43520
    buffer_load_dwordx4 v3, s[36:39], s72 offen offset:1024 lds
    v_mfma_f32_32x32x16_bf16 v[204:219], v[32:35], a[164:167], v[204:219]
    ds_read_b64_tr_b16 a[52:53], v55 offset:2048
    ds_read_b64_tr_b16 a[54:55], v55 offset:3072
    s_waitcnt lgkmcnt(8)
    v_mfma_f32_32x32x16_bf16 v[124:139], v[36:39], a[160:163], v[124:139]
    ds_read_b64_tr_b16 v[32:33], v18 offset:41984
    ds_read_b64_tr_b16 v[34:35], v18 offset:42240
    buffer_load_dwordx4 v4, s[36:39], s72 offen offset:2048 lds
    v_mfma_f32_32x32x16_bf16 v[140:155], v[36:39], a[164:167], v[140:155]
    ds_read_b64_tr_b16 a[56:57], v52 offset:0
    ds_read_b64_tr_b16 a[58:59], v52 offset:1024
    s_waitcnt lgkmcnt(10)
    v_mfma_f32_32x32x16_bf16 v[156:171], v[40:43], a[168:171], v[156:171]
    ds_read_b64_tr_b16 v[36:37], v12 offset:45056
    ds_read_b64_tr_b16 v[38:39], v12 offset:45568
    buffer_load_dwordx4 v5, s[36:39], s72 offen offset:3072 lds
    s_add_u32 m0, s88, 16384
    v_mfma_f32_32x32x16_bf16 v[172:187], v[40:43], a[172:175], v[172:187]
    ds_read_b64_tr_b16 a[60:61], v53 offset:0
    ds_read_b64_tr_b16 a[62:63], v53 offset:1024
    s_waitcnt lgkmcnt(10)
    v_mfma_f32_32x32x16_bf16 v[188:203], v[28:31], a[168:171], v[188:203]
    ds_read_b64_tr_b16 v[40:41], v13 offset:45056
    ds_read_b64_tr_b16 v[42:43], v13 offset:45568
    buffer_load_dwordx4 v10, s[36:39], s3 offen offset:0 lds
    v_mfma_f32_32x32x16_bf16 v[204:219], v[28:31], a[172:175], v[204:219]
    ds_read_b64_tr_b16 a[64:65], v52 offset:2048
    ds_read_b64_tr_b16 a[66:67], v52 offset:3072
    s_waitcnt lgkmcnt(10)
    v_mfma_f32_32x32x16_bf16 v[124:139], v[32:35], a[168:171], v[124:139]
    ds_read_b64_tr_b16 v[28:29], v18 offset:43008
    ds_read_b64_tr_b16 v[30:31], v18 offset:43264
    buffer_load_dwordx4 v11, s[36:39], s3 offen offset:1024 lds
    v_mfma_f32_32x32x16_bf16 v[140:155], v[32:35], a[172:175], v[140:155]
    ds_read_b64_tr_b16 a[68:69], v53 offset:2048
    ds_read_b64_tr_b16 a[70:71], v53 offset:3072
    s_waitcnt lgkmcnt(10)
    v_mfma_f32_32x32x16_bf16 v[156:171], v[36:39], a[176:179], v[156:171]
    ds_read_b64_tr_b16 v[32:33], v12 offset:47104
    ds_read_b64_tr_b16 v[34:35], v12 offset:47616
    s_add_u32 s75, s91, 0
    s_add_u32 s76, s92, 0
    buffer_load_dwordx4 a[72:75], v1, s[40:43], s75 offen offset:0 sc1
    buffer_load_dwordx4 a[76:79], v1, s[40:43], s76 offen offset:0 sc1
    v_mfma_f32_32x32x16_bf16 v[172:187], v[36:39], a[180:183], v[172:187]
    s_waitcnt lgkmcnt(8)
    v_mfma_f32_32x32x16_bf16 v[188:203], v[40:43], a[176:179], v[188:203]
    ds_read_b64_tr_b16 v[36:37], v13 offset:47104
    ds_read_b64_tr_b16 v[38:39], v13 offset:47616
    v_mfma_f32_32x32x16_bf16 v[204:219], v[40:43], a[180:183], v[204:219]
    s_waitcnt lgkmcnt(6)
    v_mfma_f32_32x32x16_bf16 v[124:139], v[28:31], a[176:179], v[124:139]
    ds_read_b64_tr_b16 v[40:41], v18 offset:44032
    ds_read_b64_tr_b16 v[42:43], v18 offset:44288
    buffer_load_dwordx4 a[80:83], v1, s[40:43], s75 offen offset:1024 sc1
    buffer_load_dwordx4 a[84:87], v1, s[40:43], s76 offen offset:1024 sc1
    v_mfma_f32_32x32x16_bf16 v[140:155], v[28:31], a[180:183], v[140:155]
    s_waitcnt lgkmcnt(4)
    v_mfma_f32_32x32x16_bf16 v[156:171], v[32:35], a[184:187], v[156:171]
    v_mfma_f32_32x32x16_bf16 v[172:187], v[32:35], a[188:191], v[172:187]
    s_waitcnt lgkmcnt(0)
    s_barrier
    v_mfma_f32_32x32x16_bf16 v[188:203], v[36:39], a[184:187], v[188:203]
    ds_read_b64_tr_b16 v[28:29], v14 offset:0
    ds_read_b64_tr_b16 v[30:31], v14 offset:512
    v_mfma_f32_32x32x16_bf16 v[204:219], v[36:39], a[188:191], v[204:219]
    ds_read_b64_tr_b16 v[32:33], v15 offset:0
    ds_read_b64_tr_b16 v[34:35], v15 offset:512
    v_mfma_f32_32x32x16_bf16 v[124:139], v[40:43], a[184:187], v[124:139]
    ds_read_b64_tr_b16 v[36:37], v21 offset:0
    ds_read_b64_tr_b16 v[38:39], v21 offset:256
    v_mfma_f32_32x32x16_bf16 v[140:155], v[40:43], a[188:191], v[140:155]
    s_waitcnt lgkmcnt(4)
    v_mfma_f32_32x32x16_bf16 v[156:171], v[28:31], a[192:195], v[156:171]
    ds_read_b64_tr_b16 v[40:41], v14 offset:2048
    ds_read_b64_tr_b16 v[42:43], v14 offset:2560
    buffer_load_dwordx4 a[112:115], v1, s[40:43], s75 offen offset:2048 sc1
    buffer_load_dwordx4 a[116:119], v1, s[40:43], s76 offen offset:2048 sc1
    v_mfma_f32_32x32x16_bf16 v[172:187], v[28:31], a[196:199], v[172:187]
    ds_read_b64_tr_b16 a[88:89], v52 offset:40960
    ds_read_b64_tr_b16 a[90:91], v52 offset:41984
    s_waitcnt lgkmcnt(6)
    v_mfma_f32_32x32x16_bf16 v[188:203], v[32:35], a[192:195], v[188:203]
    ds_read_b64_tr_b16 v[28:29], v15 offset:2048
    ds_read_b64_tr_b16 v[30:31], v15 offset:2560
    v_mfma_f32_32x32x16_bf16 v[204:219], v[32:35], a[196:199], v[204:219]
    ds_read_b64_tr_b16 a[92:93], v53 offset:40960
    ds_read_b64_tr_b16 a[94:95], v53 offset:41984
    s_waitcnt lgkmcnt(8)
    v_mfma_f32_32x32x16_bf16 v[124:139], v[36:39], a[192:195], v[124:139]
    ds_read_b64_tr_b16 v[32:33], v21 offset:1024
    ds_read_b64_tr_b16 v[34:35], v21 offset:1280
    v_mfma_f32_32x32x16_bf16 v[140:155], v[36:39], a[196:199], v[140:155]
    ds_read_b64_tr_b16 a[96:97], v52 offset:43008
    ds_read_b64_tr_b16 a[98:99], v52 offset:44032
    s_waitcnt lgkmcnt(10)
    v_mfma_f32_32x32x16_bf16 v[156:171], v[40:43], a[200:203], v[156:171]
    ds_read_b64_tr_b16 v[36:37], v14 offset:4096
    ds_read_b64_tr_b16 v[38:39], v14 offset:4608
    buffer_load_dwordx4 a[120:123], v1, s[40:43], s75 offen offset:3072 sc1
    buffer_load_dwordx4 a[124:127], v1, s[40:43], s76 offen offset:3072 sc1
    v_mfma_f32_32x32x16_bf16 v[172:187], v[40:43], a[204:207], v[172:187]
    ds_read_b64_tr_b16 a[100:101], v53 offset:43008
    ds_read_b64_tr_b16 a[102:103], v53 offset:44032
    s_waitcnt lgkmcnt(10)
    v_mfma_f32_32x32x16_bf16 v[188:203], v[28:31], a[200:203], v[188:203]
    ds_read_b64_tr_b16 v[40:41], v15 offset:4096
    ds_read_b64_tr_b16 v[42:43], v15 offset:4608
    v_mfma_f32_32x32x16_bf16 v[204:219], v[28:31], a[204:207], v[204:219]
    s_waitcnt vmcnt(18)
    ds_read_b64_tr_b16 a[104:105], v58 offset:0
    ds_read_b64_tr_b16 a[106:107], v58 offset:1024
    s_waitcnt lgkmcnt(10)
    v_mfma_f32_32x32x16_bf16 v[124:139], v[32:35], a[200:203], v[124:139]
    ds_read_b64_tr_b16 v[28:29], v21 offset:2048
    ds_read_b64_tr_b16 v[30:31], v21 offset:2304
    v_mfma_f32_32x32x16_bf16 v[140:155], v[32:35], a[204:207], v[140:155]
    ds_read_b64_tr_b16 a[108:109], v59 offset:0
    ds_read_b64_tr_b16 a[110:111], v59 offset:1024
    s_waitcnt lgkmcnt(10)
    v_mfma_f32_32x32x16_bf16 v[156:171], v[36:39], a[208:211], v[156:171]
    ds_read_b64_tr_b16 v[32:33], v14 offset:6144
    ds_read_b64_tr_b16 v[34:35], v14 offset:6656
    v_mfma_f32_32x32x16_bf16 v[172:187], v[36:39], a[212:215], v[172:187]
    s_add_u32 m0, s93, 4096
    s_add_u32 s77, s89, 229376
    buffer_load_dwordx4 v24, s[44:47], s77 offen lds
    buffer_load_dwordx4 v25, s[44:47], s77 offen offset:1024 lds
    s_waitcnt lgkmcnt(8)
    v_mfma_f32_32x32x16_bf16 v[188:203], v[40:43], a[208:211], v[188:203]
    ds_read_b64_tr_b16 v[36:37], v15 offset:6144
    ds_read_b64_tr_b16 v[38:39], v15 offset:6656
    v_mfma_f32_32x32x16_bf16 v[204:219], v[40:43], a[212:215], v[204:219]
    s_waitcnt lgkmcnt(6)
    v_mfma_f32_32x32x16_bf16 v[124:139], v[28:31], a[208:211], v[124:139]
    ds_read_b64_tr_b16 v[40:41], v21 offset:3072
    ds_read_b64_tr_b16 v[42:43], v21 offset:3328
    v_mfma_f32_32x32x16_bf16 v[140:155], v[28:31], a[212:215], v[140:155]
    s_waitcnt lgkmcnt(4)
    v_mfma_f32_32x32x16_bf16 v[156:171], v[32:35], a[216:219], v[156:171]
    v_mfma_f32_32x32x16_bf16 v[172:187], v[32:35], a[220:223], v[172:187]
    s_waitcnt lgkmcnt(0)
    s_waitcnt vmcnt(10)
    s_barrier
    v_mfma_f32_32x32x16_bf16 v[188:203], v[36:39], a[216:219], v[188:203]
    ds_read_b64_tr_b16 v[28:29], v12 offset:0
    ds_read_b64_tr_b16 v[30:31], v12 offset:512
    v_mfma_f32_32x32x16_bf16 v[204:219], v[36:39], a[220:223], v[204:219]
    ds_read_b64_tr_b16 v[32:33], v13 offset:0
    ds_read_b64_tr_b16 v[34:35], v13 offset:512
    v_mfma_f32_32x32x16_bf16 v[124:139], v[40:43], a[216:219], v[124:139]
    ds_read_b64_tr_b16 v[36:37], v18 offset:0
    ds_read_b64_tr_b16 v[38:39], v18 offset:256
    v_mfma_f32_32x32x16_bf16 v[140:155], v[40:43], a[220:223], v[140:155]
    s_waitcnt lgkmcnt(4)
    v_mfma_f32_32x32x16_bf16 v[156:171], v[28:31], a[224:227], v[156:171]
    ds_read_b64_tr_b16 v[40:41], v12 offset:2048
    ds_read_b64_tr_b16 v[42:43], v12 offset:2560
    s_add_u32 s75, s91, 20480
    s_add_u32 s76, s92, 20480
    buffer_load_dwordx4 a[144:147], v1, s[40:43], s75 offen offset:0 sc1
    buffer_load_dwordx4 a[148:151], v1, s[40:43], s76 offen offset:0 sc1
    v_mfma_f32_32x32x16_bf16 v[172:187], v[28:31], a[228:231], v[172:187]
    ds_read_b64_tr_b16 a[128:129], v26 offset:0
    ds_read_b64_tr_b16 a[130:131], v26 offset:1024
    s_waitcnt lgkmcnt(6)
    v_mfma_f32_32x32x16_bf16 v[188:203], v[32:35], a[224:227], v[188:203]
    ds_read_b64_tr_b16 v[28:29], v13 offset:2048
    ds_read_b64_tr_b16 v[30:31], v13 offset:2560
    v_mfma_f32_32x32x16_bf16 v[204:219], v[32:35], a[228:231], v[204:219]
    ds_read_b64_tr_b16 a[132:133], v27 offset:0
    ds_read_b64_tr_b16 a[134:135], v27 offset:1024
    s_waitcnt lgkmcnt(8)
    v_mfma_f32_32x32x16_bf16 v[124:139], v[36:39], a[224:227], v[124:139]
    ds_read_b64_tr_b16 v[32:33], v18 offset:1024
    ds_read_b64_tr_b16 v[34:35], v18 offset:1280
    v_mfma_f32_32x32x16_bf16 v[140:155], v[36:39], a[228:231], v[140:155]
    ds_read_b64_tr_b16 a[136:137], v26 offset:2048
    ds_read_b64_tr_b16 a[138:139], v26 offset:3072
    s_waitcnt lgkmcnt(10)
    v_mfma_f32_32x32x16_bf16 v[156:171], v[40:43], a[232:235], v[156:171]
    ds_read_b64_tr_b16 v[36:37], v12 offset:4096
    ds_read_b64_tr_b16 v[38:39], v12 offset:4608
    v_mfma_f32_32x32x16_bf16 v[172:187], v[40:43], a[236:239], v[172:187]
    ds_read_b64_tr_b16 a[140:141], v27 offset:2048
    ds_read_b64_tr_b16 a[142:143], v27 offset:3072
    s_waitcnt lgkmcnt(10)
    v_mfma_f32_32x32x16_bf16 v[188:203], v[28:31], a[232:235], v[188:203]
    ds_read_b64_tr_b16 v[40:41], v13 offset:4096
    ds_read_b64_tr_b16 v[42:43], v13 offset:4608
    buffer_load_dwordx4 a[152:155], v1, s[40:43], s75 offen offset:1024 sc1
    buffer_load_dwordx4 a[156:159], v1, s[40:43], s76 offen offset:1024 sc1
    v_mfma_f32_32x32x16_bf16 v[204:219], v[28:31], a[236:239], v[204:219]
    s_waitcnt lgkmcnt(8)
    v_mfma_f32_32x32x16_bf16 v[124:139], v[32:35], a[232:235], v[124:139]
    ds_read_b64_tr_b16 v[28:29], v18 offset:2048
    ds_read_b64_tr_b16 v[30:31], v18 offset:2304
    v_mfma_f32_32x32x16_bf16 v[140:155], v[32:35], a[236:239], v[140:155]
    buffer_load_dword v246, v250, s[40:43], s1 offen sc1
    s_waitcnt lgkmcnt(6)
    v_mfma_f32_32x32x16_bf16 v[156:171], v[36:39], a[240:243], v[156:171]
    ds_read_b64_tr_b16 v[32:33], v12 offset:6144
    ds_read_b64_tr_b16 v[34:35], v12 offset:6656
    v_mfma_f32_32x32x16_bf16 v[172:187], v[36:39], a[244:247], v[172:187]
    s_waitcnt lgkmcnt(4)
    v_mfma_f32_32x32x16_bf16 v[188:203], v[40:43], a[240:243], v[188:203]
    ds_read_b64_tr_b16 v[36:37], v13 offset:6144
    ds_read_b64_tr_b16 v[38:39], v13 offset:6656
    v_mfma_f32_32x32x16_bf16 v[204:219], v[40:43], a[244:247], v[204:219]
    s_waitcnt lgkmcnt(4)
    v_mfma_f32_32x32x16_bf16 v[124:139], v[28:31], a[240:243], v[124:139]
    ds_read_b64_tr_b16 v[40:41], v18 offset:3072
    ds_read_b64_tr_b16 v[42:43], v18 offset:3328
    s_add_u32 m0, s93, 6144
    s_add_u32 s77, s89, 245760
    buffer_load_dwordx4 v24, s[44:47], s77 offen lds
    buffer_load_dwordx4 v25, s[44:47], s77 offen offset:1024 lds
    v_mfma_f32_32x32x16_bf16 v[140:155], v[28:31], a[244:247], v[140:155]
    s_waitcnt lgkmcnt(4)
    v_mfma_f32_32x32x16_bf16 v[156:171], v[32:35], a[248:251], v[156:171]
    v_mfma_f32_32x32x16_bf16 v[172:187], v[32:35], a[252:255], v[172:187]
    s_waitcnt lgkmcnt(2)
    v_mfma_f32_32x32x16_bf16 v[188:203], v[36:39], a[248:251], v[188:203]
    v_mfma_f32_32x32x16_bf16 v[204:219], v[36:39], a[252:255], v[204:219]
    s_waitcnt lgkmcnt(0)
    v_mfma_f32_32x32x16_bf16 v[124:139], v[40:43], a[248:251], v[124:139]
    v_mfma_f32_32x32x16_bf16 v[140:155], v[40:43], a[252:255], v[140:155]
    s_add_u32 s78, s85, 147456
    s_nop 3
    v_pk_mul_f32 v[156:157], v[156:157], v[164:165]
    v_pk_mul_f32 v[158:159], v[158:159], v[166:167]
    v_pk_mul_f32 v[160:161], v[160:161], v[168:169]
    v_pk_mul_f32 v[162:163], v[162:163], v[170:171]
    v_cvt_pk_bf16_f32 v28, v156, v157
    v_cvt_pk_bf16_f32 v29, v158, v159
    v_cvt_pk_bf16_f32 v30, v160, v161
    v_cvt_pk_bf16_f32 v31, v162, v163
    buffer_store_dwordx4 v[28:31], v1, s[40:43], s85 offen offset:0 sc1
    v_pk_mul_f32 v[188:189], v[188:189], v[196:197]
    v_pk_mul_f32 v[190:191], v[190:191], v[198:199]
    v_pk_mul_f32 v[192:193], v[192:193], v[200:201]
    v_pk_mul_f32 v[194:195], v[194:195], v[202:203]
    v_cvt_pk_bf16_f32 v32, v188, v189
    v_cvt_pk_bf16_f32 v33, v190, v191
    v_cvt_pk_bf16_f32 v34, v192, v193
    v_cvt_pk_bf16_f32 v35, v194, v195
    buffer_store_dwordx4 v[32:35], v1, s[40:43], s85 offen offset:1024 sc1
    v_pk_mul_f32 v[172:173], v[172:173], v[180:181]
    v_pk_mul_f32 v[174:175], v[174:175], v[182:183]
    v_pk_mul_f32 v[176:177], v[176:177], v[184:185]
    v_pk_mul_f32 v[178:179], v[178:179], v[186:187]
    v_cvt_pk_bf16_f32 v36, v172, v173
    v_cvt_pk_bf16_f32 v37, v174, v175
    v_cvt_pk_bf16_f32 v38, v176, v177
    v_cvt_pk_bf16_f32 v39, v178, v179
    buffer_store_dwordx4 v[36:39], v1, s[40:43], s78 offen offset:0 sc1
    v_pk_mul_f32 v[204:205], v[204:205], v[212:213]
    v_pk_mul_f32 v[206:207], v[206:207], v[214:215]
    v_pk_mul_f32 v[208:209], v[208:209], v[216:217]
    v_pk_mul_f32 v[210:211], v[210:211], v[218:219]
    v_cvt_pk_bf16_f32 v40, v204, v205
    v_cvt_pk_bf16_f32 v41, v206, v207
    v_cvt_pk_bf16_f32 v42, v208, v209
    v_cvt_pk_bf16_f32 v43, v210, v211
    buffer_store_dwordx4 v[40:43], v1, s[40:43], s78 offen offset:1024 sc1
    s_add_u32 s78, s84, 147456
    v_pk_mul_f32 v[124:125], v[124:125], v[132:133]
    v_pk_mul_f32 v[126:127], v[126:127], v[134:135]
    v_pk_mul_f32 v[128:129], v[128:129], v[136:137]
    v_pk_mul_f32 v[130:131], v[130:131], v[138:139]
    v_cvt_pk_bf16_f32 v220, v124, v125
    v_cvt_pk_bf16_f32 v221, v126, v127
    v_cvt_pk_bf16_f32 v222, v128, v129
    v_cvt_pk_bf16_f32 v223, v130, v131
    buffer_store_dwordx4 v[220:223], v1, s[40:43], s84 offen offset:0 sc1
    v_pk_mul_f32 v[140:141], v[140:141], v[148:149]
    v_pk_mul_f32 v[142:143], v[142:143], v[150:151]
    v_pk_mul_f32 v[144:145], v[144:145], v[152:153]
    v_pk_mul_f32 v[146:147], v[146:147], v[154:155]
    v_cvt_pk_bf16_f32 v224, v140, v141
    v_cvt_pk_bf16_f32 v225, v142, v143
    v_cvt_pk_bf16_f32 v226, v144, v145
    v_cvt_pk_bf16_f32 v227, v146, v147
    buffer_store_dwordx4 v[224:227], v1, s[40:43], s78 offen offset:0 sc1
    buffer_load_dwordx4 a[160:163], v1, s[40:43], s75 offen offset:2048 sc1
    buffer_load_dwordx4 a[164:167], v1, s[40:43], s76 offen offset:2048 sc1
    buffer_load_dwordx4 a[168:171], v1, s[40:43], s75 offen offset:3072 sc1
    buffer_load_dwordx4 a[172:175], v1, s[40:43], s76 offen offset:3072 sc1
    s_lshl_b32 s78, s66, 1
    s_add_u32 s78, s78, s64
    s_lshl_b32 s78, s78, 15
    s_lshl_b32 s79, s67, 1
    s_add_u32 s79, s79, s65
    s_lshl_b32 s79, s79, 6
    s_add_u32 s73, s78, s79
    s_add_u32 s74, s26, 327680
    v_and_b32 v248, 31, v0
    v_lshrrev_b32 v247, 5, v0
    v_and_b32 v249, 15, v0
    v_lshlrev_b32_e64 v249, 10, v249
    v_lshl_add_u32 v249, v247, 4, v249
    v_bfe_u32 v243, v0, 4, 1
    v_lshl_add_u32 v249, v243, 5, v249
    s_add_u32 s85, s73, 16384
    v_lshlrev_b32 v248, 10, v248
    v_lshl_add_u32 v248, v247, 3, v248
    s_xor_b32 s78, s60, 1
    s_mul_i32 s78, s78, 12288
    s_add_u32 s78, s78, 0
    v_add_u32 v239, s78, v1
    s_xor_b32 s78, s60, 2
    s_mul_i32 s78, s78, 12288
    s_add_u32 s78, s78, 4096
    v_add_u32 v240, s78, v1
    s_xor_b32 s78, s60, 3
    s_mul_i32 s78, s78, 12288
    s_add_u32 s78, s78, 8192
    v_add_u32 v241, s78, v1
    s_mul_i32 s78, s60, 12288
    v_add_u32 v238, s78, v1
    s_waitcnt vmcnt(25)
    v_mfma_f32_32x32x16_bf16 v[156:171], v[60:63], a[72:75], 0
    v_mfma_f32_32x32x16_bf16 v[172:187], v[64:67], a[72:75], 0
    s_waitcnt vmcnt(17)
    ds_read_b64_tr_b16 a[176:177], v26 offset:4096
    ds_read_b64_tr_b16 a[178:179], v26 offset:5120
    ds_read_b64_tr_b16 a[180:181], v27 offset:4096
    ds_read_b64_tr_b16 a[182:183], v27 offset:5120
    v_mfma_f32_32x32x16_bf16 v[188:203], v[60:63], a[76:79], 0
    v_mfma_f32_32x32x16_bf16 v[204:219], v[64:67], a[76:79], 0
    v_mfma_f32_32x32x16_bf16 v[156:171], v[68:71], a[80:83], v[156:171]
    v_mfma_f32_32x32x16_bf16 v[172:187], v[72:75], a[80:83], v[172:187]
    v_mfma_f32_32x32x16_bf16 v[188:203], v[68:71], a[84:87], v[188:203]
    v_mfma_f32_32x32x16_bf16 v[204:219], v[72:75], a[84:87], v[204:219]
    v_mfma_f32_32x32x16_bf16 v[156:171], v[92:95], a[112:115], v[156:171]
    v_mfma_f32_32x32x16_bf16 v[172:187], v[96:99], a[112:115], v[172:187]
    s_waitcnt vmcnt(10)
    ds_read_b64_tr_b16 a[184:185], v26 offset:6144
    ds_read_b64_tr_b16 a[186:187], v26 offset:7168
    ds_read_b64_tr_b16 a[188:189], v27 offset:6144
    ds_read_b64_tr_b16 a[190:191], v27 offset:7168
    v_mfma_f32_32x32x16_bf16 v[188:203], v[92:95], a[116:119], v[188:203]
    v_mfma_f32_32x32x16_bf16 v[204:219], v[96:99], a[116:119], v[204:219]
    v_mfma_f32_32x32x16_bf16 v[156:171], v[100:103], a[120:123], v[156:171]
    v_mfma_f32_32x32x16_bf16 v[172:187], v[104:107], a[120:123], v[172:187]
    v_mfma_f32_32x32x16_bf16 v[188:203], v[100:103], a[124:127], v[188:203]
    v_mfma_f32_32x32x16_bf16 v[204:219], v[104:107], a[124:127], v[204:219]
    v_mfma_f32_32x32x16_bf16 v[156:171], v[108:111], a[144:147], v[156:171]
    v_mfma_f32_32x32x16_bf16 v[172:187], v[112:115], a[144:147], v[172:187]
    v_mfma_f32_32x32x16_bf16 v[188:203], v[108:111], a[148:151], v[188:203]
    v_mfma_f32_32x32x16_bf16 v[204:219], v[112:115], a[148:151], v[204:219]
    v_mfma_f32_32x32x16_bf16 v[156:171], v[116:119], a[152:155], v[156:171]
    v_mfma_f32_32x32x16_bf16 v[172:187], v[120:123], a[152:155], v[172:187]
    v_mfma_f32_32x32x16_bf16 v[188:203], v[116:119], a[156:159], v[188:203]
    v_mfma_f32_32x32x16_bf16 v[204:219], v[120:123], a[156:159], v[204:219]
    s_waitcnt vmcnt(4)
    s_barrier
    s_cmp_lg_u32 s60, 0
    s_cbranch_scc1 L_fl_7
    s_lshl_b32 s79, s61, 4
    s_add_u32 s79, s79, s62
    s_lshl_b32 s79, s79, 7
    v_mov_b32 v254, s68
    s_add_u32 s79, s79, 262144
    s_mov_b64 exec, 1
    buffer_store_dword v254, off, s[40:43], s79 sc1
    s_mov_b64 exec, -1
L_fl_7:
    buffer_load_dword v246, v250, s[40:43], s1 offen sc1
    s_waitcnt vmcnt(3)
    v_mfma_f32_32x32x16_bf16 v[156:171], a[0:3], a[160:163], v[156:171]
    v_mfma_f32_32x32x16_bf16 v[172:187], a[4:7], a[160:163], v[172:187]
    v_mfma_f32_32x32x16_bf16 v[188:203], a[0:3], a[164:167], v[188:203]
    v_mfma_f32_32x32x16_bf16 v[204:219], a[4:7], a[164:167], v[204:219]
    s_waitcnt vmcnt(1)
    v_mfma_f32_32x32x16_bf16 v[156:171], a[8:11], a[168:171], v[156:171]
    v_mfma_f32_32x32x16_bf16 v[172:187], a[12:15], a[168:171], v[172:187]
    v_mfma_f32_32x32x16_bf16 v[188:203], a[8:11], a[172:175], v[188:203]
    v_mfma_f32_32x32x16_bf16 v[204:219], a[12:15], a[172:175], v[204:219]
    s_waitcnt vmcnt(0)
    v_cmp_ne_u32 vcc, s68, v246
    s_cbranch_vccz L_pd_9
    s_mov_b32 s94, 0
L_pl_8:
    buffer_load_dword v246, v250, s[40:43], s1 offen sc1
    s_add_u32 s94, s94, 1
    s_waitcnt vmcnt(0)
    v_cmp_ne_u32 vcc, s68, v246
    s_cbranch_vccz L_pd_9
    s_cmp_lt_u32 s94, s97
    s_cbranch_scc1 L_pl_8
    s_mov_b32 s97, 0
L_pd_9:
    s_add_u32 s75, s91, 4096
    s_add_u32 s76, s92, 4096
    buffer_load_dwordx4 a[192:195], v1, s[40:43], s75 offen offset:0 sc1
    buffer_load_dwordx4 a[196:199], v1, s[40:43], s76 offen offset:0 sc1
    buffer_load_dwordx4 a[200:203], v1, s[40:43], s75 offen offset:1024 sc1
    buffer_load_dwordx4 a[204:207], v1, s[40:43], s76 offen offset:1024 sc1
    buffer_load_dwordx4 a[208:211], v1, s[40:43], s75 offen offset:2048 sc1
    buffer_load_dwordx4 a[212:215], v1, s[40:43], s76 offen offset:2048 sc1
    buffer_load_dwordx4 a[216:219], v1, s[40:43], s75 offen offset:3072 sc1
    buffer_load_dwordx4 a[220:223], v1, s[40:43], s76 offen offset:3072 sc1
    s_add_u32 s75, s91, 24576
    s_add_u32 s76, s92, 24576
    buffer_load_dwordx4 a[224:227], v1, s[40:43], s75 offen offset:0 sc1
    buffer_load_dwordx4 a[228:231], v1, s[40:43], s76 offen offset:0 sc1
    buffer_load_dwordx4 a[232:235], v1, s[40:43], s75 offen offset:1024 sc1
    buffer_load_dwordx4 a[236:239], v1, s[40:43], s76 offen offset:1024 sc1
    s_waitcnt vmcnt(10)
    v_mfma_f32_32x32x16_bf16 v[156:171], a[16:19], a[192:195], v[156:171]
    buffer_load_dwordx4 a[240:243], v1, s[40:43], s75 offen offset:2048 sc1
    buffer_load_dwordx4 a[244:247], v1, s[40:43], s76 offen offset:2048 sc1
    v_mfma_f32_32x32x16_bf16 v[172:187], a[20:23], a[192:195], v[172:187]
    v_mfma_f32_32x32x16_bf16 v[188:203], a[16:19], a[196:199], v[188:203]
    v_mfma_f32_32x32x16_bf16 v[204:219], a[20:23], a[196:199], v[204:219]
    s_add_u32 m0, s27, 81920
    s_add_u32 s77, s89, 262144
    buffer_load_dwordx4 v24, s[44:47], s77 offen lds
    buffer_load_dwordx4 v25, s[44:47], s77 offen offset:1024 lds
    s_waitcnt vmcnt(12)
    v_mfma_f32_32x32x16_bf16 v[156:171], a[24:27], a[200:203], v[156:171]
    buffer_load_dwordx4 a[248:251], v1, s[40:43], s75 offen offset:3072 sc1
    buffer_load_dwordx4 a[252:255], v1, s[40:43], s76 offen offset:3072 sc1
    v_mfma_f32_32x32x16_bf16 v[172:187], a[28:31], a[200:203], v[172:187]
    v_mfma_f32_32x32x16_bf16 v[188:203], a[24:27], a[204:207], v[188:203]
    v_mfma_f32_32x32x16_bf16 v[204:219], a[28:31], a[204:207], v[204:219]
    s_add_u32 m0, s27, 83968
    s_add_u32 s77, s89, 278528
    buffer_load_dwordx4 v24, s[44:47], s77 offen lds
    buffer_load_dwordx4 v25, s[44:47], s77 offen offset:1024 lds
    buffer_load_dword v246, v245, s[40:43], s1 offen sc1
    s_waitcnt vmcnt(15)
    v_mfma_f32_32x32x16_bf16 v[156:171], v[76:79], a[208:211], v[156:171]
    v_mfma_f32_32x32x16_bf16 v[172:187], v[80:83], a[208:211], v[172:187]
    v_mfma_f32_32x32x16_bf16 v[188:203], v[76:79], a[212:215], v[188:203]
    v_mfma_f32_32x32x16_bf16 v[204:219], v[80:83], a[212:215], v[204:219]
    s_add_u32 m0, s27, 40960
    s_add_u32 s77, s89, 294912
    buffer_load_dwordx4 v24, s[44:47], s77 offen lds
    buffer_load_dwordx4 v25, s[44:47], s77 offen offset:1024 lds
    s_waitcnt vmcnt(15)
    v_mfma_f32_32x32x16_bf16 v[156:171], v[84:87], a[216:219], v[156:171]
    v_mfma_f32_32x32x16_bf16 v[172:187], v[88:91], a[216:219], v[172:187]
    v_mfma_f32_32x32x16_bf16 v[188:203], v[84:87], a[220:223], v[188:203]
    v_mfma_f32_32x32x16_bf16 v[204:219], v[88:91], a[220:223], v[204:219]
    s_add_u32 m0, s27, 43008
    s_add_u32 s77, s89, 311296
    buffer_load_dwordx4 v24, s[44:47], s77 offen lds
    buffer_load_dwordx4 v25, s[44:47], s77 offen offset:1024 lds
    s_waitcnt vmcnt(4)
    v_cmp_ne_u32 vcc, s68, v246
    s_cbranch_vccz L_pd_11
    s_mov_b32 s94, 0
L_pl_10:
    buffer_load_dword v246, v245, s[40:43], s1 offen sc1
    s_add_u32 s94, s94, 1
    s_waitcnt vmcnt(0)
    v_cmp_ne_u32 vcc, s68, v246
    s_cbranch_vccz L_pd_11
    s_cmp_lt_u32 s94, s97
    s_cbranch_scc1 L_pl_10
    s_mov_b32 s97, 0
L_pd_11:
    v_mfma_f32_32x32x16_bf16 v[156:171], a[32:35], a[224:227], v[156:171]
    s_add_u32 s75, s91, 8192
    s_add_u32 s76, s92, 8192
    buffer_load_dwordx4 a[72:75], v1, s[40:43], s75 offen offset:0 sc1
    buffer_load_dwordx4 a[76:79], v1, s[40:43], s76 offen offset:0 sc1
    v_mfma_f32_32x32x16_bf16 v[172:187], a[36:39], a[224:227], v[172:187]
    ds_read_b64_tr_b16 v[124:125], v54 offset:0
    ds_read_b64_tr_b16 v[126:127], v54 offset:1024
    ds_read_b64_tr_b16 v[128:129], v55 offset:0
    ds_read_b64_tr_b16 v[130:131], v55 offset:1024
    v_mfma_f32_32x32x16_bf16 v[188:203], a[32:35], a[228:231], v[188:203]
    v_mfma_f32_32x32x16_bf16 v[204:219], a[36:39], a[228:231], v[204:219]
    s_add_u32 m0, s88, 155648
    s_add_u32 s77, s90, 0
    buffer_load_dwordx4 v24, s[48:51], s77 offen lds
    buffer_load_dwordx4 v25, s[48:51], s77 offen offset:1024 lds
    v_mfma_f32_32x32x16_bf16 v[156:171], a[40:43], a[232:235], v[156:171]
    buffer_load_dwordx4 a[80:83], v1, s[40:43], s75 offen offset:1024 sc1
    buffer_load_dwordx4 a[84:87], v1, s[40:43], s76 offen offset:1024 sc1
    v_mfma_f32_32x32x16_bf16 v[172:187], a[44:47], a[232:235], v[172:187]
    ds_read_b64_tr_b16 v[132:133], v54 offset:2048
    ds_read_b64_tr_b16 v[134:135], v54 offset:3072
    ds_read_b64_tr_b16 v[136:137], v55 offset:2048
    ds_read_b64_tr_b16 v[138:139], v55 offset:3072
    v_mfma_f32_32x32x16_bf16 v[188:203], a[40:43], a[236:239], v[188:203]
    v_mfma_f32_32x32x16_bf16 v[204:219], a[44:47], a[236:239], v[204:219]
    s_add_u32 m0, s93, 0
    s_add_u32 s77, s90, 16384
    buffer_load_dwordx4 v24, s[48:51], s77 offen lds
    buffer_load_dwordx4 v25, s[48:51], s77 offen offset:1024 lds
    v_mfma_f32_32x32x16_bf16 v[156:171], a[48:51], a[240:243], v[156:171]
    buffer_load_dwordx4 a[112:115], v1, s[40:43], s75 offen offset:2048 sc1
    buffer_load_dwordx4 a[116:119], v1, s[40:43], s76 offen offset:2048 sc1
    v_mfma_f32_32x32x16_bf16 v[172:187], a[52:55], a[240:243], v[172:187]
    s_waitcnt vmcnt(12)
    ds_read_b64_tr_b16 v[140:141], v52 offset:40960
    ds_read_b64_tr_b16 v[142:143], v52 offset:41984
    ds_read_b64_tr_b16 v[144:145], v53 offset:40960
    ds_read_b64_tr_b16 v[146:147], v53 offset:41984
    v_mfma_f32_32x32x16_bf16 v[188:203], a[48:51], a[244:247], v[188:203]
    v_mfma_f32_32x32x16_bf16 v[204:219], a[52:55], a[244:247], v[204:219]
    s_add_u32 m0, s93, 2048
    s_add_u32 s77, s90, 32768
    buffer_load_dwordx4 v24, s[48:51], s77 offen lds
    buffer_load_dwordx4 v25, s[48:51], s77 offen offset:1024 lds
    v_mfma_f32_32x32x16_bf16 v[156:171], a[56:59], a[248:251], v[156:171]
    buffer_load_dwordx4 a[120:123], v1, s[40:43], s75 offen offset:3072 sc1
    buffer_load_dwordx4 a[124:127], v1, s[40:43], s76 offen offset:3072 sc1
    v_mfma_f32_32x32x16_bf16 v[172:187], a[60:63], a[248:251], v[172:187]
    s_waitcnt vmcnt(14)
    ds_read_b64_tr_b16 v[148:149], v52 offset:43008
    ds_read_b64_tr_b16 v[150:151], v52 offset:44032
    ds_read_b64_tr_b16 v[152:153], v53 offset:43008
    ds_read_b64_tr_b16 v[154:155], v53 offset:44032
    v_mfma_f32_32x32x16_bf16 v[188:203], a[56:59], a[252:255], v[188:203]
    v_mfma_f32_32x32x16_bf16 v[204:219], a[60:63], a[252:255], v[204:219]
    s_waitcnt lgkmcnt(15)
    s_add_u32 m0, s93, 4096
    s_add_u32 s77, s90, 49152
    buffer_load_dwordx4 v24, s[48:51], s77 offen lds
    buffer_load_dwordx4 v25, s[48:51], s77 offen offset:1024 lds
    buffer_load_dword v251, v250, s[40:43], s74 offen sc1
    s_waitcnt vmcnt(15)
    v_mfma_f32_32x32x16_bf16 v[156:171], a[64:67], a[72:75], v[156:171]
    s_add_u32 s75, s91, 12288
    s_add_u32 s76, s92, 12288
    buffer_load_dwordx4 a[144:147], v1, s[40:43], s75 offen offset:0 sc1
    buffer_load_dwordx4 a[148:151], v1, s[40:43], s76 offen offset:0 sc1
    v_mfma_f32_32x32x16_bf16 v[172:187], a[68:71], a[72:75], v[172:187]
    s_waitcnt vmcnt(15)
    ds_read_b64_tr_b16 v[60:61], v58 offset:0
    ds_read_b64_tr_b16 v[62:63], v58 offset:1024
    ds_read_b64_tr_b16 v[64:65], v59 offset:0
    ds_read_b64_tr_b16 v[66:67], v59 offset:1024
    v_mfma_f32_32x32x16_bf16 v[188:203], a[64:67], a[76:79], v[188:203]
    v_mfma_f32_32x32x16_bf16 v[204:219], a[68:71], a[76:79], v[204:219]
    s_add_u32 m0, s93, 6144
    s_add_u32 s77, s90, 65536
    buffer_load_dwordx4 v24, s[48:51], s77 offen lds
    buffer_load_dwordx4 v25, s[48:51], s77 offen offset:1024 lds
    s_barrier
    s_waitcnt vmcnt(15)
    v_mfma_f32_32x32x16_bf16 v[156:171], a[88:91], a[80:83], v[156:171]
    buffer_load_dwordx4 a[152:155], v1, s[40:43], s75 offen offset:1024 sc1
    buffer_load_dwordx4 a[156:159], v1, s[40:43], s76 offen offset:1024 sc1
    v_mfma_f32_32x32x16_bf16 v[172:187], a[92:95], a[80:83], v[172:187]
    s_waitcnt vmcnt(15)
    ds_read_b64_tr_b16 v[68:69], v26 offset:0
    ds_read_b64_tr_b16 v[70:71], v26 offset:1024
    ds_read_b64_tr_b16 v[72:73], v27 offset:0
    ds_read_b64_tr_b16 v[74:75], v27 offset:1024
    v_mfma_f32_32x32x16_bf16 v[188:203], a[88:91], a[84:87], v[188:203]
    v_mfma_f32_32x32x16_bf16 v[204:219], a[92:95], a[84:87], v[204:219]
    s_waitcnt lgkmcnt(15)
    s_add_u32 m0, s27, 81920
    s_add_u32 s77, s90, 81920
    buffer_load_dwordx4 v24, s[48:51], s77 offen lds
    buffer_load_dwordx4 v25, s[48:51], s77 offen offset:1024 lds
    s_waitcnt vmcnt(15)
    v_mfma_f32_32x32x16_bf16 v[156:171], a[96:99], a[112:115], v[156:171]
    buffer_load_dwordx4 a[0:3], v1, s[40:43], s75 offen offset:2048 sc1
    buffer_load_dwordx4 a[4:7], v1, s[40:43], s76 offen offset:2048 sc1
    v_mfma_f32_32x32x16_bf16 v[172:187], a[100:103], a[112:115], v[172:187]
    s_waitcnt vmcnt(15)
    ds_read_b64_tr_b16 v[92:93], v26 offset:2048
    ds_read_b64_tr_b16 v[94:95], v26 offset:3072
    ds_read_b64_tr_b16 v[96:97], v27 offset:2048
    ds_read_b64_tr_b16 v[98:99], v27 offset:3072
    v_mfma_f32_32x32x16_bf16 v[188:203], a[96:99], a[116:119], v[188:203]
    v_mfma_f32_32x32x16_bf16 v[204:219], a[100:103], a[116:119], v[204:219]
    s_add_u32 m0, s27, 83968
    s_add_u32 s77, s90, 98304
    buffer_load_dwordx4 v24, s[48:51], s77 offen lds
    buffer_load_dwordx4 v25, s[48:51], s77 offen offset:1024 lds
    s_waitcnt vmcnt(12)
    v_cmp_ne_u32 vcc, s68, v251
    s_cbranch_vccz L_pd_13
    s_mov_b32 s94, 0
L_pl_12:
    buffer_load_dword v251, v250, s[40:43], s74 offen sc1
    s_add_u32 s94, s94, 1
    s_waitcnt vmcnt(0)
    v_cmp_ne_u32 vcc, s68, v251
    s_cbranch_vccz L_pd_13
    s_cmp_lt_u32 s94, s97
    s_cbranch_scc1 L_pl_12
    s_mov_b32 s97, 0
L_pd_13:
    v_mfma_f32_32x32x16_bf16 v[156:171], a[104:107], a[120:123], v[156:171]
    buffer_load_dwordx4 a[160:163], v1, s[40:43], s75 offen offset:3072 sc1
    buffer_load_dwordx4 a[164:167], v1, s[40:43], s76 offen offset:3072 sc1
    v_mfma_f32_32x32x16_bf16 v[172:187], a[108:111], a[120:123], v[172:187]
    ds_read_b64_tr_b16 v[100:101], v26 offset:4096
    ds_read_b64_tr_b16 v[102:103], v26 offset:5120
    ds_read_b64_tr_b16 v[104:105], v27 offset:4096
    ds_read_b64_tr_b16 v[106:107], v27 offset:5120
    v_mfma_f32_32x32x16_bf16 v[188:203], a[104:107], a[124:127], v[188:203]
    v_mfma_f32_32x32x16_bf16 v[204:219], a[108:111], a[124:127], v[204:219]
    s_waitcnt lgkmcnt(15)
    s_add_u32 m0, s27, 40960
    s_add_u32 s77, s90, 114688
    buffer_load_dwordx4 v24, s[48:51], s77 offen lds
    buffer_load_dwordx4 v25, s[48:51], s77 offen offset:1024 lds
    s_waitcnt vmcnt(14)
    v_mfma_f32_32x32x16_bf16 v[156:171], a[128:131], a[144:147], v[156:171]
    s_add_u32 s75, s91, 16384
    s_add_u32 s76, s92, 16384
    buffer_load_dwordx4 a[8:11], v1, s[40:43], s75 offen offset:0 sc1
    buffer_load_dwordx4 a[12:15], v1, s[40:43], s76 offen offset:0 sc1
    v_mfma_f32_32x32x16_bf16 v[172:187], a[132:135], a[144:147], v[172:187]
    s_waitcnt vmcnt(14)
    ds_read_b64_tr_b16 v[108:109], v26 offset:6144
    ds_read_b64_tr_b16 v[110:111], v26 offset:7168
    ds_read_b64_tr_b16 v[112:113], v27 offset:6144
    ds_read_b64_tr_b16 v[114:115], v27 offset:7168
    v_mfma_f32_32x32x16_bf16 v[188:203], a[128:131], a[148:151], v[188:203]
    v_mfma_f32_32x32x16_bf16 v[204:219], a[132:135], a[148:151], v[204:219]
    buffer_load_dwordx4 a[168:171], v1, s[40:43], s75 offen offset:1024 sc1
    buffer_load_dwordx4 a[172:175], v1, s[40:43], s76 offen offset:1024 sc1
    s_waitcnt vmcnt(14)
    v_mfma_f32_32x32x16_bf16 v[156:171], a[136:139], a[152:155], v[156:171]
    buffer_load_dwordx4 a[16:19], v1, s[40:43], s75 offen offset:2048 sc1
    buffer_load_dwordx4 a[20:23], v1, s[40:43], s76 offen offset:2048 sc1
    v_mfma_f32_32x32x16_bf16 v[172:187], a[140:143], a[152:155], v[172:187]
    s_waitcnt vmcnt(14)
    ds_read_b64_tr_b16 v[116:117], v54 offset:0
    ds_read_b64_tr_b16 v[118:119], v54 offset:1024
    ds_read_b64_tr_b16 v[120:121], v55 offset:0
    ds_read_b64_tr_b16 v[122:123], v55 offset:1024
    v_mfma_f32_32x32x16_bf16 v[188:203], a[136:139], a[156:159], v[188:203]
    v_mfma_f32_32x32x16_bf16 v[204:219], a[140:143], a[156:159], v[204:219]
    buffer_load_dwordx4 a[192:195], v1, s[40:43], s75 offen offset:3072 sc1
    buffer_load_dwordx4 a[196:199], v1, s[40:43], s76 offen offset:3072 sc1
    s_waitcnt vmcnt(14)
    v_mfma_f32_32x32x16_bf16 v[156:171], a[176:179], a[0:3], v[156:171]
    s_mul_i32 s76, s60, -20480
    s_add_u32 s76, s76, 114688
    s_add_u32 s75, s91, s76
    s_add_u32 s76, s92, s76
    buffer_load_dwordx4 a[24:27], v1, s[40:43], s75 offen offset:0 sc1
    buffer_load_dwordx4 a[28:31], v1, s[40:43], s76 offen offset:0 sc1
    v_mfma_f32_32x32x16_bf16 v[172:187], a[180:183], a[0:3], v[172:187]
    s_waitcnt vmcnt(14)
    ds_read_b64_tr_b16 a[200:201], v54 offset:2048
    ds_read_b64_tr_b16 a[202:203], v54 offset:3072
    ds_read_b64_tr_b16 a[204:205], v55 offset:2048
    ds_read_b64_tr_b16 a[206:207], v55 offset:3072
    v_mfma_f32_32x32x16_bf16 v[188:203], a[176:179], a[4:7], v[188:203]
    v_mfma_f32_32x32x16_bf16 v[204:219], a[180:183], a[4:7], v[204:219]
    buffer_load_dwordx4 a[208:211], v1, s[40:43], s75 offen offset:1024 sc1
    buffer_load_dwordx4 a[212:215], v1, s[40:43], s76 offen offset:1024 sc1
    s_waitcnt vmcnt(14)
    v_mfma_f32_32x32x16_bf16 v[156:171], a[184:187], a[160:163], v[156:171]
    buffer_load_dwordx4 a[216:219], v1, s[40:43], s75 offen offset:2048 sc1
    buffer_load_dwordx4 a[220:223], v1, s[40:43], s76 offen offset:2048 sc1
    v_mfma_f32_32x32x16_bf16 v[172:187], a[188:191], a[160:163], v[172:187]
    s_waitcnt vmcnt(14)
    ds_read_b64_tr_b16 v[76:77], v52 offset:40960
    ds_read_b64_tr_b16 v[78:79], v52 offset:41984
    ds_read_b64_tr_b16 v[80:81], v53 offset:40960
    ds_read_b64_tr_b16 v[82:83], v53 offset:41984
    v_mfma_f32_32x32x16_bf16 v[188:203], a[184:187], a[164:167], v[188:203]
    v_mfma_f32_32x32x16_bf16 v[204:219], a[188:191], a[164:167], v[204:219]
    buffer_load_dwordx4 a[32:35], v1, s[40:43], s75 offen offset:3072 sc1
    buffer_load_dwordx4 a[36:39], v1, s[40:43], s76 offen offset:3072 sc1
    s_waitcnt vmcnt(14)
    s_mul_i32 s76, s60, -20480
    s_add_u32 s76, s76, 118784
    s_add_u32 s75, s91, s76
    s_add_u32 s76, s92, s76
    buffer_load_dwordx4 a[224:227], v1, s[40:43], s75 offen offset:0 sc1
    buffer_load_dwordx4 a[228:231], v1, s[40:43], s76 offen offset:0 sc1
    v_mfma_f32_32x32x16_bf16 v[172:187], v[128:131], a[8:11], v[172:187]
    v_mfma_f32_32x32x16_bf16 v[188:203], v[124:127], a[12:15], v[188:203]
    v_mfma_f32_32x32x16_bf16 v[204:219], v[128:131], a[12:15], v[204:219]
    buffer_load_dwordx4 a[40:43], v1, s[40:43], s75 offen offset:1024 sc1
    buffer_load_dwordx4 a[44:47], v1, s[40:43], s76 offen offset:1024 sc1
    s_waitcnt vmcnt(16)
    buffer_load_dwordx4 a[232:235], v1, s[40:43], s75 offen offset:2048 sc1
    buffer_load_dwordx4 a[236:239], v1, s[40:43], s76 offen offset:2048 sc1
    v_mfma_f32_32x32x16_bf16 v[172:187], v[136:139], a[168:171], v[172:187]
    v_mfma_f32_32x32x16_bf16 v[188:203], v[132:135], a[172:175], v[188:203]
    v_mfma_f32_32x32x16_bf16 v[204:219], v[136:139], a[172:175], v[204:219]
    buffer_load_dwordx4 a[48:51], v1, s[40:43], s75 offen offset:3072 sc1
    buffer_load_dwordx4 a[52:55], v1, s[40:43], s76 offen offset:3072 sc1
    s_waitcnt vmcnt(18)
    v_mfma_f32_32x32x16_bf16 v[172:187], v[144:147], a[16:19], v[172:187]
    v_mfma_f32_32x32x16_bf16 v[188:203], v[140:143], a[20:23], v[188:203]
    v_mfma_f32_32x32x16_bf16 v[204:219], v[144:147], a[20:23], v[204:219]
    s_waitcnt vmcnt(16)
    v_mfma_f32_32x32x16_bf16 v[172:187], v[152:155], a[192:195], v[172:187]
    v_mfma_f32_32x32x16_bf16 v[188:203], v[148:151], a[196:199], v[188:203]
    v_mfma_f32_32x32x16_bf16 v[204:219], v[152:155], a[196:199], v[204:219]
    buffer_load_dwordx2 v[220:221], v248, s[28:31], s73 offen offset:0
    buffer_load_dwordx2 v[222:223], v248, s[28:31], s73 offen offset:16
    buffer_load_dwordx2 v[224:225], v248, s[28:31], s73 offen offset:32
    buffer_load_dwordx2 v[226:227], v248, s[28:31], s73 offen offset:48
    s_waitcnt vmcnt(18) lgkmcnt(15)
    v_mfma_f32_32x32x16_bf16 v[172:187], v[64:67], a[24:27], v[172:187]
    v_mfma_f32_32x32x16_bf16 v[188:203], v[60:63], a[28:31], v[188:203]
    v_mfma_f32_32x32x16_bf16 v[204:219], v[64:67], a[28:31], v[204:219]
    s_waitcnt vmcnt(16)
    v_mfma_f32_32x32x16_bf16 v[172:187], v[72:75], a[208:211], v[172:187]
    v_mfma_f32_32x32x16_bf16 v[188:203], v[68:71], a[212:215], v[188:203]
    v_mfma_f32_32x32x16_bf16 v[204:219], v[72:75], a[212:215], v[204:219]
    s_waitcnt vmcnt(14)
    v_mfma_f32_32x32x16_bf16 v[172:187], v[96:99], a[216:219], v[172:187]
    v_mfma_f32_32x32x16_bf16 v[188:203], v[92:95], a[220:223], v[188:203]
    v_mfma_f32_32x32x16_bf16 v[204:219], v[96:99], a[220:223], v[204:219]
    s_waitcnt vmcnt(12)
    v_mfma_f32_32x32x16_bf16 v[172:187], v[104:107], a[32:35], v[172:187]
    v_mfma_f32_32x32x16_bf16 v[188:203], v[100:103], a[36:39], v[188:203]
    v_mfma_f32_32x32x16_bf16 v[204:219], v[104:107], a[36:39], v[204:219]
    s_waitcnt vmcnt(10) lgkmcnt(12)
    v_mfma_f32_32x32x16_bf16 v[172:187], v[112:115], a[224:227], v[172:187]
    v_mfma_f32_32x32x16_bf16 v[188:203], v[108:111], a[228:231], v[188:203]
    v_mfma_f32_32x32x16_bf16 v[204:219], v[112:115], a[228:231], v[204:219]
    s_waitcnt vmcnt(8) lgkmcnt(8)
    v_mfma_f32_32x32x16_bf16 v[172:187], v[120:123], a[40:43], v[172:187]
    v_mfma_f32_32x32x16_bf16 v[188:203], v[116:119], a[44:47], v[188:203]
    v_mfma_f32_32x32x16_bf16 v[204:219], v[120:123], a[44:47], v[204:219]
    s_waitcnt vmcnt(6) lgkmcnt(4)
    v_mfma_f32_32x32x16_bf16 v[172:187], a[204:207], a[232:235], v[172:187]
    v_mfma_f32_32x32x16_bf16 v[188:203], a[200:203], a[236:239], v[188:203]
    v_mfma_f32_32x32x16_bf16 v[204:219], a[204:207], a[236:239], v[204:219]
    s_waitcnt vmcnt(4) lgkmcnt(0)
    v_mfma_f32_32x32x16_bf16 v[172:187], v[80:83], a[48:51], v[172:187]
    v_mfma_f32_32x32x16_bf16 v[188:203], v[76:79], a[52:55], v[188:203]
    v_mfma_f32_32x32x16_bf16 v[204:219], v[80:83], a[52:55], v[204:219]
    s_nop 9
    ds_write_b128 v239, v[172:175] offset:0
    v_mfma_f32_32x32x16_bf16 v[156:171], v[124:127], a[8:11], v[156:171]
    ds_write_b128 v239, v[176:179] offset:1024
    v_mfma_f32_32x32x16_bf16 v[156:171], v[132:135], a[168:171], v[156:171]
    ds_write_b128 v239, v[180:183] offset:2048
    v_mfma_f32_32x32x16_bf16 v[156:171], v[140:143], a[16:19], v[156:171]
    ds_write_b128 v239, v[184:187] offset:3072
    v_mfma_f32_32x32x16_bf16 v[156:171], v[148:151], a[192:195], v[156:171]
    ds_write_b128 v240, v[188:191] offset:0
    v_mfma_f32_32x32x16_bf16 v[156:171], v[60:63], a[24:27], v[156:171]
    ds_write_b128 v240, v[192:195] offset:1024
    v_mfma_f32_32x32x16_bf16 v[156:171], v[68:71], a[208:211], v[156:171]
    ds_write_b128 v240, v[196:199] offset:2048
    v_mfma_f32_32x32x16_bf16 v[156:171], v[92:95], a[216:219], v[156:171]
    ds_write_b128 v240, v[200:203] offset:3072
    v_mfma_f32_32x32x16_bf16 v[156:171], v[100:103], a[32:35], v[156:171]
    ds_write_b128 v241, v[204:207] offset:0
    v_mfma_f32_32x32x16_bf16 v[156:171], v[108:111], a[224:227], v[156:171]
    ds_write_b128 v241, v[208:211] offset:1024
    v_mfma_f32_32x32x16_bf16 v[156:171], v[116:119], a[40:43], v[156:171]
    ds_write_b128 v241, v[212:215] offset:2048
    v_mfma_f32_32x32x16_bf16 v[156:171], a[200:203], a[232:235], v[156:171]
    ds_write_b128 v241, v[216:219] offset:3072
    v_mfma_f32_32x32x16_bf16 v[156:171], v[76:79], a[48:51], v[156:171]
    s_waitcnt vmcnt(0)
    v_lshlrev_b32 v228, 16, v220
    v_and_b32 v229, 0xffff0000, v220
    s_nop 8
    v_pk_add_f32 v[156:157], v[156:157], v[228:229]
    v_lshlrev_b32 v228, 16, v221
    v_and_b32 v229, 0xffff0000, v221
    v_pk_add_f32 v[158:159], v[158:159], v[228:229]
    v_lshlrev_b32 v228, 16, v222
    v_and_b32 v229, 0xffff0000, v222
    v_pk_add_f32 v[160:161], v[160:161], v[228:229]
    v_lshlrev_b32 v228, 16, v223
    v_and_b32 v229, 0xffff0000, v223
    v_pk_add_f32 v[162:163], v[162:163], v[228:229]
    v_lshlrev_b32 v228, 16, v224
    v_and_b32 v229, 0xffff0000, v224
    v_pk_add_f32 v[164:165], v[164:165], v[228:229]
    v_lshlrev_b32 v228, 16, v225
    v_and_b32 v229, 0xffff0000, v225
    v_pk_add_f32 v[166:167], v[166:167], v[228:229]
    v_lshlrev_b32 v228, 16, v226
    v_and_b32 v229, 0xffff0000, v226
    v_pk_add_f32 v[168:169], v[168:169], v[228:229]
    v_lshlrev_b32 v228, 16, v227
    v_and_b32 v229, 0xffff0000, v227
    v_pk_add_f32 v[170:171], v[170:171], v[228:229]
    s_waitcnt lgkmcnt(0)
    s_barrier
    ds_read_b128 v[60:63], v238 offset:0
    ds_read_b128 v[64:67], v238 offset:1024
    ds_read_b128 v[68:71], v238 offset:2048
    ds_read_b128 v[72:75], v238 offset:3072
    ds_read_b128 v[76:79], v238 offset:4096
    ds_read_b128 v[80:83], v238 offset:5120
    ds_read_b128 v[84:87], v238 offset:6144
    ds_read_b128 v[88:91], v238 offset:7168
    ds_read_b128 v[92:95], v238 offset:8192
    ds_read_b128 v[96:99], v238 offset:9216
    ds_read_b128 v[100:103], v238 offset:10240
    ds_read_b128 v[104:107], v238 offset:11264
    s_waitcnt lgkmcnt(11)
    v_pk_add_f32 v[156:157], v[156:157], v[60:61]
    v_pk_add_f32 v[158:159], v[158:159], v[62:63]
    s_waitcnt lgkmcnt(10)
    v_pk_add_f32 v[160:161], v[160:161], v[64:65]
    v_pk_add_f32 v[162:163], v[162:163], v[66:67]
    s_waitcnt lgkmcnt(9)
    v_pk_add_f32 v[164:165], v[164:165], v[68:69]
    v_pk_add_f32 v[166:167], v[166:167], v[70:71]
    s_waitcnt lgkmcnt(8)
    v_pk_add_f32 v[168:169], v[168:169], v[72:73]
    v_pk_add_f32 v[170:171], v[170:171], v[74:75]
    s_waitcnt lgkmcnt(7)
    v_pk_add_f32 v[156:157], v[156:157], v[76:77]
    v_pk_add_f32 v[158:159], v[158:159], v[78:79]
    s_waitcnt lgkmcnt(6)
    v_pk_add_f32 v[160:161], v[160:161], v[80:81]
    v_pk_add_f32 v[162:163], v[162:163], v[82:83]
    s_waitcnt lgkmcnt(5)
    v_pk_add_f32 v[164:165], v[164:165], v[84:85]
    v_pk_add_f32 v[166:167], v[166:167], v[86:87]
    s_waitcnt lgkmcnt(4)
    v_pk_add_f32 v[168:169], v[168:169], v[88:89]
    v_pk_add_f32 v[170:171], v[170:171], v[90:91]
    s_waitcnt lgkmcnt(3)
    v_pk_add_f32 v[156:157], v[156:157], v[92:93]
    v_pk_add_f32 v[158:159], v[158:159], v[94:95]
    s_waitcnt lgkmcnt(2)
    v_pk_add_f32 v[160:161], v[160:161], v[96:97]
    v_pk_add_f32 v[162:163], v[162:163], v[98:99]
    s_waitcnt lgkmcnt(1)
    v_pk_add_f32 v[164:165], v[164:165], v[100:101]
    v_pk_add_f32 v[166:167], v[166:167], v[102:103]
    s_waitcnt lgkmcnt(0)
    v_pk_add_f32 v[168:169], v[168:169], v[104:105]
    v_pk_add_f32 v[170:171], v[170:171], v[106:107]
    v_cvt_pk_bf16_f32 v220, v156, v157
    v_cvt_pk_bf16_f32 v221, v158, v159
    v_cvt_pk_bf16_f32 v222, v160, v161
    v_cvt_pk_bf16_f32 v223, v162, v163
    v_cvt_pk_bf16_f32 v224, v164, v165
    v_cvt_pk_bf16_f32 v225, v166, v167
    v_cvt_pk_bf16_f32 v226, v168, v169
    v_cvt_pk_bf16_f32 v227, v170, v171
    v_permlane32_swap_b32 v220, v222
    v_permlane32_swap_b32 v221, v223
    v_permlane32_swap_b32 v224, v226
    v_permlane32_swap_b32 v225, v227
    s_nop 0
    v_permlane16_swap_b32 v220, v224
    v_permlane16_swap_b32 v221, v225
    v_permlane16_swap_b32 v222, v226
    v_permlane16_swap_b32 v223, v227
    buffer_store_dwordx4 v[220:223], v249, s[52:55], s73 offen
    buffer_store_dwordx4 v[224:227], v249, s[52:55], s85 offen
    s_endpgm
L_typeB:
    s_nop 1
    s_cmp_eq_u32 s78, 0
    s_cselect_b32 s73, 0, 192
    s_add_u32 s74, s73, 128
    s_add_u32 s73, s73, s80
    s_add_u32 s74, s74, s80
    s_mul_i32 s78, s60, 49152
    s_lshl_b32 s79, s63, 7
    s_add_u32 s78, s78, s79
    v_lshrrev_b32_e64 v222, 3, v0
    v_mul_u32_u24 v222, 3072, v222
    v_add3_u32 v6, v222, v221, s78
    v_add_u32 v7, 23552, v6
    v_and_b32 v86, 7, v0
    v_lshrrev_b32 v87, 3, v0
    v_lshlrev_b32 v96, 5, v86
    v_add_u32 v96, 155648, v96
    s_lshl_b32 s78, s60, 3
    v_add_u32 v98, s78, v96
    s_lshr_b32 s78, s62, 2
    s_lshl_b32 s79, s61, 2
    s_add_u32 s78, s78, s79
    s_lshl_b32 s78, s78, 15
    s_and_b32 s79, s62, 3
    s_lshl_b32 s79, s79, 7
    s_add_u32 s78, s78, s79
    s_lshl_b32 s79, s60, 13
    s_add_u32 s78, s78, s79
    s_add_u32 s78, s78, 3145728
    s_add_u32 s79, s78, 4096
    v_lshlrev_b32 v97, 9, v87
    v_lshl_add_u32 v97, v86, 4, v97
    s_waitcnt vmcnt(3)
    s_lshl_b32 s77, s2, 1
    s_add_u32 s77, s77, s65
    s_mul_i32 s77, s77, 3584
    s_mov_b64 exec, 0xfffffff
    buffer_load_dword v231, v229, s[36:39], s77 offen
    s_mov_b64 exec, -1
    v_lshlrev_b32 v68, 16, v60
    v_and_b32 v69, 0xffff0000, v60
    v_lshlrev_b32 v70, 16, v61
    v_and_b32 v71, 0xffff0000, v61
    v_lshlrev_b32 v72, 16, v62
    v_and_b32 v73, 0xffff0000, v62
    v_lshlrev_b32 v74, 16, v63
    v_and_b32 v75, 0xffff0000, v63
    v_lshlrev_b32 v76, 16, v64
    v_and_b32 v77, 0xffff0000, v64
    v_lshlrev_b32 v78, 16, v65
    v_and_b32 v79, 0xffff0000, v65
    v_lshlrev_b32 v80, 16, v66
    v_and_b32 v81, 0xffff0000, v66
    v_lshlrev_b32 v82, 16, v67
    v_and_b32 v83, 0xffff0000, v67
    v_add_f32 v84, v68, v69
    v_mul_f32 v85, v68, v68
    v_fmac_f32 v85, v69, v69
    v_add_f32 v84, v84, v70
    v_fmac_f32 v85, v70, v70
    v_add_f32 v84, v84, v71
    v_fmac_f32 v85, v71, v71
    v_add_f32 v84, v84, v72
    v_fmac_f32 v85, v72, v72
    v_add_f32 v84, v84, v73
    v_fmac_f32 v85, v73, v73
    v_add_f32 v84, v84, v74
    v_fmac_f32 v85, v74, v74
    v_add_f32 v84, v84, v75
    v_fmac_f32 v85, v75, v75
    v_add_f32 v84, v84, v76
    v_fmac_f32 v85, v76, v76
    v_add_f32 v84, v84, v77
    v_fmac_f32 v85, v77, v77
    v_add_f32 v84, v84, v78
    v_fmac_f32 v85, v78, v78
    v_add_f32 v84, v84, v79
    v_fmac_f32 v85, v79, v79
    v_add_f32 v84, v84, v80
    v_fmac_f32 v85, v80, v80
    v_add_f32 v84, v84, v81
    v_fmac_f32 v85, v81, v81
    v_add_f32 v84, v84, v82
    v_fmac_f32 v85, v82, v82
    v_add_f32 v84, v84, v83
    v_fmac_f32 v85, v83, v83
    s_nop 0
    v_add_f32_dpp v84, v84, v84 row_ror:8 row_mask:0xf bank_mask:0xf
    v_add_f32_dpp v85, v85, v85 row_ror:8 row_mask:0xf bank_mask:0xf
    v_mov_b32 v86, v84
    v_mov_b32 v87, v85
    s_nop 0
    v_permlane16_swap_b32 v86, v84
    v_permlane16_swap_b32 v87, v85
    v_add_f32 v84, v84, v86
    v_add_f32 v85, v85, v87
    v_mov_b32 v86, v84
    v_mov_b32 v87, v85
    s_nop 0
    v_permlane32_swap_b32 v86, v84
    v_permlane32_swap_b32 v87, v85
    v_add_f32 v84, v84, v86
    v_add_f32 v85, v85, v87
    ds_write_b64 v98, v[84:85]
    s_waitcnt lgkmcnt(0)
    s_barrier
    ds_read_b128 v[88:91], v96
    ds_read_b128 v[92:95], v96 offset:16
    s_waitcnt lgkmcnt(0)
    v_add_f32 v84, v88, v90
    v_add_f32 v85, v89, v91
    v_add_f32 v86, v92, v94
    v_add_f32 v87, v93, v95
    v_add_f32 v84, v84, v86
    v_add_f32 v85, v85, v87
    v_mul_f32 v84, 0x3b000000, v84
    v_mul_f32 v86, v84, v84
    v_mul_f32 v85, 0x3b000000, v85
    v_sub_f32 v85, v85, v86
    v_max_f32 v85, 0, v85
    v_cvt_pk_bf16_f32 v86, v84, v85
    v_lshlrev_b32 v84, 16, v86
    v_and_b32 v85, 0xffff0000, v86
    v_sub_f32 v68, v68, v84
    v_sub_f32 v69, v69, v84
    v_add_f32 v85, 0x3727c5ac, v85
    v_cvt_pk_bf16_f32 v60, v68, v69
    v_sub_f32 v70, v70, v84
    v_sub_f32 v71, v71, v84
    v_cvt_pk_bf16_f32 v86, v85, v85
    v_cvt_pk_bf16_f32 v61, v70, v71
    v_sub_f32 v72, v72, v84
    v_sub_f32 v73, v73, v84
    v_lshlrev_b32 v85, 16, v86
    v_cvt_pk_bf16_f32 v62, v72, v73
    v_sub_f32 v74, v74, v84
    v_sub_f32 v75, v75, v84
    v_sqrt_f32 v85, v85
    v_cvt_pk_bf16_f32 v63, v74, v75
    v_sub_f32 v76, v76, v84
    v_sub_f32 v77, v77, v84
    v_cvt_pk_bf16_f32 v86, v85, v85
    v_cvt_pk_bf16_f32 v64, v76, v77
    v_sub_f32 v78, v78, v84
    v_sub_f32 v79, v79, v84
    v_lshlrev_b32 v85, 16, v86
    v_cvt_pk_bf16_f32 v65, v78, v79
    v_sub_f32 v80, v80, v84
    v_sub_f32 v81, v81, v84
    v_rcp_f32 v85, v85
    v_cvt_pk_bf16_f32 v66, v80, v81
    v_sub_f32 v82, v82, v84
    v_sub_f32 v83, v83, v84
    v_cvt_pk_bf16_f32 v67, v82, v83
    v_lshlrev_b32 v68, 16, v60
    v_and_b32 v69, 0xffff0000, v60
    v_lshlrev_b32 v70, 16, v61
    v_and_b32 v71, 0xffff0000, v61
    v_lshlrev_b32 v72, 16, v62
    v_and_b32 v73, 0xffff0000, v62
    v_lshlrev_b32 v74, 16, v63
    v_and_b32 v75, 0xffff0000, v63
    v_lshlrev_b32 v76, 16, v64
    v_and_b32 v77, 0xffff0000, v64
    v_lshlrev_b32 v78, 16, v65
    v_and_b32 v79, 0xffff0000, v65
    v_lshlrev_b32 v80, 16, v66
    v_and_b32 v81, 0xffff0000, v66
    v_lshlrev_b32 v82, 16, v67
    v_and_b32 v83, 0xffff0000, v67
    v_mul_f32 v68, v68, v85
    v_mul_f32 v69, v69, v85
    v_mul_f32 v70, v70, v85
    v_mul_f32 v71, v71, v85
    v_cvt_pk_bf16_f32 v60, v68, v69
    v_mul_f32 v72, v72, v85
    v_mul_f32 v73, v73, v85
    v_cvt_pk_bf16_f32 v61, v70, v71
    v_mul_f32 v74, v74, v85
    v_mul_f32 v75, v75, v85
    v_cvt_pk_bf16_f32 v62, v72, v73
    v_mul_f32 v76, v76, v85
    v_mul_f32 v77, v77, v85
    v_cvt_pk_bf16_f32 v63, v74, v75
    v_mul_f32 v78, v78, v85
    v_mul_f32 v79, v79, v85
    v_cvt_pk_bf16_f32 v64, v76, v77
    v_mul_f32 v80, v80, v85
    v_mul_f32 v81, v81, v85
    v_cvt_pk_bf16_f32 v65, v78, v79
    v_mul_f32 v82, v82, v85
    v_mul_f32 v83, v83, v85
    v_cvt_pk_bf16_f32 v66, v80, v81
    v_cvt_pk_bf16_f32 v67, v82, v83
    buffer_store_dwordx4 v[60:63], v97, s[40:43], s78 offen sc1
    buffer_store_dwordx4 v[64:67], v97, s[40:43], s79 offen sc1
    s_waitcnt vmcnt(5)
    v_readfirstlane_b32 s68, v220
    v_and_b32 v255, 3, v0
    v_lshlrev_b32 v255, 7, v255
    s_lshl_b32 s78, s60, 9
    s_mul_i32 s68, s68, 0x9e3779b9
    s_add_u32 s68, s68, 0x7f4a7c14
    v_add_u32 v255, s78, v255
    s_lshl_b32 s75, s61, 11
    s_add_u32 s75, s75, 131072
    s_waitcnt vmcnt(0)
    s_barrier
    s_cmp_lg_u32 s60, 0
    s_cbranch_scc1 L_fl_14
    s_lshl_b32 s79, s61, 4
    s_add_u32 s79, s79, s62
    s_lshl_b32 s79, s79, 7
    v_mov_b32 v254, s68
    s_add_u32 s79, s79, 131072
    s_mov_b64 exec, 1
    buffer_store_dword v254, off, s[40:43], s79 sc1
    s_mov_b64 exec, -1
L_fl_14:
    s_add_u32 s69, s81, 0
    s_and_b32 s69, s69, 7
    s_lshl_b32 s70, s69, 12
    s_add_u32 s70, s70, s86
    s_mul_i32 s71, s69, 196608
    s_mul_i32 s72, s69, 229376
    s_add_u32 s72, s72, s73
    s_add_u32 m0, s87, 0
    s_nop 0
    buffer_load_dwordx4 v2, s[36:39], s72 offen offset:0 lds
    buffer_load_dwordx4 v3, s[36:39], s72 offen offset:1024 lds
    buffer_load_dwordx4 v4, s[36:39], s72 offen offset:2048 lds
    buffer_load_dwordx4 v5, s[36:39], s72 offen offset:3072 lds
    s_add_u32 m0, s88, 16384
    s_nop 0
    buffer_load_dwordx4 v6, s[32:35], s71 offen offset:0 lds
    buffer_load_dwordx4 v7, s[32:35], s71 offen offset:1024 lds
    s_lshl_b32 s77, s63, 11
    s_lshl_b32 s78, s65, 10
    s_mov_b32 m0, s93
    s_add_u32 s77, s77, s78
    buffer_load_dwordx4 v1, s[56:59], s77 offen lds
    s_add_u32 s69, s81, 1
    s_and_b32 s69, s69, 7
    s_lshl_b32 s70, s69, 12
    s_add_u32 s70, s70, s86
    s_mul_i32 s71, s69, 196608
    s_mul_i32 s72, s69, 229376
    s_add_u32 s72, s72, s73
    s_add_u32 m0, s87, 40960
    s_nop 0
    buffer_load_dwordx4 v2, s[36:39], s72 offen offset:0 lds
    buffer_load_dwordx4 v3, s[36:39], s72 offen offset:1024 lds
    buffer_load_dwordx4 v4, s[36:39], s72 offen offset:2048 lds
    buffer_load_dwordx4 v5, s[36:39], s72 offen offset:3072 lds
    s_add_u32 m0, s88, 57344
    s_nop 0
    buffer_load_dwordx4 v6, s[32:35], s71 offen offset:0 lds
    buffer_load_dwordx4 v7, s[32:35], s71 offen offset:1024 lds
    s_mov_b32 s95, 0x3fb8aa3b
    s_mov_b32 s82, 0x0000ffff
    s_mov_b32 s83, 0x0000ffff
    s_mul_i32 s89, s60, 458752
    s_lshl_b32 s90, s60, 17
    s_lshl_b32 s96, s61, 1
    s_add_u32 s96, s96, s64
    s_mul_i32 s96, s96, 294912
    s_add_u32 s96, s96, 5242880
    s_mul_i32 s27, s60, 6144
    s_add_u32 s27, s27, 16384
    s_lshr_b32 s26, s66, 1
    s_lshl_b32 s26, s26, 11
    v_and_b32 v222, 3, v0
    v_lshlrev_b32 v222, 3, v222
    v_bfe_u32 v223, v0, 2, 2
    v_bfe_u32 v224, v0, 4, 1
    v_lshrrev_b32 v225, 5, v0
    v_lshl_add_u32 v226, v225, 3, v223
    v_and_b32 v227, 2, v223
    s_lshl_b32 s78, s65, 1
    v_xor_b32 v227, s78, v227
    v_xor_b32 v227, v227, v224
    v_lshl_add_u32 v227, v227, 5, v222
    v_lshl_add_u32 v227, v226, 7, v227
    v_lshl_add_u32 v12, v224, 13, v227
    v_xor_b32 v13, 32, v12
    v_add_u32 v14, 81920, v12
    v_add_u32 v15, 81920, v13
    s_lshl_b32 s79, s64, 13
    s_add_u32 s79, s79, 24576
    v_add_u32_e64 v22, s79, v1
    v_add_u32 v23, 81920, v22
    v_add_u32 v16, 16384, v227
    v_add_u32 v19, 81920, v16
    v_lshl_add_u32 v226, v225, 2, v223
    v_and_b32 v227, 2, v223
    v_xor_b32 v227, s78, v227
    v_add_u32 v227, v227, v224
    v_lshl_add_u32 v227, v227, 5, v222
    v_lshl_add_u32 v227, v226, 7, v227
    v_add_u32 v26, s93, v227
    v_xor_b32 v27, 64, v26
    v_add_u32 v52, s27, v227
    v_xor_b32 v53, 64, v52
    v_add_u32 v54, 81920, v52
    v_add_u32 v55, 81920, v53
    s_add_u32 s79, s87, 40960
    v_add_u32 v56, s79, v227
    v_xor_b32 v57, 64, v56
    s_add_u32 s79, s88, 155648
    v_add_u32 v58, s79, v227
    v_xor_b32 v59, 64, v58
    s_lshl_b32 s84, s73, 5
    s_lshl_b32 s79, s65, 11
    s_add_u32 s84, s84, s79
    s_add_u32 s84, s84, s96
    s_lshl_b32 s85, s74, 5
    s_lshl_b32 s79, s65, 11
    s_add_u32 s85, s85, s79
    s_add_u32 s85, s85, s96
    s_lshl_b32 s79, s66, 1
    s_add_u32 s91, s79, s64
    s_xor_b32 s92, s91, 1
    s_mul_i32 s91, s91, 147456
    s_mul_i32 s92, s92, 147456
    s_mul_i32 s79, s60, 28672
    s_add_u32 s79, s79, 5242880
    s_add_u32 s91, s91, s79
    s_add_u32 s92, s92, s79
    v_lshlrev_b32_e64 v226, 5, v226
    v_lshl_add_u32 v226, v224, 4, v226
    v_bfe_u32 v227, v0, 1, 1
    v_lshl_add_u32 v226, v227, 3, v226
    v_add_u32_e64 v226, s93, v226
    v_xor_b32 v227, 512, v226
    v_bfe_i32 v228, v0, 2, 1
    v_and_b32 v228, 0x80008000, v228
    buffer_load_dword v220, v255, s[40:43], s75 offen sc1
    s_waitcnt vmcnt(0)
    v_cmp_ne_u32 vcc, s68, v220
    s_cbranch_vccz L_pd_16
    s_mov_b32 s94, 0
L_pl_15:
    buffer_load_dword v220, v255, s[40:43], s75 offen sc1
    s_add_u32 s94, s94, 1
    s_waitcnt vmcnt(0)
    v_cmp_ne_u32 vcc, s68, v220
    s_cbranch_vccz L_pd_16
    s_cmp_lt_u32 s94, s97
    s_cbranch_scc1 L_pl_15
    s_mov_b32 s97, 0
L_pd_16:
    s_add_u32 s69, s81, 0
    s_and_b32 s69, s69, 7
    s_lshl_b32 s70, s69, 12
    s_add_u32 s70, s70, s86
    s_mul_i32 s71, s69, 196608
    s_mul_i32 s72, s69, 229376
    s_add_u32 s72, s72, s73
    s_add_u32 m0, s87, 24576
    s_nop 0
    buffer_load_dwordx4 v1, s[40:43], s70 offen offset:0 sc1 lds
    buffer_load_dwordx4 v1, s[40:43], s70 offen offset:1024 sc1 lds
    buffer_load_dwordx4 v1, s[40:43], s70 offen offset:2048 sc1 lds
    buffer_load_dwordx4 v1, s[40:43], s70 offen offset:3072 sc1 lds
    s_add_u32 s69, s81, 1
    s_and_b32 s69, s69, 7
    s_lshl_b32 s70, s69, 12
    s_add_u32 s70, s70, s86
    s_mul_i32 s71, s69, 196608
    s_mul_i32 s72, s69, 229376
    s_add_u32 s72, s72, s73
    s_add_u32 m0, s87, 65536
    s_nop 0
    buffer_load_dwordx4 v1, s[40:43], s70 offen offset:0 sc1 lds
    buffer_load_dwordx4 v1, s[40:43], s70 offen offset:1024 sc1 lds
    buffer_load_dwordx4 v1, s[40:43], s70 offen offset:2048 sc1 lds
    buffer_load_dwordx4 v1, s[40:43], s70 offen offset:3072 sc1 lds
    s_waitcnt vmcnt(4)
    s_barrier
    ds_read_b64_tr_b16 v[28:29], v16 offset:0
    ds_read_b64_tr_b16 v[30:31], v16 offset:512
    ds_read_b128 a[0:3], v22 offset:0
    ds_read_b128 a[4:7], v22 offset:4096
    ds_read_b64_tr_b16 v[32:33], v12 offset:0
    ds_read_b64_tr_b16 v[34:35], v12 offset:512
    ds_read_b64_tr_b16 v[36:37], v13 offset:0
    ds_read_b64_tr_b16 v[38:39], v13 offset:512
    s_add_u32 s69, s81, 2
    s_and_b32 s69, s69, 7
    s_lshl_b32 s70, s69, 12
    s_add_u32 s70, s70, s86
    s_mul_i32 s71, s69, 196608
    s_mul_i32 s72, s69, 229376
    s_add_u32 s72, s72, s73
    s_add_u32 m0, s87, 81920
    s_waitcnt lgkmcnt(4)
    v_mfma_f32_32x32x16_bf16 v[60:75], v[28:31], a[0:3], 0
    ds_read_b64_tr_b16 v[40:41], v16 offset:2048
    ds_read_b64_tr_b16 v[42:43], v16 offset:2560
    buffer_load_dwordx4 v2, s[36:39], s72 offen offset:0 lds
    v_mfma_f32_32x32x16_bf16 v[76:91], v[28:31], a[4:7], 0
    ds_read_b128 a[8:11], v22 offset:1024
    ds_read_b128 a[12:15], v22 offset:5120
    s_waitcnt lgkmcnt(6)
    v_mfma_f32_32x32x16_bf16 v[92:107], v[32:35], a[0:3], 0
    ds_read_b64_tr_b16 v[28:29], v12 offset:2048
    ds_read_b64_tr_b16 v[30:31], v12 offset:2560
    buffer_load_dwordx4 v3, s[36:39], s72 offen offset:1024 lds
    v_mfma_f32_32x32x16_bf16 v[108:123], v[32:35], a[4:7], 0
    s_waitcnt lgkmcnt(6)
    v_mfma_f32_32x32x16_bf16 v[124:139], v[36:39], a[0:3], 0
    ds_read_b64_tr_b16 v[32:33], v13 offset:2048
    ds_read_b64_tr_b16 v[34:35], v13 offset:2560
    buffer_load_dwordx4 v4, s[36:39], s72 offen offset:2048 lds
    v_mfma_f32_32x32x16_bf16 v[140:155], v[36:39], a[4:7], 0
    s_waitcnt lgkmcnt(4)
    v_mfma_f32_32x32x16_bf16 v[60:75], v[40:43], a[8:11], v[60:75]
    ds_read_b64_tr_b16 v[36:37], v16 offset:4096
    ds_read_b64_tr_b16 v[38:39], v16 offset:4608
    buffer_load_dwordx4 v5, s[36:39], s72 offen offset:3072 lds
    s_add_u32 m0, s88, 98304
    v_mfma_f32_32x32x16_bf16 v[76:91], v[40:43], a[12:15], v[76:91]
    ds_read_b128 a[16:19], v22 offset:2048
    ds_read_b128 a[20:23], v22 offset:6144
    s_waitcnt lgkmcnt(6)
    v_mfma_f32_32x32x16_bf16 v[92:107], v[28:31], a[8:11], v[92:107]
    ds_read_b64_tr_b16 v[40:41], v12 offset:4096
    ds_read_b64_tr_b16 v[42:43], v12 offset:4608
    buffer_load_dwordx4 v6, s[32:35], s71 offen offset:0 lds
    v_mfma_f32_32x32x16_bf16 v[108:123], v[28:31], a[12:15], v[108:123]
    s_waitcnt lgkmcnt(6)
    v_mfma_f32_32x32x16_bf16 v[124:139], v[32:35], a[8:11], v[124:139]
    ds_read_b64_tr_b16 v[28:29], v13 offset:4096
    ds_read_b64_tr_b16 v[30:31], v13 offset:4608
    buffer_load_dwordx4 v7, s[32:35], s71 offen offset:1024 lds
    s_add_u32 m0, s87, 106496
    v_mfma_f32_32x32x16_bf16 v[140:155], v[32:35], a[12:15], v[140:155]
    s_waitcnt lgkmcnt(4)
    v_mfma_f32_32x32x16_bf16 v[60:75], v[36:39], a[16:19], v[60:75]
    ds_read_b64_tr_b16 v[32:33], v16 offset:6144
    ds_read_b64_tr_b16 v[34:35], v16 offset:6656
    buffer_load_dwordx4 v1, s[40:43], s70 offen offset:0 sc1 lds
    v_mfma_f32_32x32x16_bf16 v[76:91], v[36:39], a[20:23], v[76:91]
    ds_read_b128 a[24:27], v22 offset:3072
    ds_read_b128 a[28:31], v22 offset:7168
    s_waitcnt lgkmcnt(6)
    v_mfma_f32_32x32x16_bf16 v[92:107], v[40:43], a[16:19], v[92:107]
    ds_read_b64_tr_b16 v[36:37], v12 offset:6144
    ds_read_b64_tr_b16 v[38:39], v12 offset:6656
    buffer_load_dwordx4 v1, s[40:43], s70 offen offset:1024 sc1 lds
    v_mfma_f32_32x32x16_bf16 v[108:123], v[40:43], a[20:23], v[108:123]
    s_waitcnt lgkmcnt(6)
    v_mfma_f32_32x32x16_bf16 v[124:139], v[28:31], a[16:19], v[124:139]
    ds_read_b64_tr_b16 v[40:41], v13 offset:6144
    ds_read_b64_tr_b16 v[42:43], v13 offset:6656
    buffer_load_dwordx4 v1, s[40:43], s70 offen offset:2048 sc1 lds
    v_mfma_f32_32x32x16_bf16 v[140:155], v[28:31], a[20:23], v[140:155]
    s_waitcnt lgkmcnt(4)
    v_mfma_f32_32x32x16_bf16 v[60:75], v[32:35], a[24:27], v[60:75]
    buffer_load_dwordx4 v1, s[40:43], s70 offen offset:3072 sc1 lds
    v_mfma_f32_32x32x16_bf16 v[76:91], v[32:35], a[28:31], v[76:91]
    s_waitcnt lgkmcnt(0)
    s_waitcnt vmcnt(10)
    s_barrier
    v_mfma_f32_32x32x16_bf16 v[92:107], v[36:39], a[24:27], v[92:107]
    ds_read_b64_tr_b16 v[28:29], v16 offset:40960
    ds_read_b64_tr_b16 v[30:31], v16 offset:41472
    ds_read_b128 a[32:35], v22 offset:40960
    ds_read_b128 a[36:39], v22 offset:45056
    v_mfma_f32_32x32x16_bf16 v[108:123], v[36:39], a[28:31], v[108:123]
    ds_read_b64_tr_b16 v[32:33], v12 offset:40960
    ds_read_b64_tr_b16 v[34:35], v12 offset:41472
    v_mfma_f32_32x32x16_bf16 v[124:139], v[40:43], a[24:27], v[124:139]
    ds_read_b64_tr_b16 v[36:37], v13 offset:40960
    ds_read_b64_tr_b16 v[38:39], v13 offset:41472
    v_mfma_f32_32x32x16_bf16 v[140:155], v[40:43], a[28:31], v[140:155]
    s_add_u32 s69, s81, 3
    s_and_b32 s69, s69, 7
    s_lshl_b32 s70, s69, 12
    s_add_u32 s70, s70, s86
    s_mul_i32 s71, s69, 196608
    s_mul_i32 s72, s69, 229376
    s_add_u32 s72, s72, s73
    s_add_u32 m0, s87, 0
    s_waitcnt lgkmcnt(4)
    v_mfma_f32_32x32x16_bf16 v[60:75], v[28:31], a[32:35], v[60:75]
    ds_read_b64_tr_b16 v[40:41], v16 offset:43008
    ds_read_b64_tr_b16 v[42:43], v16 offset:43520
    buffer_load_dwordx4 v2, s[36:39], s72 offen offset:0 lds
    v_mfma_f32_32x32x16_bf16 v[76:91], v[28:31], a[36:39], v[76:91]
    ds_read_b128 a[40:43], v22 offset:41984
    ds_read_b128 a[44:47], v22 offset:46080
    s_waitcnt lgkmcnt(6)
    v_mfma_f32_32x32x16_bf16 v[92:107], v[32:35], a[32:35], v[92:107]
    ds_read_b64_tr_b16 v[28:29], v12 offset:43008
    ds_read_b64_tr_b16 v[30:31], v12 offset:43520
    buffer_load_dwordx4 v3, s[36:39], s72 offen offset:1024 lds
    v_mfma_f32_32x32x16_bf16 v[108:123], v[32:35], a[36:39], v[108:123]
    s_waitcnt lgkmcnt(6)
    v_mfma_f32_32x32x16_bf16 v[124:139], v[36:39], a[32:35], v[124:139]
    ds_read_b64_tr_b16 v[32:33], v13 offset:43008
    ds_read_b64_tr_b16 v[34:35], v13 offset:43520
    buffer_load_dwordx4 v4, s[36:39], s72 offen offset:2048 lds
    v_mfma_f32_32x32x16_bf16 v[140:155], v[36:39], a[36:39], v[140:155]
    ds_read_b64_tr_b16 v[44:45], v226 offset:0
    ds_read_b64_tr_b16 v[46:47], v226 offset:256
    ds_read_b64_tr_b16 v[48:49], v227 offset:0
    ds_read_b64_tr_b16 v[50:51], v227 offset:256
    s_waitcnt lgkmcnt(8)
    v_mfma_f32_32x32x16_bf16 v[60:75], v[40:43], a[40:43], v[60:75]
    ds_read_b64_tr_b16 v[36:37], v16 offset:45056
    ds_read_b64_tr_b16 v[38:39], v16 offset:45568
    buffer_load_dwordx4 v5, s[36:39], s72 offen offset:3072 lds
    s_add_u32 m0, s88, 16384
    v_mfma_f32_32x32x16_bf16 v[76:91], v[40:43], a[44:47], v[76:91]
    ds_read_b128 a[48:51], v22 offset:43008
    ds_read_b128 a[52:55], v22 offset:47104
    s_waitcnt lgkmcnt(10)
    v_mfma_f32_32x32x16_bf16 v[92:107], v[28:31], a[40:43], v[92:107]
    ds_read_b64_tr_b16 v[40:41], v12 offset:45056
    ds_read_b64_tr_b16 v[42:43], v12 offset:45568
    buffer_load_dwordx4 v6, s[32:35], s71 offen offset:0 lds
    v_mfma_f32_32x32x16_bf16 v[108:123], v[28:31], a[44:47], v[108:123]
    s_waitcnt lgkmcnt(6)
    v_xor_b32 v44, v44, v228
    v_xor_b32 v45, v45, v228
    v_xor_b32 v46, v46, v228
    v_xor_b32 v47, v47, v228
    v_xor_b32 v48, v48, v228
    v_xor_b32 v49, v49, v228
    v_xor_b32 v50, v50, v228
    v_xor_b32 v51, v51, v228
    v_mfma_f32_32x32x16_bf16 v[124:139], v[32:35], a[40:43], v[124:139]
    ds_read_b64_tr_b16 v[28:29], v13 offset:45056
    ds_read_b64_tr_b16 v[30:31], v13 offset:45568
    buffer_load_dwordx4 v7, s[32:35], s71 offen offset:1024 lds
    s_add_u32 m0, s87, 24576
    v_mfma_f32_32x32x16_bf16 v[140:155], v[32:35], a[44:47], v[140:155]
    s_waitcnt lgkmcnt(4)
    v_mfma_f32_32x32x16_bf16 v[60:75], v[36:39], a[48:51], v[60:75]
    ds_read_b64_tr_b16 v[32:33], v16 offset:47104
    ds_read_b64_tr_b16 v[34:35], v16 offset:47616
    buffer_load_dwordx4 v1, s[40:43], s70 offen offset:0 sc1 lds
    v_mfma_f32_32x32x16_bf16 v[76:91], v[36:39], a[52:55], v[76:91]
    ds_read_b128 a[56:59], v22 offset:44032
    ds_read_b128 a[60:63], v22 offset:48128
    s_waitcnt lgkmcnt(6)
    v_mfma_f32_32x32x16_bf16 v[92:107], v[40:43], a[48:51], v[92:107]
    ds_read_b64_tr_b16 v[36:37], v12 offset:47104
    ds_read_b64_tr_b16 v[38:39], v12 offset:47616
    buffer_load_dwordx4 v1, s[40:43], s70 offen offset:1024 sc1 lds
    v_mfma_f32_32x32x16_bf16 v[108:123], v[40:43], a[52:55], v[108:123]
    s_waitcnt lgkmcnt(6)
    v_mfma_f32_32x32x16_bf16 v[124:139], v[28:31], a[48:51], v[124:139]
    ds_read_b64_tr_b16 v[40:41], v13 offset:47104
    ds_read_b64_tr_b16 v[42:43], v13 offset:47616
    buffer_load_dwordx4 v1, s[40:43], s70 offen offset:2048 sc1 lds
    v_mfma_f32_32x32x16_bf16 v[140:155], v[28:31], a[52:55], v[140:155]
    s_waitcnt lgkmcnt(4)
    v_mfma_f32_32x32x16_bf16 v[60:75], v[32:35], a[56:59], v[60:75]
    buffer_load_dwordx4 v1, s[40:43], s70 offen offset:3072 sc1 lds
    v_mfma_f32_32x32x16_bf16 v[76:91], v[32:35], a[60:63], v[76:91]
    s_waitcnt lgkmcnt(0)
    s_waitcnt vmcnt(10)
    s_barrier
    v_mfma_f32_32x32x16_bf16 v[92:107], v[36:39], a[56:59], v[92:107]
    ds_read_b64_tr_b16 v[28:29], v19 offset:0
    ds_read_b64_tr_b16 v[30:31], v19 offset:512
    ds_read_b128 a[64:67], v23 offset:0
    ds_read_b128 a[68:71], v23 offset:4096
    v_mfma_f32_32x32x16_bf16 v[108:123], v[36:39], a[60:63], v[108:123]
    ds_read_b64_tr_b16 v[32:33], v14 offset:0
    ds_read_b64_tr_b16 v[34:35], v14 offset:512
    v_mfma_f32_32x32x16_bf16 v[124:139], v[40:43], a[56:59], v[124:139]
    ds_read_b64_tr_b16 v[36:37], v15 offset:0
    ds_read_b64_tr_b16 v[38:39], v15 offset:512
    v_mfma_f32_32x32x16_bf16 v[140:155], v[40:43], a[60:63], v[140:155]
    s_add_u32 s69, s81, 4
    s_and_b32 s69, s69, 7
    s_lshl_b32 s70, s69, 12
    s_add_u32 s70, s70, s86
    s_mul_i32 s71, s69, 196608
    s_mul_i32 s72, s69, 229376
    s_add_u32 s72, s72, s73
    s_add_u32 m0, s87, 40960
    s_waitcnt lgkmcnt(4)
    v_mfma_f32_32x32x16_bf16 v[60:75], v[28:31], a[64:67], v[60:75]
    ds_read_b64_tr_b16 v[40:41], v19 offset:2048
    ds_read_b64_tr_b16 v[42:43], v19 offset:2560
    buffer_load_dwordx4 v2, s[36:39], s72 offen offset:0 lds
    v_mfma_f32_32x32x16_bf16 v[76:91], v[28:31], a[68:71], v[76:91]
    ds_read_b128 a[72:75], v23 offset:1024
    ds_read_b128 a[76:79], v23 offset:5120
    s_waitcnt lgkmcnt(6)
    v_mfma_f32_32x32x16_bf16 v[92:107], v[32:35], a[64:67], v[92:107]
    ds_read_b64_tr_b16 v[28:29], v14 offset:2048
    ds_read_b64_tr_b16 v[30:31], v14 offset:2560
    buffer_load_dwordx4 v3, s[36:39], s72 offen offset:1024 lds
    v_mfma_f32_32x32x16_bf16 v[108:123], v[32:35], a[68:71], v[108:123]
    s_waitcnt lgkmcnt(6)
    v_mfma_f32_32x32x16_bf16 v[124:139], v[36:39], a[64:67], v[124:139]
    ds_read_b64_tr_b16 v[32:33], v15 offset:2048
    ds_read_b64_tr_b16 v[34:35], v15 offset:2560
    buffer_load_dwordx4 v4, s[36:39], s72 offen offset:2048 lds
    v_mfma_f32_32x32x16_bf16 v[140:155], v[36:39], a[68:71], v[140:155]
    s_waitcnt lgkmcnt(4)
    v_mfma_f32_32x32x16_bf16 v[60:75], v[40:43], a[72:75], v[60:75]
    ds_read_b64_tr_b16 v[36:37], v19 offset:4096
    ds_read_b64_tr_b16 v[38:39], v19 offset:4608
    buffer_load_dwordx4 v5, s[36:39], s72 offen offset:3072 lds
    s_add_u32 m0, s88, 57344
    v_mfma_f32_32x32x16_bf16 v[76:91], v[40:43], a[76:79], v[76:91]
    ds_read_b128 a[80:83], v23 offset:2048
    ds_read_b128 a[84:87], v23 offset:6144
    s_waitcnt lgkmcnt(6)
    v_mfma_f32_32x32x16_bf16 v[92:107], v[28:31], a[72:75], v[92:107]
    ds_read_b64_tr_b16 v[40:41], v14 offset:4096
    ds_read_b64_tr_b16 v[42:43], v14 offset:4608
    buffer_load_dwordx4 v6, s[32:35], s71 offen offset:0 lds
    v_mfma_f32_32x32x16_bf16 v[108:123], v[28:31], a[76:79], v[108:123]
    s_waitcnt lgkmcnt(6)
    v_mfma_f32_32x32x16_bf16 v[124:139], v[32:35], a[72:75], v[124:139]
    ds_read_b64_tr_b16 v[28:29], v15 offset:4096
    ds_read_b64_tr_b16 v[30:31], v15 offset:4608
    buffer_load_dwordx4 v7, s[32:35], s71 offen offset:1024 lds
    s_add_u32 m0, s87, 65536
    v_mfma_f32_32x32x16_bf16 v[140:155], v[32:35], a[76:79], v[140:155]
    s_waitcnt lgkmcnt(4)
    v_mfma_f32_32x32x16_bf16 v[60:75], v[36:39], a[80:83], v[60:75]
    ds_read_b64_tr_b16 v[32:33], v19 offset:6144
    ds_read_b64_tr_b16 v[34:35], v19 offset:6656
    buffer_load_dwordx4 v1, s[40:43], s70 offen offset:0 sc1 lds
    v_mfma_f32_32x32x16_bf16 v[76:91], v[36:39], a[84:87], v[76:91]
    ds_read_b128 a[88:91], v23 offset:3072
    ds_read_b128 a[92:95], v23 offset:7168
    s_waitcnt lgkmcnt(6)
    v_mfma_f32_32x32x16_bf16 v[92:107], v[40:43], a[80:83], v[92:107]
    ds_read_b64_tr_b16 v[36:37], v14 offset:6144
    ds_read_b64_tr_b16 v[38:39], v14 offset:6656
    buffer_load_dwordx4 v1, s[40:43], s70 offen offset:1024 sc1 lds
    v_mfma_f32_32x32x16_bf16 v[108:123], v[40:43], a[84:87], v[108:123]
    s_waitcnt lgkmcnt(6)
    v_mfma_f32_32x32x16_bf16 v[124:139], v[28:31], a[80:83], v[124:139]
    ds_read_b64_tr_b16 v[40:41], v15 offset:6144
    ds_read_b64_tr_b16 v[42:43], v15 offset:6656
    buffer_load_dwordx4 v1, s[40:43], s70 offen offset:2048 sc1 lds
    v_mfma_f32_32x32x16_bf16 v[140:155], v[28:31], a[84:87], v[140:155]
    s_waitcnt lgkmcnt(4)
    v_mfma_f32_32x32x16_bf16 v[60:75], v[32:35], a[88:91], v[60:75]
    buffer_load_dwordx4 v1, s[40:43], s70 offen offset:3072 sc1 lds
    v_mfma_f32_32x32x16_bf16 v[76:91], v[32:35], a[92:95], v[76:91]
    s_xor_b32 s78, s2, 0
    s_lshl_b32 s78, s78, 2
    s_add_u32 s78, s78, s60
    s_mul_i32 s79, s78, 1792
    s_lshl_b32 s78, s78, 9
    v_lshlrev_b32 v229, 3, v1
    s_mov_b64 exec, 0x3fff
    buffer_load_dword v246, v229, s[44:47], s79 offen
    s_mov_b64 exec, 0xf
    buffer_load_dword v247, v229, s[48:51], s78 offen
    s_mov_b64 exec, -1
    s_waitcnt lgkmcnt(0)
    s_waitcnt vmcnt(12)
    s_barrier
    v_mfma_f32_32x32x16_bf16 v[92:107], v[36:39], a[88:91], v[92:107]
    ds_read_b64_tr_b16 v[28:29], v16 offset:0
    ds_read_b64_tr_b16 v[30:31], v16 offset:512
    ds_read_b128 a[96:99], v22 offset:0
    ds_read_b128 a[100:103], v22 offset:4096
    v_mfma_f32_32x32x16_bf16 v[108:123], v[36:39], a[92:95], v[108:123]
    ds_read_b64_tr_b16 v[32:33], v12 offset:0
    ds_read_b64_tr_b16 v[34:35], v12 offset:512
    v_mfma_f32_32x32x16_bf16 v[124:139], v[40:43], a[88:91], v[124:139]
    ds_read_b64_tr_b16 v[36:37], v13 offset:0
    ds_read_b64_tr_b16 v[38:39], v13 offset:512
    v_mfma_f32_32x32x16_bf16 v[140:155], v[40:43], a[92:95], v[140:155]
    s_add_u32 s69, s81, 5
    s_and_b32 s69, s69, 7
    s_lshl_b32 s70, s69, 12
    s_add_u32 s70, s70, s86
    s_mul_i32 s71, s69, 196608
    s_mul_i32 s72, s69, 229376
    s_add_u32 s72, s72, s73
    s_add_u32 m0, s87, 81920
    s_waitcnt lgkmcnt(4)
    v_mfma_f32_32x32x16_bf16 v[60:75], v[28:31], a[96:99], v[60:75]
    ds_read_b64_tr_b16 v[40:41], v16 offset:2048
    ds_read_b64_tr_b16 v[42:43], v16 offset:2560
    buffer_load_dwordx4 v2, s[36:39], s72 offen offset:0 lds
    v_mfma_f32_32x32x16_bf16 v[76:91], v[28:31], a[100:103], v[76:91]
    ds_read_b128 a[104:107], v22 offset:1024
    ds_read_b128 a[108:111], v22 offset:5120
    s_waitcnt lgkmcnt(6)
    v_mfma_f32_32x32x16_bf16 v[92:107], v[32:35], a[96:99], v[92:107]
    ds_read_b64_tr_b16 v[28:29], v12 offset:2048
    ds_read_b64_tr_b16 v[30:31], v12 offset:2560
    buffer_load_dwordx4 v3, s[36:39], s72 offen offset:1024 lds
    v_mfma_f32_32x32x16_bf16 v[108:123], v[32:35], a[100:103], v[108:123]
    s_waitcnt lgkmcnt(6)
    v_mfma_f32_32x32x16_bf16 v[124:139], v[36:39], a[96:99], v[124:139]
    ds_read_b64_tr_b16 v[32:33], v13 offset:2048
    ds_read_b64_tr_b16 v[34:35], v13 offset:2560
    buffer_load_dwordx4 v4, s[36:39], s72 offen offset:2048 lds
    v_mfma_f32_32x32x16_bf16 v[140:155], v[36:39], a[100:103], v[140:155]
    s_waitcnt lgkmcnt(4)
    v_mfma_f32_32x32x16_bf16 v[60:75], v[40:43], a[104:107], v[60:75]
    ds_read_b64_tr_b16 v[36:37], v16 offset:4096
    ds_read_b64_tr_b16 v[38:39], v16 offset:4608
    buffer_load_dwordx4 v5, s[36:39], s72 offen offset:3072 lds
    s_add_u32 m0, s88, 98304
    v_mfma_f32_32x32x16_bf16 v[76:91], v[40:43], a[108:111], v[76:91]
    ds_read_b128 a[112:115], v22 offset:2048
    ds_read_b128 a[116:119], v22 offset:6144
    s_waitcnt lgkmcnt(6)
    v_mfma_f32_32x32x16_bf16 v[92:107], v[28:31], a[104:107], v[92:107]
    ds_read_b64_tr_b16 v[40:41], v12 offset:4096
    ds_read_b64_tr_b16 v[42:43], v12 offset:4608
    buffer_load_dwordx4 v6, s[32:35], s71 offen offset:0 lds
    v_mfma_f32_32x32x16_bf16 v[108:123], v[28:31], a[108:111], v[108:123]
    s_waitcnt lgkmcnt(6)
    v_mfma_f32_32x32x16_bf16 v[124:139], v[32:35], a[104:107], v[124:139]
    ds_read_b64_tr_b16 v[28:29], v13 offset:4096
    ds_read_b64_tr_b16 v[30:31], v13 offset:4608
    buffer_load_dwordx4 v7, s[32:35], s71 offen offset:1024 lds
    s_add_u32 m0, s87, 106496
    v_mfma_f32_32x32x16_bf16 v[140:155], v[32:35], a[108:111], v[140:155]
    s_waitcnt lgkmcnt(4)
    v_mfma_f32_32x32x16_bf16 v[60:75], v[36:39], a[112:115], v[60:75]
    ds_read_b64_tr_b16 v[32:33], v16 offset:6144
    ds_read_b64_tr_b16 v[34:35], v16 offset:6656
    buffer_load_dwordx4 v1, s[40:43], s70 offen offset:0 sc1 lds
    v_mfma_f32_32x32x16_bf16 v[76:91], v[36:39], a[116:119], v[76:91]
    ds_read_b128 a[120:123], v22 offset:3072
    ds_read_b128 a[124:127], v22 offset:7168
    s_waitcnt lgkmcnt(6)
    v_mfma_f32_32x32x16_bf16 v[92:107], v[40:43], a[112:115], v[92:107]
    ds_read_b64_tr_b16 v[36:37], v12 offset:6144
    ds_read_b64_tr_b16 v[38:39], v12 offset:6656
    buffer_load_dwordx4 v1, s[40:43], s70 offen offset:1024 sc1 lds
    v_mfma_f32_32x32x16_bf16 v[108:123], v[40:43], a[116:119], v[108:123]
    s_waitcnt lgkmcnt(6)
    v_mfma_f32_32x32x16_bf16 v[124:139], v[28:31], a[112:115], v[124:139]
    ds_read_b64_tr_b16 v[40:41], v13 offset:6144
    ds_read_b64_tr_b16 v[42:43], v13 offset:6656
    buffer_load_dwordx4 v1, s[40:43], s70 offen offset:2048 sc1 lds
    v_mfma_f32_32x32x16_bf16 v[140:155], v[28:31], a[116:119], v[140:155]
    s_waitcnt lgkmcnt(4)
    v_mfma_f32_32x32x16_bf16 v[60:75], v[32:35], a[120:123], v[60:75]
    buffer_load_dwordx4 v1, s[40:43], s70 offen offset:3072 sc1 lds
    v_mfma_f32_32x32x16_bf16 v[76:91], v[32:35], a[124:127], v[76:91]
    s_waitcnt lgkmcnt(0)
    s_waitcnt vmcnt(12)
    s_barrier
    v_mfma_f32_32x32x16_bf16 v[92:107], v[36:39], a[120:123], v[92:107]
    ds_read_b64_tr_b16 v[28:29], v16 offset:40960
    ds_read_b64_tr_b16 v[30:31], v16 offset:41472
    ds_read_b128 a[128:131], v22 offset:40960
    ds_read_b128 a[132:135], v22 offset:45056
    v_mfma_f32_32x32x16_bf16 v[108:123], v[36:39], a[124:127], v[108:123]
    ds_read_b64_tr_b16 v[32:33], v12 offset:40960
    ds_read_b64_tr_b16 v[34:35], v12 offset:41472
    v_mfma_f32_32x32x16_bf16 v[124:139], v[40:43], a[120:123], v[124:139]
    ds_read_b64_tr_b16 v[36:37], v13 offset:40960
    ds_read_b64_tr_b16 v[38:39], v13 offset:41472
    v_mfma_f32_32x32x16_bf16 v[140:155], v[40:43], a[124:127], v[140:155]
    s_add_u32 s69, s81, 6
    s_and_b32 s69, s69, 7
    s_lshl_b32 s70, s69, 12
    s_add_u32 s70, s70, s86
    s_mul_i32 s71, s69, 196608
    s_mul_i32 s72, s69, 229376
    s_add_u32 s72, s72, s73
    s_add_u32 m0, s87, 0
    s_waitcnt lgkmcnt(4)
    v_mfma_f32_32x32x16_bf16 v[60:75], v[28:31], a[128:131], v[60:75]
    ds_read_b64_tr_b16 v[40:41], v16 offset:43008
    ds_read_b64_tr_b16 v[42:43], v16 offset:43520
    buffer_load_dwordx4 v2, s[36:39], s72 offen offset:0 lds
    v_mfma_f32_32x32x16_bf16 v[76:91], v[28:31], a[132:135], v[76:91]
    ds_read_b128 a[136:139], v22 offset:41984
    ds_read_b128 a[140:143], v22 offset:46080
    s_waitcnt lgkmcnt(6)
    v_mfma_f32_32x32x16_bf16 v[92:107], v[32:35], a[128:131], v[92:107]
    ds_read_b64_tr_b16 v[28:29], v12 offset:43008
    ds_read_b64_tr_b16 v[30:31], v12 offset:43520
    buffer_load_dwordx4 v3, s[36:39], s72 offen offset:1024 lds
    v_mfma_f32_32x32x16_bf16 v[108:123], v[32:35], a[132:135], v[108:123]
    s_waitcnt lgkmcnt(6)
    v_mfma_f32_32x32x16_bf16 v[124:139], v[36:39], a[128:131], v[124:139]
    ds_read_b64_tr_b16 v[32:33], v13 offset:43008
    ds_read_b64_tr_b16 v[34:35], v13 offset:43520
    buffer_load_dwordx4 v4, s[36:39], s72 offen offset:2048 lds
    v_mfma_f32_32x32x16_bf16 v[140:155], v[36:39], a[132:135], v[140:155]
    s_waitcnt lgkmcnt(4)
    v_mfma_f32_32x32x16_bf16 v[60:75], v[40:43], a[136:139], v[60:75]
    ds_read_b64_tr_b16 v[36:37], v16 offset:45056
    ds_read_b64_tr_b16 v[38:39], v16 offset:45568
    buffer_load_dwordx4 v5, s[36:39], s72 offen offset:3072 lds
    s_add_u32 m0, s88, 16384
    v_mfma_f32_32x32x16_bf16 v[76:91], v[40:43], a[140:143], v[76:91]
    ds_read_b128 a[144:147], v22 offset:43008
    ds_read_b128 a[148:151], v22 offset:47104
    s_waitcnt lgkmcnt(6)
    v_mfma_f32_32x32x16_bf16 v[92:107], v[28:31], a[136:139], v[92:107]
    ds_read_b64_tr_b16 v[40:41], v12 offset:45056
    ds_read_b64_tr_b16 v[42:43], v12 offset:45568
    buffer_load_dwordx4 v6, s[32:35], s71 offen offset:0 lds
    v_mfma_f32_32x32x16_bf16 v[108:123], v[28:31], a[140:143], v[108:123]
    s_waitcnt lgkmcnt(6)
    v_mfma_f32_32x32x16_bf16 v[124:139], v[32:35], a[136:139], v[124:139]
    ds_read_b64_tr_b16 v[28:29], v13 offset:45056
    ds_read_b64_tr_b16 v[30:31], v13 offset:45568
    buffer_load_dwordx4 v7, s[32:35], s71 offen offset:1024 lds
    s_add_u32 m0, s87, 24576
    v_mfma_f32_32x32x16_bf16 v[140:155], v[32:35], a[140:143], v[140:155]
    s_waitcnt lgkmcnt(4)
    v_mfma_f32_32x32x16_bf16 v[60:75], v[36:39], a[144:147], v[60:75]
    ds_read_b64_tr_b16 v[32:33], v16 offset:47104
    ds_read_b64_tr_b16 v[34:35], v16 offset:47616
    buffer_load_dwordx4 v1, s[40:43], s70 offen offset:0 sc1 lds
    v_mfma_f32_32x32x16_bf16 v[76:91], v[36:39], a[148:151], v[76:91]
    ds_read_b128 a[152:155], v22 offset:44032
    ds_read_b128 a[156:159], v22 offset:48128
    s_waitcnt lgkmcnt(6)
    v_mfma_f32_32x32x16_bf16 v[92:107], v[40:43], a[144:147], v[92:107]
    ds_read_b64_tr_b16 v[36:37], v12 offset:47104
    ds_read_b64_tr_b16 v[38:39], v12 offset:47616
    buffer_load_dwordx4 v1, s[40:43], s70 offen offset:1024 sc1 lds
    v_mfma_f32_32x32x16_bf16 v[108:123], v[40:43], a[148:151], v[108:123]
    s_waitcnt lgkmcnt(6)
    v_mfma_f32_32x32x16_bf16 v[124:139], v[28:31], a[144:147], v[124:139]
    ds_read_b64_tr_b16 v[40:41], v13 offset:47104
    ds_read_b64_tr_b16 v[42:43], v13 offset:47616
    buffer_load_dwordx4 v1, s[40:43], s70 offen offset:2048 sc1 lds
    v_mfma_f32_32x32x16_bf16 v[140:155], v[28:31], a[148:151], v[140:155]
    s_waitcnt lgkmcnt(4)
    v_mfma_f32_32x32x16_bf16 v[60:75], v[32:35], a[152:155], v[60:75]
    buffer_load_dwordx4 v1, s[40:43], s70 offen offset:3072 sc1 lds
    v_mfma_f32_32x32x16_bf16 v[76:91], v[32:35], a[156:159], v[76:91]
    s_waitcnt lgkmcnt(0)
    s_waitcnt vmcnt(10)
    s_barrier
    v_mfma_f32_32x32x16_bf16 v[92:107], v[36:39], a[152:155], v[92:107]
    ds_read_b64_tr_b16 v[28:29], v19 offset:0
    ds_read_b64_tr_b16 v[30:31], v19 offset:512
    ds_read_b128 a[160:163], v23 offset:0
    ds_read_b128 a[164:167], v23 offset:4096
    v_mfma_f32_32x32x16_bf16 v[108:123], v[36:39], a[156:159], v[108:123]
    ds_read_b64_tr_b16 v[32:33], v14 offset:0
    ds_read_b64_tr_b16 v[34:35], v14 offset:512
    v_mfma_f32_32x32x16_bf16 v[124:139], v[40:43], a[152:155], v[124:139]
    ds_read_b64_tr_b16 v[36:37], v15 offset:0
    ds_read_b64_tr_b16 v[38:39], v15 offset:512
    v_mfma_f32_32x32x16_bf16 v[140:155], v[40:43], a[156:159], v[140:155]
    s_add_u32 s69, s81, 7
    s_and_b32 s69, s69, 7
    s_lshl_b32 s70, s69, 12
    s_add_u32 s70, s70, s86
    s_mul_i32 s71, s69, 196608
    s_mul_i32 s72, s69, 229376
    s_add_u32 s72, s72, s73
    s_add_u32 m0, s87, 40960
    s_waitcnt lgkmcnt(4)
    v_mfma_f32_32x32x16_bf16 v[60:75], v[28:31], a[160:163], v[60:75]
    ds_read_b64_tr_b16 v[40:41], v19 offset:2048
    ds_read_b64_tr_b16 v[42:43], v19 offset:2560
    buffer_load_dwordx4 v2, s[36:39], s72 offen offset:0 lds
    v_mfma_f32_32x32x16_bf16 v[76:91], v[28:31], a[164:167], v[76:91]
    ds_read_b128 a[168:171], v23 offset:1024
    ds_read_b128 a[172:175], v23 offset:5120
    s_waitcnt lgkmcnt(6)
    v_mfma_f32_32x32x16_bf16 v[92:107], v[32:35], a[160:163], v[92:107]
    ds_read_b64_tr_b16 v[28:29], v14 offset:2048
    ds_read_b64_tr_b16 v[30:31], v14 offset:2560
    buffer_load_dwordx4 v3, s[36:39], s72 offen offset:1024 lds
    v_mfma_f32_32x32x16_bf16 v[108:123], v[32:35], a[164:167], v[108:123]
    s_waitcnt lgkmcnt(6)
    v_mfma_f32_32x32x16_bf16 v[124:139], v[36:39], a[160:163], v[124:139]
    ds_read_b64_tr_b16 v[32:33], v15 offset:2048
    ds_read_b64_tr_b16 v[34:35], v15 offset:2560
    buffer_load_dwordx4 v4, s[36:39], s72 offen offset:2048 lds
    v_mfma_f32_32x32x16_bf16 v[140:155], v[36:39], a[164:167], v[140:155]
    s_waitcnt lgkmcnt(4)
    v_mfma_f32_32x32x16_bf16 v[60:75], v[40:43], a[168:171], v[60:75]
    ds_read_b64_tr_b16 v[36:37], v19 offset:4096
    ds_read_b64_tr_b16 v[38:39], v19 offset:4608
    buffer_load_dwordx4 v5, s[36:39], s72 offen offset:3072 lds
    s_add_u32 m0, s88, 57344
    v_mfma_f32_32x32x16_bf16 v[76:91], v[40:43], a[172:175], v[76:91]
    ds_read_b128 a[176:179], v23 offset:2048
    ds_read_b128 a[180:183], v23 offset:6144
    s_waitcnt lgkmcnt(6)
    v_mfma_f32_32x32x16_bf16 v[92:107], v[28:31], a[168:171], v[92:107]
    ds_read_b64_tr_b16 v[40:41], v14 offset:4096
    ds_read_b64_tr_b16 v[42:43], v14 offset:4608
    buffer_load_dwordx4 v6, s[32:35], s71 offen offset:0 lds
    v_mfma_f32_32x32x16_bf16 v[108:123], v[28:31], a[172:175], v[108:123]
    s_waitcnt lgkmcnt(6)
    v_mfma_f32_32x32x16_bf16 v[124:139], v[32:35], a[168:171], v[124:139]
    ds_read_b64_tr_b16 v[28:29], v15 offset:4096
    ds_read_b64_tr_b16 v[30:31], v15 offset:4608
    buffer_load_dwordx4 v7, s[32:35], s71 offen offset:1024 lds
    s_add_u32 m0, s87, 65536
    v_mfma_f32_32x32x16_bf16 v[140:155], v[32:35], a[172:175], v[140:155]
    s_waitcnt lgkmcnt(4)
    v_mfma_f32_32x32x16_bf16 v[60:75], v[36:39], a[176:179], v[60:75]
    ds_read_b64_tr_b16 v[32:33], v19 offset:6144
    ds_read_b64_tr_b16 v[34:35], v19 offset:6656
    buffer_load_dwordx4 v1, s[40:43], s70 offen offset:0 sc1 lds
    v_mfma_f32_32x32x16_bf16 v[76:91], v[36:39], a[180:183], v[76:91]
    ds_read_b128 a[184:187], v23 offset:3072
    ds_read_b128 a[188:191], v23 offset:7168
    s_waitcnt lgkmcnt(6)
    v_mfma_f32_32x32x16_bf16 v[92:107], v[40:43], a[176:179], v[92:107]
    ds_read_b64_tr_b16 v[36:37], v14 offset:6144
    ds_read_b64_tr_b16 v[38:39], v14 offset:6656
    buffer_load_dwordx4 v1, s[40:43], s70 offen offset:1024 sc1 lds
    v_mfma_f32_32x32x16_bf16 v[108:123], v[40:43], a[180:183], v[108:123]
    s_waitcnt lgkmcnt(6)
    v_mfma_f32_32x32x16_bf16 v[124:139], v[28:31], a[176:179], v[124:139]
    ds_read_b64_tr_b16 v[40:41], v15 offset:6144
    ds_read_b64_tr_b16 v[42:43], v15 offset:6656
    buffer_load_dwordx4 v1, s[40:43], s70 offen offset:2048 sc1 lds
    v_mfma_f32_32x32x16_bf16 v[140:155], v[28:31], a[180:183], v[140:155]
    s_waitcnt lgkmcnt(4)
    v_mfma_f32_32x32x16_bf16 v[60:75], v[32:35], a[184:187], v[60:75]
    buffer_load_dwordx4 v1, s[40:43], s70 offen offset:3072 sc1 lds
    v_mfma_f32_32x32x16_bf16 v[76:91], v[32:35], a[188:191], v[76:91]
    s_waitcnt lgkmcnt(0)
    s_waitcnt vmcnt(10)
    s_barrier
    v_mfma_f32_32x32x16_bf16 v[92:107], v[36:39], a[184:187], v[92:107]
    ds_read_b64_tr_b16 v[28:29], v16 offset:0
    ds_read_b64_tr_b16 v[30:31], v16 offset:512
    ds_read_b128 a[192:195], v22 offset:0
    ds_read_b128 a[196:199], v22 offset:4096
    v_mfma_f32_32x32x16_bf16 v[108:123], v[36:39], a[188:191], v[108:123]
    ds_read_b64_tr_b16 v[32:33], v12 offset:0
    ds_read_b64_tr_b16 v[34:35], v12 offset:512
    v_mfma_f32_32x32x16_bf16 v[124:139], v[40:43], a[184:187], v[124:139]
    ds_read_b64_tr_b16 v[36:37], v13 offset:0
    ds_read_b64_tr_b16 v[38:39], v13 offset:512
    v_mfma_f32_32x32x16_bf16 v[140:155], v[40:43], a[188:191], v[140:155]
    s_add_u32 s69, s81, 0
    s_and_b32 s69, s69, 7
    s_mul_i32 s72, s69, 229376
    s_add_u32 s72, s72, s74
    s_add_u32 m0, s87, 81920
    s_waitcnt lgkmcnt(4)
    v_mfma_f32_32x32x16_bf16 v[60:75], v[28:31], a[192:195], v[60:75]
    ds_read_b64_tr_b16 v[40:41], v16 offset:2048
    ds_read_b64_tr_b16 v[42:43], v16 offset:2560
    buffer_load_dwordx4 v2, s[36:39], s72 offen offset:0 lds
    v_mfma_f32_32x32x16_bf16 v[76:91], v[28:31], a[196:199], v[76:91]
    ds_read_b128 a[200:203], v22 offset:1024
    ds_read_b128 a[204:207], v22 offset:5120
    s_waitcnt lgkmcnt(6)
    v_mfma_f32_32x32x16_bf16 v[92:107], v[32:35], a[192:195], v[92:107]
    ds_read_b64_tr_b16 v[28:29], v12 offset:2048
    ds_read_b64_tr_b16 v[30:31], v12 offset:2560
    v_mfma_f32_32x32x16_bf16 v[108:123], v[32:35], a[196:199], v[108:123]
    s_waitcnt lgkmcnt(6)
    v_mfma_f32_32x32x16_bf16 v[124:139], v[36:39], a[192:195], v[124:139]
    ds_read_b64_tr_b16 v[32:33], v13 offset:2048
    ds_read_b64_tr_b16 v[34:35], v13 offset:2560
    v_mfma_f32_32x32x16_bf16 v[140:155], v[36:39], a[196:199], v[140:155]
    buffer_load_dwordx4 v3, s[36:39], s72 offen offset:1024 lds
    s_waitcnt lgkmcnt(4)
    v_mfma_f32_32x32x16_bf16 v[60:75], v[40:43], a[200:203], v[60:75]
    ds_read_b64_tr_b16 v[36:37], v16 offset:4096
    ds_read_b64_tr_b16 v[38:39], v16 offset:4608
    v_mfma_f32_32x32x16_bf16 v[76:91], v[40:43], a[204:207], v[76:91]
    ds_read_b128 a[208:211], v22 offset:2048
    ds_read_b128 a[212:215], v22 offset:6144
    s_waitcnt lgkmcnt(6)
    v_mfma_f32_32x32x16_bf16 v[92:107], v[28:31], a[200:203], v[92:107]
    ds_read_b64_tr_b16 v[40:41], v12 offset:4096
    ds_read_b64_tr_b16 v[42:43], v12 offset:4608
    v_mfma_f32_32x32x16_bf16 v[108:123], v[28:31], a[204:207], v[108:123]
    s_waitcnt lgkmcnt(6)
    v_mfma_f32_32x32x16_bf16 v[124:139], v[32:35], a[200:203], v[124:139]
    ds_read_b64_tr_b16 v[28:29], v13 offset:4096
    ds_read_b64_tr_b16 v[30:31], v13 offset:4608
    buffer_load_dwordx4 v4, s[36:39], s72 offen offset:2048 lds
    v_mfma_f32_32x32x16_bf16 v[140:155], v[32:35], a[204:207], v[140:155]
    s_waitcnt lgkmcnt(4)
    v_mfma_f32_32x32x16_bf16 v[60:75], v[36:39], a[208:211], v[60:75]
    ds_read_b64_tr_b16 v[32:33], v16 offset:6144
    ds_read_b64_tr_b16 v[34:35], v16 offset:6656
    v_mfma_f32_32x32x16_bf16 v[76:91], v[36:39], a[212:215], v[76:91]
    ds_read_b128 a[216:219], v22 offset:3072
    ds_read_b128 a[220:223], v22 offset:7168
    s_waitcnt lgkmcnt(6)
    v_mfma_f32_32x32x16_bf16 v[92:107], v[40:43], a[208:211], v[92:107]
    ds_read_b64_tr_b16 v[36:37], v12 offset:6144
    ds_read_b64_tr_b16 v[38:39], v12 offset:6656
    v_mfma_f32_32x32x16_bf16 v[108:123], v[40:43], a[212:215], v[108:123]
    buffer_load_dwordx4 v5, s[36:39], s72 offen offset:3072 lds
    s_waitcnt lgkmcnt(6)
    v_mfma_f32_32x32x16_bf16 v[124:139], v[28:31], a[208:211], v[124:139]
    ds_read_b64_tr_b16 v[40:41], v13 offset:6144
    ds_read_b64_tr_b16 v[42:43], v13 offset:6656
    v_mfma_f32_32x32x16_bf16 v[140:155], v[28:31], a[212:215], v[140:155]
    s_waitcnt lgkmcnt(4)
    v_mfma_f32_32x32x16_bf16 v[60:75], v[32:35], a[216:219], v[60:75]
    v_mfma_f32_32x32x16_bf16 v[76:91], v[32:35], a[220:223], v[76:91]
    s_waitcnt lgkmcnt(0)
    s_waitcnt vmcnt(4)
    s_barrier
    v_mfma_f32_32x32x16_bf16 v[92:107], v[36:39], a[216:219], v[92:107]
    ds_read_b64_tr_b16 v[28:29], v16 offset:40960
    ds_read_b64_tr_b16 v[30:31], v16 offset:41472
    ds_read_b128 a[224:227], v22 offset:40960
    ds_read_b128 a[228:231], v22 offset:45056
    v_mfma_f32_32x32x16_bf16 v[108:123], v[36:39], a[220:223], v[108:123]
    ds_read_b64_tr_b16 v[32:33], v12 offset:40960
    ds_read_b64_tr_b16 v[34:35], v12 offset:41472
    v_mfma_f32_32x32x16_bf16 v[124:139], v[40:43], a[216:219], v[124:139]
    ds_read_b64_tr_b16 v[36:37], v13 offset:40960
    ds_read_b64_tr_b16 v[38:39], v13 offset:41472
    v_mfma_f32_32x32x16_bf16 v[140:155], v[40:43], a[220:223], v[140:155]
    s_add_u32 s69, s81, 1
    s_and_b32 s69, s69, 7
    s_mul_i32 s72, s69, 229376
    s_add_u32 s72, s72, s74
    s_add_u32 m0, s87, 0
    s_waitcnt lgkmcnt(4)
    v_mfma_f32_32x32x16_bf16 v[60:75], v[28:31], a[224:227], v[60:75]
    ds_read_b64_tr_b16 v[40:41], v16 offset:43008
    ds_read_b64_tr_b16 v[42:43], v16 offset:43520
    buffer_load_dwordx4 v2, s[36:39], s72 offen offset:0 lds
    v_mfma_f32_32x32x16_bf16 v[76:91], v[28:31], a[228:231], v[76:91]
    ds_read_b128 a[232:235], v22 offset:41984
    ds_read_b128 a[236:239], v22 offset:46080
    s_waitcnt lgkmcnt(6)
    v_mfma_f32_32x32x16_bf16 v[92:107], v[32:35], a[224:227], v[92:107]
    ds_read_b64_tr_b16 v[28:29], v12 offset:43008
    ds_read_b64_tr_b16 v[30:31], v12 offset:43520
    v_mfma_f32_32x32x16_bf16 v[108:123], v[32:35], a[228:231], v[108:123]
    s_waitcnt lgkmcnt(6)
    v_mfma_f32_32x32x16_bf16 v[124:139], v[36:39], a[224:227], v[124:139]
    ds_read_b64_tr_b16 v[32:33], v13 offset:43008
    ds_read_b64_tr_b16 v[34:35], v13 offset:43520
    v_mfma_f32_32x32x16_bf16 v[140:155], v[36:39], a[228:231], v[140:155]
    buffer_load_dwordx4 v3, s[36:39], s72 offen offset:1024 lds
    s_waitcnt lgkmcnt(4)
    v_mfma_f32_32x32x16_bf16 v[60:75], v[40:43], a[232:235], v[60:75]
    ds_read_b64_tr_b16 v[36:37], v16 offset:45056
    ds_read_b64_tr_b16 v[38:39], v16 offset:45568
    v_mfma_f32_32x32x16_bf16 v[76:91], v[40:43], a[236:239], v[76:91]
    ds_read_b128 a[240:243], v22 offset:43008
    ds_read_b128 a[244:247], v22 offset:47104
    s_waitcnt lgkmcnt(6)
    v_mfma_f32_32x32x16_bf16 v[92:107], v[28:31], a[232:235], v[92:107]
    ds_read_b64_tr_b16 v[40:41], v12 offset:45056
    ds_read_b64_tr_b16 v[42:43], v12 offset:45568
    v_mfma_f32_32x32x16_bf16 v[108:123], v[28:31], a[236:239], v[108:123]
    s_waitcnt lgkmcnt(6)
    v_mfma_f32_32x32x16_bf16 v[124:139], v[32:35], a[232:235], v[124:139]
    ds_read_b64_tr_b16 v[28:29], v13 offset:45056
    ds_read_b64_tr_b16 v[30:31], v13 offset:45568
    buffer_load_dwordx4 v4, s[36:39], s72 offen offset:2048 lds
    v_mfma_f32_32x32x16_bf16 v[140:155], v[32:35], a[236:239], v[140:155]
    s_waitcnt lgkmcnt(4)
    v_mfma_f32_32x32x16_bf16 v[60:75], v[36:39], a[240:243], v[60:75]
    ds_read_b64_tr_b16 v[32:33], v16 offset:47104
    ds_read_b64_tr_b16 v[34:35], v16 offset:47616
    v_mfma_f32_32x32x16_bf16 v[76:91], v[36:39], a[244:247], v[76:91]
    ds_read_b128 a[248:251], v22 offset:44032
    ds_read_b128 a[252:255], v22 offset:48128
    s_waitcnt lgkmcnt(6)
    v_mfma_f32_32x32x16_bf16 v[92:107], v[40:43], a[240:243], v[92:107]
    ds_read_b64_tr_b16 v[36:37], v12 offset:47104
    ds_read_b64_tr_b16 v[38:39], v12 offset:47616
    v_mfma_f32_32x32x16_bf16 v[108:123], v[40:43], a[244:247], v[108:123]
    buffer_load_dwordx4 v5, s[36:39], s72 offen offset:3072 lds
    s_waitcnt lgkmcnt(6)
    v_mfma_f32_32x32x16_bf16 v[124:139], v[28:31], a[240:243], v[124:139]
    ds_read_b64_tr_b16 v[40:41], v13 offset:47104
    ds_read_b64_tr_b16 v[42:43], v13 offset:47616
    v_mfma_f32_32x32x16_bf16 v[140:155], v[28:31], a[244:247], v[140:155]
    s_waitcnt lgkmcnt(4)
    v_mfma_f32_32x32x16_bf16 v[60:75], v[32:35], a[248:251], v[60:75]
    v_mfma_f32_32x32x16_bf16 v[76:91], v[32:35], a[252:255], v[76:91]
    s_waitcnt lgkmcnt(0)
    s_waitcnt vmcnt(4)
    s_barrier
    v_mfma_f32_32x32x16_bf16 v[92:107], v[36:39], a[248:251], v[92:107]
    ds_read_b64_tr_b16 v[28:29], v14 offset:0
    ds_read_b64_tr_b16 v[30:31], v14 offset:512
    v_mfma_f32_32x32x16_bf16 v[108:123], v[36:39], a[252:255], v[108:123]
    ds_read_b64_tr_b16 v[32:33], v15 offset:0
    ds_read_b64_tr_b16 v[34:35], v15 offset:512
    v_mfma_f32_32x32x16_bf16 v[124:139], v[40:43], a[248:251], v[124:139]
    ds_read_b64_tr_b16 v[36:37], v14 offset:2048
    ds_read_b64_tr_b16 v[38:39], v14 offset:2560
    v_mfma_f32_32x32x16_bf16 v[140:155], v[40:43], a[252:255], v[140:155]
    s_add_u32 s75, s84, 147456
    s_add_u32 m0, s87, 40960
    s_add_u32 s77, s89, 0
    buffer_load_dwordx4 v24, s[44:47], s77 offen lds
    buffer_load_dwordx4 v25, s[44:47], s77 offen offset:1024 lds
    v_cvt_pk_bf16_f32 v60, v60, v61
    v_cvt_pk_bf16_f32 v61, v62, v63
    v_cvt_pk_bf16_f32 v62, v64, v65
    v_cvt_pk_bf16_f32 v63, v66, v67
    v_cvt_pk_bf16_f32 v64, v68, v69
    v_cvt_pk_bf16_f32 v65, v70, v71
    v_cvt_pk_bf16_f32 v66, v72, v73
    v_cvt_pk_bf16_f32 v67, v74, v75
    v_cvt_pk_bf16_f32 v68, v76, v77
    v_cvt_pk_bf16_f32 v69, v78, v79
    v_cvt_pk_bf16_f32 v70, v80, v81
    v_cvt_pk_bf16_f32 v71, v82, v83
    v_cvt_pk_bf16_f32 v72, v84, v85
    v_cvt_pk_bf16_f32 v73, v86, v87
    v_cvt_pk_bf16_f32 v74, v88, v89
    v_cvt_pk_bf16_f32 v75, v90, v91
    v_mfma_f32_32x32x16_bf16 v[156:171], v[44:47], v[60:63], 0
    v_mfma_f32_32x32x16_bf16 v[172:187], v[48:51], v[64:67], 0
    v_mfma_f32_32x32x16_bf16 v[188:203], v[44:47], v[68:71], 0
    v_mfma_f32_32x32x16_bf16 v[204:219], v[48:51], v[72:75], 0
    v_pk_mul_f32 v[92:93], v[92:93], v[100:101]
    v_pk_mul_f32 v[94:95], v[94:95], v[102:103]
    v_pk_mul_f32 v[96:97], v[96:97], v[104:105]
    v_pk_mul_f32 v[98:99], v[98:99], v[106:107]
    v_cvt_pk_bf16_f32 v228, v92, v93
    v_cvt_pk_bf16_f32 v229, v94, v95
    v_cvt_pk_bf16_f32 v230, v96, v97
    v_cvt_pk_bf16_f32 v231, v98, v99
    buffer_store_dwordx4 v[228:231], v1, s[40:43], s84 offen offset:0 sc1
    v_pk_mul_f32 v[124:125], v[124:125], v[132:133]
    s_add_u32 m0, s87, 43008
    s_add_u32 s77, s89, 16384
    buffer_load_dwordx4 v24, s[44:47], s77 offen lds
    buffer_load_dwordx4 v25, s[44:47], s77 offen offset:1024 lds
    v_pk_mul_f32 v[126:127], v[126:127], v[134:135]
    v_pk_mul_f32 v[128:129], v[128:129], v[136:137]
    v_pk_mul_f32 v[130:131], v[130:131], v[138:139]
    v_cvt_pk_bf16_f32 v232, v124, v125
    v_cvt_pk_bf16_f32 v233, v126, v127
    v_cvt_pk_bf16_f32 v234, v128, v129
    v_cvt_pk_bf16_f32 v235, v130, v131
    buffer_store_dwordx4 v[232:235], v1, s[40:43], s84 offen offset:1024 sc1
    v_pk_mul_f32 v[108:109], v[108:109], v[116:117]
    v_pk_mul_f32 v[110:111], v[110:111], v[118:119]
    v_pk_mul_f32 v[112:113], v[112:113], v[120:121]
    v_pk_mul_f32 v[114:115], v[114:115], v[122:123]
    v_cvt_pk_bf16_f32 v236, v108, v109
    v_cvt_pk_bf16_f32 v237, v110, v111
    v_cvt_pk_bf16_f32 v238, v112, v113
    v_cvt_pk_bf16_f32 v239, v114, v115
    buffer_store_dwordx4 v[236:239], v1, s[40:43], s75 offen offset:0 sc1
    v_pk_mul_f32 v[140:141], v[140:141], v[148:149]
    v_pk_mul_f32 v[142:143], v[142:143], v[150:151]
    v_pk_mul_f32 v[144:145], v[144:145], v[152:153]
    v_pk_mul_f32 v[146:147], v[146:147], v[154:155]
    v_cvt_pk_bf16_f32 v240, v140, v141
    v_cvt_pk_bf16_f32 v241, v142, v143
    v_cvt_pk_bf16_f32 v242, v144, v145
    v_cvt_pk_bf16_f32 v243, v146, v147
    buffer_store_dwordx4 v[240:243], v1, s[40:43], s75 offen offset:1024 sc1
    v_max3_f32 v220, v156, v157, v158
    s_add_u32 m0, s27, 81920
    s_add_u32 s77, s89, 32768
    buffer_load_dwordx4 v24, s[44:47], s77 offen lds
    buffer_load_dwordx4 v25, s[44:47], s77 offen offset:1024 lds
    v_max3_f32 v222, v172, v173, v174
    v_max3_f32 v224, v188, v189, v190
    v_max3_f32 v226, v204, v205, v206
    v_max3_f32 v220, v220, v159, v160
    v_max3_f32 v222, v222, v175, v176
    v_max3_f32 v224, v224, v191, v192
    v_max3_f32 v226, v226, v207, v208
    v_max3_f32 v220, v220, v161, v162
    v_max3_f32 v222, v222, v177, v178
    v_max3_f32 v224, v224, v193, v194
    v_max3_f32 v226, v226, v209, v210
    v_max3_f32 v220, v220, v163, v164
    v_max3_f32 v222, v222, v179, v180
    v_max3_f32 v224, v224, v195, v196
    v_max3_f32 v226, v226, v211, v212
    v_max3_f32 v220, v220, v165, v166
    v_max3_f32 v222, v222, v181, v182
    v_max3_f32 v224, v224, v197, v198
    v_max3_f32 v226, v226, v213, v214
    v_max3_f32 v220, v220, v167, v168
    v_max3_f32 v222, v222, v183, v184
    v_max3_f32 v224, v224, v199, v200
    v_max3_f32 v226, v226, v215, v216
    v_max3_f32 v220, v220, v169, v170
    v_max3_f32 v222, v222, v185, v186
    v_max3_f32 v224, v224, v201, v202
    v_max3_f32 v226, v226, v217, v218
    v_max_f32 v220, v220, v171
    v_max_f32 v222, v222, v187
    v_max_f32 v224, v224, v203
    v_max_f32 v226, v226, v219
    v_mul_f32 v220, s95, v220
    v_mul_f32 v222, s95, v222
    v_mul_f32 v224, s95, v224
    v_mul_f32 v226, s95, v226
    v_pk_fma_f32 v[156:157], v[156:157], s[94:95], v[220:221] op_sel:[0,1,0] op_sel_hi:[1,1,0] neg_lo:[0,0,1] neg_hi:[0,0,1]
    v_pk_fma_f32 v[172:173], v[172:173], s[94:95], v[222:223] op_sel:[0,1,0] op_sel_hi:[1,1,0] neg_lo:[0,0,1] neg_hi:[0,0,1]
    s_add_u32 m0, s27, 83968
    s_add_u32 s77, s89, 49152
    buffer_load_dwordx4 v24, s[44:47], s77 offen lds
    buffer_load_dwordx4 v25, s[44:47], s77 offen offset:1024 lds
    v_pk_fma_f32 v[188:189], v[188:189], s[94:95], v[224:225] op_sel:[0,1,0] op_sel_hi:[1,1,0] neg_lo:[0,0,1] neg_hi:[0,0,1]
    v_pk_fma_f32 v[204:205], v[204:205], s[94:95], v[226:227] op_sel:[0,1,0] op_sel_hi:[1,1,0] neg_lo:[0,0,1] neg_hi:[0,0,1]
    v_pk_fma_f32 v[158:159], v[158:159], s[94:95], v[220:221] op_sel:[0,1,0] op_sel_hi:[1,1,0] neg_lo:[0,0,1] neg_hi:[0,0,1]
    v_pk_fma_f32 v[174:175], v[174:175], s[94:95], v[222:223] op_sel:[0,1,0] op_sel_hi:[1,1,0] neg_lo:[0,0,1] neg_hi:[0,0,1]
    v_pk_fma_f32 v[190:191], v[190:191], s[94:95], v[224:225] op_sel:[0,1,0] op_sel_hi:[1,1,0] neg_lo:[0,0,1] neg_hi:[0,0,1]
    v_pk_fma_f32 v[206:207], v[206:207], s[94:95], v[226:227] op_sel:[0,1,0] op_sel_hi:[1,1,0] neg_lo:[0,0,1] neg_hi:[0,0,1]
    v_pk_fma_f32 v[160:161], v[160:161], s[94:95], v[220:221] op_sel:[0,1,0] op_sel_hi:[1,1,0] neg_lo:[0,0,1] neg_hi:[0,0,1]
    v_pk_fma_f32 v[176:177], v[176:177], s[94:95], v[222:223] op_sel:[0,1,0] op_sel_hi:[1,1,0] neg_lo:[0,0,1] neg_hi:[0,0,1]
    v_pk_fma_f32 v[192:193], v[192:193], s[94:95], v[224:225] op_sel:[0,1,0] op_sel_hi:[1,1,0] neg_lo:[0,0,1] neg_hi:[0,0,1]
    v_pk_fma_f32 v[208:209], v[208:209], s[94:95], v[226:227] op_sel:[0,1,0] op_sel_hi:[1,1,0] neg_lo:[0,0,1] neg_hi:[0,0,1]
    v_pk_fma_f32 v[162:163], v[162:163], s[94:95], v[220:221] op_sel:[0,1,0] op_sel_hi:[1,1,0] neg_lo:[0,0,1] neg_hi:[0,0,1]
    v_pk_fma_f32 v[178:179], v[178:179], s[94:95], v[222:223] op_sel:[0,1,0] op_sel_hi:[1,1,0] neg_lo:[0,0,1] neg_hi:[0,0,1]
    v_pk_fma_f32 v[194:195], v[194:195], s[94:95], v[224:225] op_sel:[0,1,0] op_sel_hi:[1,1,0] neg_lo:[0,0,1] neg_hi:[0,0,1]
    v_pk_fma_f32 v[210:211], v[210:211], s[94:95], v[226:227] op_sel:[0,1,0] op_sel_hi:[1,1,0] neg_lo:[0,0,1] neg_hi:[0,0,1]
    v_pk_fma_f32 v[164:165], v[164:165], s[94:95], v[220:221] op_sel:[0,1,0] op_sel_hi:[1,1,0] neg_lo:[0,0,1] neg_hi:[0,0,1]
    v_pk_fma_f32 v[180:181], v[180:181], s[94:95], v[222:223] op_sel:[0,1,0] op_sel_hi:[1,1,0] neg_lo:[0,0,1] neg_hi:[0,0,1]
    v_pk_fma_f32 v[196:197], v[196:197], s[94:95], v[224:225] op_sel:[0,1,0] op_sel_hi:[1,1,0] neg_lo:[0,0,1] neg_hi:[0,0,1]
    v_pk_fma_f32 v[212:213], v[212:213], s[94:95], v[226:227] op_sel:[0,1,0] op_sel_hi:[1,1,0] neg_lo:[0,0,1] neg_hi:[0,0,1]
    v_pk_fma_f32 v[166:167], v[166:167], s[94:95], v[220:221] op_sel:[0,1,0] op_sel_hi:[1,1,0] neg_lo:[0,0,1] neg_hi:[0,0,1]
    s_add_u32 m0, s27, 86016
    s_add_u32 s77, s89, 327680
    buffer_load_dwordx4 v24, s[44:47], s77 offen lds
    buffer_load_dwordx4 v25, s[44:47], s77 offen offset:1024 lds
    v_pk_fma_f32 v[182:183], v[182:183], s[94:95], v[222:223] op_sel:[0,1,0] op_sel_hi:[1,1,0] neg_lo:[0,0,1] neg_hi:[0,0,1]
    v_pk_fma_f32 v[198:199], v[198:199], s[94:95], v[224:225] op_sel:[0,1,0] op_sel_hi:[1,1,0] neg_lo:[0,0,1] neg_hi:[0,0,1]
    v_pk_fma_f32 v[214:215], v[214:215], s[94:95], v[226:227] op_sel:[0,1,0] op_sel_hi:[1,1,0] neg_lo:[0,0,1] neg_hi:[0,0,1]
    v_pk_fma_f32 v[168:169], v[168:169], s[94:95], v[220:221] op_sel:[0,1,0] op_sel_hi:[1,1,0] neg_lo:[0,0,1] neg_hi:[0,0,1]
    v_pk_fma_f32 v[184:185], v[184:185], s[94:95], v[222:223] op_sel:[0,1,0] op_sel_hi:[1,1,0] neg_lo:[0,0,1] neg_hi:[0,0,1]
    v_pk_fma_f32 v[200:201], v[200:201], s[94:95], v[224:225] op_sel:[0,1,0] op_sel_hi:[1,1,0] neg_lo:[0,0,1] neg_hi:[0,0,1]
    v_pk_fma_f32 v[216:217], v[216:217], s[94:95], v[226:227] op_sel:[0,1,0] op_sel_hi:[1,1,0] neg_lo:[0,0,1] neg_hi:[0,0,1]
    v_pk_fma_f32 v[170:171], v[170:171], s[94:95], v[220:221] op_sel:[0,1,0] op_sel_hi:[1,1,0] neg_lo:[0,0,1] neg_hi:[0,0,1]
    v_pk_fma_f32 v[186:187], v[186:187], s[94:95], v[222:223] op_sel:[0,1,0] op_sel_hi:[1,1,0] neg_lo:[0,0,1] neg_hi:[0,0,1]
    v_pk_fma_f32 v[202:203], v[202:203], s[94:95], v[224:225] op_sel:[0,1,0] op_sel_hi:[1,1,0] neg_lo:[0,0,1] neg_hi:[0,0,1]
    v_pk_fma_f32 v[218:219], v[218:219], s[94:95], v[226:227] op_sel:[0,1,0] op_sel_hi:[1,1,0] neg_lo:[0,0,1] neg_hi:[0,0,1]
    v_exp_f32 v156, v156
    v_exp_f32 v172, v172
    v_exp_f32 v188, v188
    v_exp_f32 v204, v204
    v_exp_f32 v157, v157
    v_exp_f32 v173, v173
    v_exp_f32 v189, v189
    v_exp_f32 v205, v205
    s_add_u32 m0, s27, 0
    s_add_u32 s77, s89, 344064
    buffer_load_dwordx4 v24, s[44:47], s77 offen lds
    buffer_load_dwordx4 v25, s[44:47], s77 offen offset:1024 lds
    v_exp_f32 v158, v158
    v_exp_f32 v174, v174
    v_exp_f32 v190, v190
    v_exp_f32 v206, v206
    v_exp_f32 v159, v159
    v_exp_f32 v175, v175
    v_exp_f32 v191, v191
    v_exp_f32 v207, v207
    v_exp_f32 v160, v160
    v_exp_f32 v176, v176
    v_exp_f32 v192, v192
    v_exp_f32 v208, v208
    v_exp_f32 v161, v161
    v_exp_f32 v177, v177
    v_exp_f32 v193, v193
    v_exp_f32 v209, v209
    v_exp_f32 v162, v162
    v_exp_f32 v178, v178
    v_exp_f32 v194, v194
    s_add_u32 m0, s27, 2048
    s_add_u32 s77, s89, 360448
    buffer_load_dwordx4 v24, s[44:47], s77 offen lds
    buffer_load_dwordx4 v25, s[44:47], s77 offen offset:1024 lds
    v_exp_f32 v210, v210
    v_exp_f32 v163, v163
    v_exp_f32 v179, v179
    v_exp_f32 v195, v195
    v_exp_f32 v211, v211
    v_exp_f32 v164, v164
    v_exp_f32 v180, v180
    v_exp_f32 v196, v196
    v_exp_f32 v212, v212
    v_exp_f32 v165, v165
    v_exp_f32 v181, v181
    v_exp_f32 v197, v197
    v_exp_f32 v213, v213
    v_exp_f32 v166, v166
    v_exp_f32 v182, v182
    v_exp_f32 v198, v198
    v_exp_f32 v214, v214
    v_exp_f32 v167, v167
    v_exp_f32 v183, v183
    s_add_u32 m0, s27, 4096
    s_add_u32 s77, s89, 376832
    buffer_load_dwordx4 v24, s[44:47], s77 offen lds
    buffer_load_dwordx4 v25, s[44:47], s77 offen offset:1024 lds
    v_exp_f32 v199, v199
    v_exp_f32 v215, v215
    v_exp_f32 v168, v168
    v_exp_f32 v184, v184
    v_exp_f32 v200, v200
    v_exp_f32 v216, v216
    v_exp_f32 v169, v169
    v_exp_f32 v185, v185
    v_exp_f32 v201, v201
    v_exp_f32 v217, v217
    v_exp_f32 v170, v170
    v_exp_f32 v186, v186
    v_exp_f32 v202, v202
    v_exp_f32 v218, v218
    v_exp_f32 v171, v171
    v_exp_f32 v187, v187
    v_exp_f32 v203, v203
    v_exp_f32_e64 v219, v219
    v_pk_add_f32 v[220:221], v[156:157], v[158:159]
    s_add_u32 m0, s27, 40960
    s_add_u32 s77, s89, 65536
    buffer_load_dwordx4 v24, s[44:47], s77 offen lds
    buffer_load_dwordx4 v25, s[44:47], s77 offen offset:1024 lds
    v_pk_add_f32 v[222:223], v[172:173], v[174:175]
    v_pk_add_f32 v[224:225], v[188:189], v[190:191]
    v_pk_add_f32 v[226:227], v[204:205], v[206:207]
    v_pk_add_f32 v[220:221], v[220:221], v[160:161]
    v_pk_add_f32 v[222:223], v[222:223], v[176:177]
    v_pk_add_f32 v[224:225], v[224:225], v[192:193]
    v_pk_add_f32 v[226:227], v[226:227], v[208:209]
    v_pk_add_f32 v[220:221], v[220:221], v[162:163]
    v_pk_add_f32 v[222:223], v[222:223], v[178:179]
    v_pk_add_f32 v[224:225], v[224:225], v[194:195]
    v_pk_add_f32 v[226:227], v[226:227], v[210:211]
    v_pk_add_f32 v[220:221], v[220:221], v[164:165]
    v_pk_add_f32 v[222:223], v[222:223], v[180:181]
    v_pk_add_f32 v[224:225], v[224:225], v[196:197]
    v_pk_add_f32 v[226:227], v[226:227], v[212:213]
    v_pk_add_f32 v[220:221], v[220:221], v[166:167]
    v_pk_add_f32 v[222:223], v[222:223], v[182:183]
    v_pk_add_f32 v[224:225], v[224:225], v[198:199]
    v_pk_add_f32 v[226:227], v[226:227], v[214:215]
    s_add_u32 m0, s27, 43008
    s_add_u32 s77, s89, 81920
    buffer_load_dwordx4 v24, s[44:47], s77 offen lds
    buffer_load_dwordx4 v25, s[44:47], s77 offen offset:1024 lds
    v_pk_add_f32 v[220:221], v[220:221], v[168:169]
    v_pk_add_f32 v[222:223], v[222:223], v[184:185]
    v_pk_add_f32 v[224:225], v[224:225], v[200:201]
    v_pk_add_f32 v[226:227], v[226:227], v[216:217]
    v_pk_add_f32 v[220:221], v[220:221], v[170:171]
    v_pk_add_f32 v[222:223], v[222:223], v[186:187]
    v_pk_add_f32 v[224:225], v[224:225], v[202:203]
    v_pk_add_f32 v[226:227], v[226:227], v[218:219]
    v_add_f32 v220, v220, v221
    v_add_f32 v222, v222, v223
    v_add_f32 v224, v224, v225
    v_add_f32 v226, v226, v227
    v_rcp_f32 v220, v220
    v_rcp_f32 v222, v222
    v_rcp_f32 v224, v224
    v_rcp_f32 v226, v226
    v_pk_mul_f32 v[156:157], v[156:157], v[220:221] op_sel_hi:[1,0]
    v_pk_mul_f32 v[158:159], v[158:159], v[220:221] op_sel_hi:[1,0]
    v_pk_mul_f32 v[160:161], v[160:161], v[220:221] op_sel_hi:[1,0]
    v_pk_mul_f32 v[162:163], v[162:163], v[220:221] op_sel_hi:[1,0]
    v_pk_mul_f32 v[164:165], v[164:165], v[220:221] op_sel_hi:[1,0]
    s_add_u32 m0, s27, 45056
    s_add_u32 s77, s89, 98304
    buffer_load_dwordx4 v24, s[44:47], s77 offen lds
    buffer_load_dwordx4 v25, s[44:47], s77 offen offset:1024 lds
    v_pk_mul_f32 v[166:167], v[166:167], v[220:221] op_sel_hi:[1,0]
    v_pk_mul_f32 v[168:169], v[168:169], v[220:221] op_sel_hi:[1,0]
    v_pk_mul_f32 v[170:171], v[170:171], v[220:221] op_sel_hi:[1,0]
    v_cvt_pk_bf16_f32 v124, v156, v157
    v_cvt_pk_bf16_f32 v125, v158, v159
    v_cvt_pk_bf16_f32 v126, v160, v161
    v_cvt_pk_bf16_f32 v127, v162, v163
    v_cvt_pk_bf16_f32 v128, v164, v165
    v_cvt_pk_bf16_f32 v129, v166, v167
    v_cvt_pk_bf16_f32 v130, v168, v169
    v_cvt_pk_bf16_f32 v131, v170, v171
    v_pk_mul_f32 v[172:173], v[172:173], v[222:223] op_sel_hi:[1,0]
    v_pk_mul_f32 v[174:175], v[174:175], v[222:223] op_sel_hi:[1,0]
    v_pk_mul_f32 v[176:177], v[176:177], v[222:223] op_sel_hi:[1,0]
    v_pk_mul_f32 v[178:179], v[178:179], v[222:223] op_sel_hi:[1,0]
    v_pk_mul_f32 v[180:181], v[180:181], v[222:223] op_sel_hi:[1,0]
    v_pk_mul_f32 v[182:183], v[182:183], v[222:223] op_sel_hi:[1,0]
    v_pk_mul_f32 v[184:185], v[184:185], v[222:223] op_sel_hi:[1,0]
    v_pk_mul_f32 v[186:187], v[186:187], v[222:223] op_sel_hi:[1,0]
    v_cvt_pk_bf16_f32 v132, v172, v173
    v_cvt_pk_bf16_f32 v133, v174, v175
    v_cvt_pk_bf16_f32 v134, v176, v177
    v_cvt_pk_bf16_f32 v135, v178, v179
    v_cvt_pk_bf16_f32 v136, v180, v181
    v_cvt_pk_bf16_f32 v137, v182, v183
    v_cvt_pk_bf16_f32 v138, v184, v185
    v_cvt_pk_bf16_f32 v139, v186, v187
    s_add_u32 m0, s93, 0
    s_add_u32 s77, s89, 114688
    buffer_load_dwordx4 v24, s[44:47], s77 offen lds
    buffer_load_dwordx4 v25, s[44:47], s77 offen offset:1024 lds
    v_pk_mul_f32 v[188:189], v[188:189], v[224:225] op_sel_hi:[1,0]
    v_pk_mul_f32 v[190:191], v[190:191], v[224:225] op_sel_hi:[1,0]
    v_pk_mul_f32 v[192:193], v[192:193], v[224:225] op_sel_hi:[1,0]
    v_pk_mul_f32 v[194:195], v[194:195], v[224:225] op_sel_hi:[1,0]
    v_pk_mul_f32 v[196:197], v[196:197], v[224:225] op_sel_hi:[1,0]
    v_pk_mul_f32 v[198:199], v[198:199], v[224:225] op_sel_hi:[1,0]
    v_pk_mul_f32 v[200:201], v[200:201], v[224:225] op_sel_hi:[1,0]
    v_pk_mul_f32 v[202:203], v[202:203], v[224:225] op_sel_hi:[1,0]
    v_cvt_pk_bf16_f32 v140, v188, v189
    v_cvt_pk_bf16_f32 v141, v190, v191
    v_cvt_pk_bf16_f32 v142, v192, v193
    v_cvt_pk_bf16_f32 v143, v194, v195
    v_cvt_pk_bf16_f32 v144, v196, v197
    v_cvt_pk_bf16_f32 v145, v198, v199
    v_cvt_pk_bf16_f32 v146, v200, v201
    v_cvt_pk_bf16_f32 v147, v202, v203
    v_pk_mul_f32 v[204:205], v[204:205], v[226:227] op_sel_hi:[1,0]
    v_pk_mul_f32 v[206:207], v[206:207], v[226:227] op_sel_hi:[1,0]
    v_pk_mul_f32 v[208:209], v[208:209], v[226:227] op_sel_hi:[1,0]
    v_pk_mul_f32 v[210:211], v[210:211], v[226:227] op_sel_hi:[1,0]
    v_pk_mul_f32 v[212:213], v[212:213], v[226:227] op_sel_hi:[1,0]
    v_pk_mul_f32 v[214:215], v[214:215], v[226:227] op_sel_hi:[1,0]
    v_pk_mul_f32 v[216:217], v[216:217], v[226:227] op_sel_hi:[1,0]
    s_add_u32 m0, s93, 2048
    s_add_u32 s77, s89, 393216
    buffer_load_dwordx4 v24, s[44:47], s77 offen lds
    buffer_load_dwordx4 v25, s[44:47], s77 offen offset:1024 lds
    v_pk_mul_f32 v[218:219], v[218:219], v[226:227] op_sel_hi:[1,0]
    v_cvt_pk_bf16_f32 v148, v204, v205
    v_cvt_pk_bf16_f32 v149, v206, v207
    v_cvt_pk_bf16_f32 v150, v208, v209
    v_cvt_pk_bf16_f32 v151, v210, v211
    v_cvt_pk_bf16_f32 v152, v212, v213
    v_cvt_pk_bf16_f32 v153, v214, v215
    v_cvt_pk_bf16_f32 v154, v216, v217
    v_cvt_pk_bf16_f32 v155, v218, v219
    s_waitcnt vmcnt(28)
    ds_read_b64_tr_b16 v[60:61], v56 offset:0
    ds_read_b64_tr_b16 v[62:63], v56 offset:1024
    ds_read_b64_tr_b16 v[64:65], v57 offset:0
    ds_read_b64_tr_b16 v[66:67], v57 offset:1024
    s_waitcnt vmcnt(25)
    ds_read_b64_tr_b16 v[68:69], v56 offset:2048
    ds_read_b64_tr_b16 v[70:71], v56 offset:3072
    ds_read_b64_tr_b16 v[72:73], v57 offset:2048
    ds_read_b64_tr_b16 v[74:75], v57 offset:3072
    s_add_u32 s69, s81, 2
    s_and_b32 s69, s69, 7
    s_mul_i32 s72, s69, 229376
    s_add_u32 s72, s72, s74
    s_add_u32 m0, s87, 40960
    s_waitcnt lgkmcnt(12)
    v_mfma_f32_32x32x16_bf16 v[156:171], v[28:31], a[0:3], 0
    ds_read_b64_tr_b16 v[40:41], v15 offset:2048
    ds_read_b64_tr_b16 v[42:43], v15 offset:2560
    v_mfma_f32_32x32x16_bf16 v[172:187], v[28:31], a[4:7], 0
    s_waitcnt vmcnt(20)
    ds_read_b64_tr_b16 v[76:77], v54 offset:0
    ds_read_b64_tr_b16 v[78:79], v54 offset:1024
    s_waitcnt lgkmcnt(14)
    v_mfma_f32_32x32x16_bf16 v[188:203], v[32:35], a[0:3], 0
    ds_read_b64_tr_b16 v[28:29], v14 offset:4096
    ds_read_b64_tr_b16 v[30:31], v14 offset:4608
    s_waitcnt lgkmcnt(6)
    buffer_load_dwordx4 v2, s[36:39], s72 offen offset:0 lds
    v_mfma_f32_32x32x16_bf16 v[204:219], v[32:35], a[4:7], 0
    ds_read_b64_tr_b16 v[80:81], v55 offset:0
    ds_read_b64_tr_b16 v[82:83], v55 offset:1024
    buffer_load_dwordx4 v3, s[36:39], s72 offen offset:1024 lds
    v_mfma_f32_32x32x16_bf16 v[156:171], v[36:39], a[8:11], v[156:171]
    ds_read_b64_tr_b16 v[32:33], v15 offset:4096
    ds_read_b64_tr_b16 v[34:35], v15 offset:4608
    buffer_load_dwordx4 v4, s[36:39], s72 offen offset:2048 lds
    v_mfma_f32_32x32x16_bf16 v[172:187], v[36:39], a[12:15], v[172:187]
    s_waitcnt vmcnt(21)
    ds_read_b64_tr_b16 v[84:85], v54 offset:2048
    ds_read_b64_tr_b16 v[86:87], v54 offset:3072
    buffer_load_dwordx4 v5, s[36:39], s72 offen offset:3072 lds
    s_waitcnt lgkmcnt(10)
    v_mfma_f32_32x32x16_bf16 v[188:203], v[40:43], a[8:11], v[188:203]
    ds_read_b64_tr_b16 v[36:37], v14 offset:6144
    ds_read_b64_tr_b16 v[38:39], v14 offset:6656
    v_mfma_f32_32x32x16_bf16 v[204:219], v[40:43], a[12:15], v[204:219]
    ds_read_b64_tr_b16 v[88:89], v55 offset:2048
    ds_read_b64_tr_b16 v[90:91], v55 offset:3072
    s_add_u32 m0, s93, 4096
    s_add_u32 s77, s89, 409600
    buffer_load_dwordx4 v24, s[44:47], s77 offen lds
    buffer_load_dwordx4 v25, s[44:47], s77 offen offset:1024 lds
    s_waitcnt lgkmcnt(10)
    v_mfma_f32_32x32x16_bf16 v[156:171], v[28:31], a[16:19], v[156:171]
    ds_read_b64_tr_b16 v[40:41], v15 offset:6144
    ds_read_b64_tr_b16 v[42:43], v15 offset:6656
    v_mfma_f32_32x32x16_bf16 v[172:187], v[28:31], a[20:23], v[172:187]
    s_add_u32 m0, s93, 6144
    s_add_u32 s77, s89, 425984
    buffer_load_dwordx4 v24, s[44:47], s77 offen lds
    buffer_load_dwordx4 v25, s[44:47], s77 offen offset:1024 lds
    s_waitcnt lgkmcnt(8)
    v_mfma_f32_32x32x16_bf16 v[188:203], v[32:35], a[16:19], v[188:203]
    v_mfma_f32_32x32x16_bf16 v[204:219], v[32:35], a[20:23], v[204:219]
    s_waitcnt lgkmcnt(0)
    s_barrier
    s_cmp_lg_u32 s60, 1
    s_cbranch_scc1 L_fl_17
    s_lshl_b32 s79, s61, 4
    s_add_u32 s79, s79, s62
    s_lshl_b32 s79, s79, 7
    v_mov_b32 v254, s68
    s_add_u32 s79, s79, 196608
    s_mov_b64 exec, 1
    buffer_store_dword v254, off, s[40:43], s79 sc1
    s_mov_b64 exec, -1
L_fl_17:
    v_mfma_f32_32x32x16_bf16 v[156:171], v[36:39], a[24:27], v[156:171]
    ds_read_b64_tr_b16 v[28:29], v12 offset:0
    ds_read_b64_tr_b16 v[30:31], v12 offset:512
    v_mfma_f32_32x32x16_bf16 v[172:187], v[36:39], a[28:31], v[172:187]
    ds_read_b64_tr_b16 v[32:33], v13 offset:0
    ds_read_b64_tr_b16 v[34:35], v13 offset:512
    v_mfma_f32_32x32x16_bf16 v[188:203], v[40:43], a[24:27], v[188:203]
    ds_read_b64_tr_b16 v[36:37], v12 offset:2048
    ds_read_b64_tr_b16 v[38:39], v12 offset:2560
    v_mfma_f32_32x32x16_bf16 v[204:219], v[40:43], a[28:31], v[204:219]
    s_add_u32 s69, s81, 3
    s_and_b32 s69, s69, 7
    s_mul_i32 s72, s69, 229376
    s_add_u32 s72, s72, s74
    s_add_u32 m0, s87, 81920
    s_waitcnt lgkmcnt(4)
    v_mfma_f32_32x32x16_bf16 v[156:171], v[28:31], a[32:35], v[156:171]
    ds_read_b64_tr_b16 v[40:41], v13 offset:2048
    ds_read_b64_tr_b16 v[42:43], v13 offset:2560
    buffer_load_dwordx4 v2, s[36:39], s72 offen offset:0 lds
    v_mfma_f32_32x32x16_bf16 v[172:187], v[28:31], a[36:39], v[172:187]
    s_waitcnt vmcnt(25)
    ds_read_b64_tr_b16 v[92:93], v54 offset:4096
    ds_read_b64_tr_b16 v[94:95], v54 offset:5120
    buffer_load_dwordx4 v3, s[36:39], s72 offen offset:1024 lds
    s_waitcnt lgkmcnt(6)
    v_mfma_f32_32x32x16_bf16 v[188:203], v[32:35], a[32:35], v[188:203]
    ds_read_b64_tr_b16 v[28:29], v12 offset:4096
    ds_read_b64_tr_b16 v[30:31], v12 offset:4608
    v_mfma_f32_32x32x16_bf16 v[204:219], v[32:35], a[36:39], v[204:219]
    ds_read_b64_tr_b16 v[96:97], v55 offset:4096
    ds_read_b64_tr_b16 v[98:99], v55 offset:5120
    buffer_load_dwordx4 v4, s[36:39], s72 offen offset:2048 lds
    s_waitcnt lgkmcnt(8)
    v_mfma_f32_32x32x16_bf16 v[156:171], v[36:39], a[40:43], v[156:171]
    ds_read_b64_tr_b16 v[32:33], v13 offset:4096
    ds_read_b64_tr_b16 v[34:35], v13 offset:4608
    buffer_load_dwordx4 v5, s[36:39], s72 offen offset:3072 lds
    v_mfma_f32_32x32x16_bf16 v[172:187], v[36:39], a[44:47], v[172:187]
    s_waitcnt vmcnt(26)
    ds_read_b64_tr_b16 v[100:101], v52 offset:0
    ds_read_b64_tr_b16 v[102:103], v52 offset:1024
    s_waitcnt lgkmcnt(10)
    v_mfma_f32_32x32x16_bf16 v[188:203], v[40:43], a[40:43], v[188:203]
    ds_read_b64_tr_b16 v[36:37], v12 offset:6144
    ds_read_b64_tr_b16 v[38:39], v12 offset:6656
    s_add_u32 m0, s88, 155648
    s_add_u32 s77, s89, 442368
    buffer_load_dwordx4 v24, s[44:47], s77 offen lds
    buffer_load_dwordx4 v25, s[44:47], s77 offen offset:1024 lds
    v_mfma_f32_32x32x16_bf16 v[204:219], v[40:43], a[44:47], v[204:219]
    ds_read_b64_tr_b16 v[104:105], v53 offset:0
    ds_read_b64_tr_b16 v[106:107], v53 offset:1024
    s_waitcnt lgkmcnt(10)
    v_mfma_f32_32x32x16_bf16 v[156:171], v[28:31], a[48:51], v[156:171]
    ds_read_b64_tr_b16 v[40:41], v13 offset:6144
    ds_read_b64_tr_b16 v[42:43], v13 offset:6656
    v_mfma_f32_32x32x16_bf16 v[172:187], v[28:31], a[52:55], v[172:187]
    s_waitcnt vmcnt(26)
    ds_read_b64_tr_b16 v[108:109], v52 offset:2048
    ds_read_b64_tr_b16 v[110:111], v52 offset:3072
    s_add_u32 m0, s27, 81920
    s_add_u32 s77, s89, 131072
    buffer_load_dwordx4 v24, s[44:47], s77 offen lds
    buffer_load_dwordx4 v25, s[44:47], s77 offen offset:1024 lds
    s_waitcnt lgkmcnt(10)
    v_mfma_f32_32x32x16_bf16 v[188:203], v[32:35], a[48:51], v[188:203]
    ds_read_b64_tr_b16 v[112:113], v53 offset:2048
    ds_read_b64_tr_b16 v[114:115], v53 offset:3072
    v_mfma_f32_32x32x16_bf16 v[204:219], v[32:35], a[52:55], v[204:219]
    s_waitcnt lgkmcnt(0)
    s_waitcnt vmcnt(12)
    s_barrier
    v_mfma_f32_32x32x16_bf16 v[156:171], v[36:39], a[56:59], v[156:171]
    ds_read_b64_tr_b16 v[28:29], v12 offset:40960
    ds_read_b64_tr_b16 v[30:31], v12 offset:41472
    v_mfma_f32_32x32x16_bf16 v[172:187], v[36:39], a[60:63], v[172:187]
    ds_read_b64_tr_b16 v[32:33], v13 offset:40960
    ds_read_b64_tr_b16 v[34:35], v13 offset:41472
    v_mfma_f32_32x32x16_bf16 v[188:203], v[40:43], a[56:59], v[188:203]
    ds_read_b64_tr_b16 v[36:37], v12 offset:43008
    ds_read_b64_tr_b16 v[38:39], v12 offset:43520
    v_mfma_f32_32x32x16_bf16 v[204:219], v[40:43], a[60:63], v[204:219]
    s_add_u32 s69, s81, 4
    s_and_b32 s69, s69, 7
    s_mul_i32 s72, s69, 229376
    s_add_u32 s72, s72, s74
    s_add_u32 m0, s87, 0
    s_waitcnt lgkmcnt(4)
    v_mfma_f32_32x32x16_bf16 v[156:171], v[28:31], a[64:67], v[156:171]
    ds_read_b64_tr_b16 v[40:41], v13 offset:43008
    ds_read_b64_tr_b16 v[42:43], v13 offset:43520
    buffer_load_dwordx4 v2, s[36:39], s72 offen offset:0 lds
    v_mfma_f32_32x32x16_bf16 v[172:187], v[28:31], a[68:71], v[172:187]
    ds_read_b64_tr_b16 v[116:117], v52 offset:4096
    ds_read_b64_tr_b16 v[118:119], v52 offset:5120
    buffer_load_dwordx4 v3, s[36:39], s72 offen offset:1024 lds
    s_waitcnt lgkmcnt(6)
    v_mfma_f32_32x32x16_bf16 v[188:203], v[32:35], a[64:67], v[188:203]
    ds_read_b64_tr_b16 v[28:29], v12 offset:45056
    ds_read_b64_tr_b16 v[30:31], v12 offset:45568
    v_mfma_f32_32x32x16_bf16 v[204:219], v[32:35], a[68:71], v[204:219]
    ds_read_b64_tr_b16 v[120:121], v53 offset:4096
    ds_read_b64_tr_b16 v[122:123], v53 offset:5120
    buffer_load_dwordx4 v4, s[36:39], s72 offen offset:2048 lds
    s_waitcnt lgkmcnt(8)
    v_mfma_f32_32x32x16_bf16 v[156:171], v[36:39], a[72:75], v[156:171]
    ds_read_b64_tr_b16 v[32:33], v13 offset:45056
    ds_read_b64_tr_b16 v[34:35], v13 offset:45568
    buffer_load_dwordx4 v5, s[36:39], s72 offen offset:3072 lds
    v_mfma_f32_32x32x16_bf16 v[172:187], v[36:39], a[76:79], v[172:187]
    ds_read_b64_tr_b16 a[0:1], v52 offset:40960
    ds_read_b64_tr_b16 a[2:3], v52 offset:41984
    s_waitcnt lgkmcnt(10)
    v_mfma_f32_32x32x16_bf16 v[188:203], v[40:43], a[72:75], v[188:203]
    ds_read_b64_tr_b16 v[36:37], v12 offset:47104
    ds_read_b64_tr_b16 v[38:39], v12 offset:47616
    s_add_u32 m0, s27, 83968
    s_add_u32 s77, s89, 147456
    buffer_load_dwordx4 v24, s[44:47], s77 offen lds
    buffer_load_dwordx4 v25, s[44:47], s77 offen offset:1024 lds
    v_mfma_f32_32x32x16_bf16 v[204:219], v[40:43], a[76:79], v[204:219]
    ds_read_b64_tr_b16 a[4:5], v53 offset:40960
    ds_read_b64_tr_b16 a[6:7], v53 offset:41984
    s_waitcnt lgkmcnt(10)
    v_mfma_f32_32x32x16_bf16 v[156:171], v[28:31], a[80:83], v[156:171]
    ds_read_b64_tr_b16 v[40:41], v13 offset:47104
    ds_read_b64_tr_b16 v[42:43], v13 offset:47616
    v_mfma_f32_32x32x16_bf16 v[172:187], v[28:31], a[84:87], v[172:187]
    ds_read_b64_tr_b16 a[8:9], v52 offset:43008
    ds_read_b64_tr_b16 a[10:11], v52 offset:44032
    s_add_u32 m0, s27, 86016
    s_add_u32 s77, s89, 163840
    buffer_load_dwordx4 v24, s[44:47], s77 offen lds
    buffer_load_dwordx4 v25, s[44:47], s77 offen offset:1024 lds
    s_waitcnt lgkmcnt(10)
    v_mfma_f32_32x32x16_bf16 v[188:203], v[32:35], a[80:83], v[188:203]
    ds_read_b64_tr_b16 a[12:13], v53 offset:43008
    ds_read_b64_tr_b16 a[14:15], v53 offset:44032
    v_mfma_f32_32x32x16_bf16 v[204:219], v[32:35], a[84:87], v[204:219]
    s_waitcnt lgkmcnt(0)
    s_waitcnt vmcnt(12)
    s_barrier
    v_mfma_f32_32x32x16_bf16 v[156:171], v[36:39], a[88:91], v[156:171]
    ds_read_b64_tr_b16 v[28:29], v14 offset:0
    ds_read_b64_tr_b16 v[30:31], v14 offset:512
    v_mfma_f32_32x32x16_bf16 v[172:187], v[36:39], a[92:95], v[172:187]
    ds_read_b64_tr_b16 v[32:33], v15 offset:0
    ds_read_b64_tr_b16 v[34:35], v15 offset:512
    v_mfma_f32_32x32x16_bf16 v[188:203], v[40:43], a[88:91], v[188:203]
    ds_read_b64_tr_b16 v[36:37], v14 offset:2048
    ds_read_b64_tr_b16 v[38:39], v14 offset:2560
    v_mfma_f32_32x32x16_bf16 v[204:219], v[40:43], a[92:95], v[204:219]
    s_add_u32 s69, s81, 5
    s_and_b32 s69, s69, 7
    s_mul_i32 s72, s69, 229376
    s_add_u32 s72, s72, s74
    s_add_u32 m0, s87, 40960
    s_waitcnt lgkmcnt(4)
    v_mfma_f32_32x32x16_bf16 v[156:171], v[28:31], a[96:99], v[156:171]
    ds_read_b64_tr_b16 v[40:41], v15 offset:2048
    ds_read_b64_tr_b16 v[42:43], v15 offset:2560
    buffer_load_dwordx4 v2, s[36:39], s72 offen offset:0 lds
    v_mfma_f32_32x32x16_bf16 v[172:187], v[28:31], a[100:103], v[172:187]
    ds_read_b64_tr_b16 a[16:17], v52 offset:45056
    ds_read_b64_tr_b16 a[18:19], v52 offset:46080
    buffer_load_dwordx4 v3, s[36:39], s72 offen offset:1024 lds
    s_waitcnt lgkmcnt(6)
    v_mfma_f32_32x32x16_bf16 v[188:203], v[32:35], a[96:99], v[188:203]
    ds_read_b64_tr_b16 v[28:29], v14 offset:4096
    ds_read_b64_tr_b16 v[30:31], v14 offset:4608
    v_mfma_f32_32x32x16_bf16 v[204:219], v[32:35], a[100:103], v[204:219]
    ds_read_b64_tr_b16 a[20:21], v53 offset:45056
    ds_read_b64_tr_b16 a[22:23], v53 offset:46080
    buffer_load_dwordx4 v4, s[36:39], s72 offen offset:2048 lds
    s_waitcnt lgkmcnt(8)
    v_mfma_f32_32x32x16_bf16 v[156:171], v[36:39], a[104:107], v[156:171]
    ds_read_b64_tr_b16 v[32:33], v15 offset:4096
    ds_read_b64_tr_b16 v[34:35], v15 offset:4608
    buffer_load_dwordx4 v5, s[36:39], s72 offen offset:3072 lds
    v_mfma_f32_32x32x16_bf16 v[172:187], v[36:39], a[108:111], v[172:187]
    ds_read_b64_tr_b16 a[24:25], v26 offset:0
    ds_read_b64_tr_b16 a[26:27], v26 offset:1024
    s_waitcnt lgkmcnt(10)
    v_mfma_f32_32x32x16_bf16 v[188:203], v[40:43], a[104:107], v[188:203]
    ds_read_b64_tr_b16 v[36:37], v14 offset:6144
    ds_read_b64_tr_b16 v[38:39], v14 offset:6656
    s_add_u32 m0, s27, 0
    s_add_u32 s77, s89, 180224
    buffer_load_dwordx4 v24, s[44:47], s77 offen lds
    buffer_load_dwordx4 v25, s[44:47], s77 offen offset:1024 lds
    v_mfma_f32_32x32x16_bf16 v[204:219], v[40:43], a[108:111], v[204:219]
    ds_read_b64_tr_b16 a[28:29], v27 offset:0
    ds_read_b64_tr_b16 a[30:31], v27 offset:1024
    s_waitcnt lgkmcnt(10)
    v_mfma_f32_32x32x16_bf16 v[156:171], v[28:31], a[112:115], v[156:171]
    ds_read_b64_tr_b16 v[40:41], v15 offset:6144
    ds_read_b64_tr_b16 v[42:43], v15 offset:6656
    v_mfma_f32_32x32x16_bf16 v[172:187], v[28:31], a[116:119], v[172:187]
    ds_read_b64_tr_b16 a[32:33], v26 offset:2048
    ds_read_b64_tr_b16 a[34:35], v26 offset:3072
    s_add_u32 m0, s27, 2048
    s_add_u32 s77, s89, 196608
    buffer_load_dwordx4 v24, s[44:47], s77 offen lds
    buffer_load_dwordx4 v25, s[44:47], s77 offen offset:1024 lds
    s_waitcnt lgkmcnt(10)
    v_mfma_f32_32x32x16_bf16 v[188:203], v[32:35], a[112:115], v[188:203]
    ds_read_b64_tr_b16 a[36:37], v27 offset:2048
    ds_read_b64_tr_b16 a[38:39], v27 offset:3072
    v_mfma_f32_32x32x16_bf16 v[204:219], v[32:35], a[116:119], v[204:219]
    s_waitcnt lgkmcnt(0)
    s_waitcnt vmcnt(12)
    s_barrier
    v_mfma_f32_32x32x16_bf16 v[156:171], v[36:39], a[120:123], v[156:171]
    ds_read_b64_tr_b16 v[28:29], v12 offset:0
    ds_read_b64_tr_b16 v[30:31], v12 offset:512
    v_mfma_f32_32x32x16_bf16 v[172:187], v[36:39], a[124:127], v[172:187]
    ds_read_b64_tr_b16 v[32:33], v13 offset:0
    ds_read_b64_tr_b16 v[34:35], v13 offset:512
    v_mfma_f32_32x32x16_bf16 v[188:203], v[40:43], a[120:123], v[188:203]
    ds_read_b64_tr_b16 v[36:37], v12 offset:2048
    ds_read_b64_tr_b16 v[38:39], v12 offset:2560
    v_mfma_f32_32x32x16_bf16 v[204:219], v[40:43], a[124:127], v[204:219]
    s_add_u32 s69, s81, 6
    s_and_b32 s69, s69, 7
    s_mul_i32 s72, s69, 229376
    s_add_u32 s72, s72, s74
    s_add_u32 m0, s87, 81920
    s_waitcnt lgkmcnt(4)
    v_mfma_f32_32x32x16_bf16 v[156:171], v[28:31], a[128:131], v[156:171]
    ds_read_b64_tr_b16 v[40:41], v13 offset:2048
    ds_read_b64_tr_b16 v[42:43], v13 offset:2560
    buffer_load_dwordx4 v2, s[36:39], s72 offen offset:0 lds
    v_mfma_f32_32x32x16_bf16 v[172:187], v[28:31], a[132:135], v[172:187]
    ds_read_b64_tr_b16 a[40:41], v26 offset:4096
    ds_read_b64_tr_b16 a[42:43], v26 offset:5120
    buffer_load_dwordx4 v3, s[36:39], s72 offen offset:1024 lds
    s_waitcnt lgkmcnt(6)
    v_mfma_f32_32x32x16_bf16 v[188:203], v[32:35], a[128:131], v[188:203]
    ds_read_b64_tr_b16 v[28:29], v12 offset:4096
    ds_read_b64_tr_b16 v[30:31], v12 offset:4608
    buffer_load_dwordx4 v4, s[36:39], s72 offen offset:2048 lds
    v_mfma_f32_32x32x16_bf16 v[204:219], v[32:35], a[132:135], v[204:219]
    ds_read_b64_tr_b16 a[44:45], v27 offset:4096
    ds_read_b64_tr_b16 a[46:47], v27 offset:5120
    buffer_load_dwordx4 v5, s[36:39], s72 offen offset:3072 lds
    s_waitcnt lgkmcnt(8)
    v_mfma_f32_32x32x16_bf16 v[156:171], v[36:39], a[136:139], v[156:171]
    ds_read_b64_tr_b16 v[32:33], v13 offset:4096
    ds_read_b64_tr_b16 v[34:35], v13 offset:4608
    s_add_u32 m0, s27, 4096
    s_add_u32 s77, s89, 212992
    buffer_load_dwordx4 v24, s[44:47], s77 offen lds
    buffer_load_dwordx4 v25, s[44:47], s77 offen offset:1024 lds
    v_mfma_f32_32x32x16_bf16 v[172:187], v[36:39], a[140:143], v[172:187]
    ds_read_b64_tr_b16 a[48:49], v26 offset:6144
    ds_read_b64_tr_b16 a[50:51], v26 offset:7168
    s_waitcnt lgkmcnt(10)
    v_mfma_f32_32x32x16_bf16 v[188:203], v[40:43], a[136:139], v[188:203]
    ds_read_b64_tr_b16 v[36:37], v12 offset:6144
    ds_read_b64_tr_b16 v[38:39], v12 offset:6656
    v_mfma_f32_32x32x16_bf16 v[204:219], v[40:43], a[140:143], v[204:219]
    ds_read_b64_tr_b16 a[52:53], v27 offset:6144
    ds_read_b64_tr_b16 a[54:55], v27 offset:7168
    v_and_b32 v252, 15, v0
    v_lshlrev_b32 v252, 7, v252
    s_lshl_b32 s71, s63, 11
    s_add_u32 s71, s71, 393216
    buffer_load_dword v251, v252, s[40:43], s71 offen sc1
    s_add_u32 m0, s27, 40960
    s_add_u32 s77, s89, 229376
    buffer_load_dwordx4 v24, s[44:47], s77 offen lds
    buffer_load_dwordx4 v25, s[44:47], s77 offen offset:1024 lds
    s_waitcnt lgkmcnt(10)
    v_mfma_f32_32x32x16_bf16 v[156:171], v[28:31], a[144:147], v[156:171]
    ds_read_b64_tr_b16 v[40:41], v13 offset:6144
    ds_read_b64_tr_b16 v[42:43], v13 offset:6656
    v_mfma_f32_32x32x16_bf16 v[172:187], v[28:31], a[148:151], v[172:187]
    ds_read_b64_tr_b16 a[56:57], v58 offset:0
    ds_read_b64_tr_b16 a[58:59], v58 offset:1024
    s_add_u32 m0, s27, 43008
    s_add_u32 s77, s89, 245760
    buffer_load_dwordx4 v24, s[44:47], s77 offen lds
    buffer_load_dwordx4 v25, s[44:47], s77 offen offset:1024 lds
    s_waitcnt lgkmcnt(10)
    v_mfma_f32_32x32x16_bf16 v[188:203], v[32:35], a[144:147], v[188:203]
    ds_read_b64_tr_b16 a[60:61], v59 offset:0
    ds_read_b64_tr_b16 a[62:63], v59 offset:1024
    v_mfma_f32_32x32x16_bf16 v[204:219], v[32:35], a[148:151], v[204:219]
    s_waitcnt lgkmcnt(0)
    s_waitcnt vmcnt(15)
    s_barrier
    v_mfma_f32_32x32x16_bf16 v[156:171], v[36:39], a[152:155], v[156:171]
    ds_read_b64_tr_b16 v[28:29], v12 offset:40960
    ds_read_b64_tr_b16 v[30:31], v12 offset:41472
    v_mfma_f32_32x32x16_bf16 v[172:187], v[36:39], a[156:159], v[172:187]
    ds_read_b64_tr_b16 v[32:33], v13 offset:40960
    ds_read_b64_tr_b16 v[34:35], v13 offset:41472
    v_mfma_f32_32x32x16_bf16 v[188:203], v[40:43], a[152:155], v[188:203]
    ds_read_b64_tr_b16 v[36:37], v12 offset:43008
    ds_read_b64_tr_b16 v[38:39], v12 offset:43520
    v_mfma_f32_32x32x16_bf16 v[204:219], v[40:43], a[156:159], v[204:219]
    s_lshl_b32 s78, s63, 4
    s_add_u32 s78, s78, s61
    s_lshl_b32 s78, s78, 14
    s_lshl_b32 s79, s60, 8
    s_add_u32 s78, s78, s79
    s_add_u32 s78, s78, 1048576
    v_lshrrev_b32 v236, 4, v0
    v_lshlrev_b32 v236, 12, v236
    v_and_b32 v237, 0xf0, v1
    v_add_u32 v236, v237, v236
    s_waitcnt vmcnt(4)
    v_cmp_ne_u32 vcc, s68, v251
    s_cbranch_vccz L_pd_19
    s_mov_b32 s94, 0
L_pl_18:
    buffer_load_dword v251, v252, s[40:43], s71 offen sc1
    s_add_u32 s94, s94, 1
    s_waitcnt vmcnt(0)
    v_cmp_ne_u32 vcc, s68, v251
    s_cbranch_vccz L_pd_19
    s_cmp_lt_u32 s94, s97
    s_cbranch_scc1 L_pl_18
    s_mov_b32 s97, 0
L_pd_19:
    buffer_load_dwordx4 v[220:223], v236, s[40:43], s78 offen offset:0 sc1
    buffer_load_dwordx4 v[224:227], v236, s[40:43], s78 offen offset:1024 sc1
    buffer_load_dwordx4 v[228:231], v236, s[40:43], s78 offen offset:2048 sc1
    buffer_load_dwordx4 v[232:235], v236, s[40:43], s78 offen offset:3072 sc1
    s_add_u32 s69, s81, 7
    s_and_b32 s69, s69, 7
    s_mul_i32 s72, s69, 229376
    s_add_u32 s72, s72, s74
    s_add_u32 m0, s87, 0
    s_waitcnt lgkmcnt(4)
    v_mfma_f32_32x32x16_bf16 v[156:171], v[28:31], a[160:163], v[156:171]
    ds_read_b64_tr_b16 v[40:41], v13 offset:43008
    ds_read_b64_tr_b16 v[42:43], v13 offset:43520
    buffer_load_dwordx4 v2, s[36:39], s72 offen offset:0 lds
    v_mfma_f32_32x32x16_bf16 v[172:187], v[28:31], a[164:167], v[172:187]
    ds_read_b64_tr_b16 a[64:65], v54 offset:0
    ds_read_b64_tr_b16 a[66:67], v54 offset:1024
    buffer_load_dwordx4 v3, s[36:39], s72 offen offset:1024 lds
    s_waitcnt lgkmcnt(6)
    v_mfma_f32_32x32x16_bf16 v[188:203], v[32:35], a[160:163], v[188:203]
    ds_read_b64_tr_b16 v[28:29], v12 offset:45056
    ds_read_b64_tr_b16 v[30:31], v12 offset:45568
    v_mfma_f32_32x32x16_bf16 v[204:219], v[32:35], a[164:167], v[204:219]
    ds_read_b64_tr_b16 a[68:69], v55 offset:0
    ds_read_b64_tr_b16 a[70:71], v55 offset:1024
    buffer_load_dwordx4 v4, s[36:39], s72 offen offset:2048 lds
    s_waitcnt lgkmcnt(8)
    v_mfma_f32_32x32x16_bf16 v[156:171], v[36:39], a[168:171], v[156:171]
    ds_read_b64_tr_b16 v[32:33], v13 offset:45056
    ds_read_b64_tr_b16 v[34:35], v13 offset:45568
    buffer_load_dwordx4 v5, s[36:39], s72 offen offset:3072 lds
    v_mfma_f32_32x32x16_bf16 v[172:187], v[36:39], a[172:175], v[172:187]
    ds_read_b64_tr_b16 a[72:73], v54 offset:2048
    ds_read_b64_tr_b16 a[74:75], v54 offset:3072
    s_waitcnt lgkmcnt(10)
    v_mfma_f32_32x32x16_bf16 v[188:203], v[40:43], a[168:171], v[188:203]
    ds_read_b64_tr_b16 v[36:37], v12 offset:47104
    ds_read_b64_tr_b16 v[38:39], v12 offset:47616
    s_add_u32 m0, s27, 45056
    s_add_u32 s77, s89, 262144
    buffer_load_dwordx4 v24, s[44:47], s77 offen lds
    buffer_load_dwordx4 v25, s[44:47], s77 offen offset:1024 lds
    v_mfma_f32_32x32x16_bf16 v[204:219], v[40:43], a[172:175], v[204:219]
    ds_read_b64_tr_b16 a[76:77], v55 offset:2048
    ds_read_b64_tr_b16 a[78:79], v55 offset:3072
    s_waitcnt lgkmcnt(10)
    v_mfma_f32_32x32x16_bf16 v[156:171], v[28:31], a[176:179], v[156:171]
    ds_read_b64_tr_b16 v[40:41], v13 offset:47104
    ds_read_b64_tr_b16 v[42:43], v13 offset:47616
    v_mfma_f32_32x32x16_bf16 v[172:187], v[28:31], a[180:183], v[172:187]
    ds_read_b64_tr_b16 a[80:81], v54 offset:4096
    ds_read_b64_tr_b16 a[82:83], v54 offset:5120
    s_add_u32 m0, s93, 0
    s_add_u32 s77, s89, 278528
    buffer_load_dwordx4 v24, s[44:47], s77 offen lds
    buffer_load_dwordx4 v25, s[44:47], s77 offen offset:1024 lds
    s_waitcnt lgkmcnt(10)
    v_mfma_f32_32x32x16_bf16 v[188:203], v[32:35], a[176:179], v[188:203]
    ds_read_b64_tr_b16 a[84:85], v55 offset:4096
    ds_read_b64_tr_b16 a[86:87], v55 offset:5120
    v_mfma_f32_32x32x16_bf16 v[204:219], v[32:35], a[180:183], v[204:219]
    s_waitcnt lgkmcnt(0)
    s_barrier
    v_mfma_f32_32x32x16_bf16 v[156:171], v[36:39], a[184:187], v[156:171]
    ds_read_b64_tr_b16 v[28:29], v14 offset:0
    ds_read_b64_tr_b16 v[30:31], v14 offset:512
    v_mfma_f32_32x32x16_bf16 v[172:187], v[36:39], a[188:191], v[172:187]
    ds_read_b64_tr_b16 v[32:33], v15 offset:0
    ds_read_b64_tr_b16 v[34:35], v15 offset:512
    v_mfma_f32_32x32x16_bf16 v[188:203], v[40:43], a[184:187], v[188:203]
    ds_read_b64_tr_b16 v[36:37], v14 offset:2048
    ds_read_b64_tr_b16 v[38:39], v14 offset:2560
    v_mfma_f32_32x32x16_bf16 v[204:219], v[40:43], a[188:191], v[204:219]
    s_lshl_b32 s78, s63, 4
    s_add_u32 s78, s78, s61
    s_lshl_b32 s78, s78, 9
    s_lshl_b32 s79, s65, 8
    s_add_u32 s78, s78, s79
    s_lshl_b32 s79, s64, 3
    s_add_u32 s78, s78, s79
    s_add_u32 s78, s78, 65536
    s_waitcnt vmcnt(8)
    v_pk_add_f32 v[220:221], v[220:221], v[224:225]
    v_pk_add_f32 v[228:229], v[228:229], v[232:233]
    v_pk_add_f32 v[222:223], v[222:223], v[226:227]
    v_pk_add_f32 v[230:231], v[230:231], v[234:235]
    v_pk_add_f32 v[220:221], v[220:221], v[228:229]
    v_pk_add_f32 v[222:223], v[222:223], v[230:231]
    v_mov_b32 v224, v220
    v_mov_b32 v225, v221
    v_mov_b32 v226, v222
    v_mov_b32 v227, v223
    v_permlane16_swap_b32 v224, v220
    v_permlane16_swap_b32 v225, v221
    v_permlane16_swap_b32 v226, v222
    v_permlane16_swap_b32 v227, v223
    v_pk_add_f32 v[220:221], v[220:221], v[224:225]
    v_pk_add_f32 v[222:223], v[222:223], v[226:227]
    v_mov_b32 v224, v220
    v_mov_b32 v225, v221
    v_mov_b32 v226, v222
    v_mov_b32 v227, v223
    v_permlane32_swap_b32 v224, v220
    v_permlane32_swap_b32 v225, v221
    v_permlane32_swap_b32 v226, v222
    v_permlane32_swap_b32 v227, v223
    v_pk_add_f32 v[220:221], v[220:221], v[224:225]
    v_pk_add_f32 v[222:223], v[222:223], v[226:227]
    v_cvt_pk_bf16_f32 v220, v220, v221
    v_cvt_pk_bf16_f32 v221, v222, v223
    s_mov_b64 exec, 0xffff
    buffer_store_dwordx2 v[220:221], v237, s[40:43], s78 offen sc1
    s_mov_b64 exec, -1
    v_and_b32 v252, 7, v0
    s_lshl_b32 s78, s65, 3
    v_add_lshl_u32 v252, v252, s78, 7
    s_lshl_b32 s0, s63, 11
    s_add_u32 s0, s0, 458752
    s_lshl_b32 s71, s63, 1
    s_add_u32 s71, s71, s65
    s_lshl_b32 s86, s71, 12
    s_add_u32 s86, s86, 65536
    s_lshl_b32 s71, s71, 11
    s_add_u32 s71, s71, s96
    s_add_u32 s71, s71, 114688
    s_add_u32 s3, s71, 147456
    s_waitcnt lgkmcnt(4)
    v_mfma_f32_32x32x16_bf16 v[156:171], v[28:31], a[192:195], v[156:171]
    ds_read_b64_tr_b16 v[40:41], v15 offset:2048
    ds_read_b64_tr_b16 v[42:43], v15 offset:2560
    s_add_u32 m0, s93, 2048
    s_add_u32 s77, s89, 294912
    buffer_load_dwordx4 v24, s[44:47], s77 offen lds
    buffer_load_dwordx4 v25, s[44:47], s77 offen offset:1024 lds
    v_mfma_f32_32x32x16_bf16 v[172:187], v[28:31], a[196:199], v[172:187]
    ds_read_b64_tr_b16 a[88:89], v52 offset:0
    ds_read_b64_tr_b16 a[90:91], v52 offset:1024
    s_waitcnt lgkmcnt(6)
    v_mfma_f32_32x32x16_bf16 v[188:203], v[32:35], a[192:195], v[188:203]
    ds_read_b64_tr_b16 v[28:29], v14 offset:4096
    ds_read_b64_tr_b16 v[30:31], v14 offset:4608
    v_mfma_f32_32x32x16_bf16 v[204:219], v[32:35], a[196:199], v[204:219]
    ds_read_b64_tr_b16 a[92:93], v53 offset:0
    ds_read_b64_tr_b16 a[94:95], v53 offset:1024
    s_waitcnt lgkmcnt(8)
    v_mfma_f32_32x32x16_bf16 v[156:171], v[36:39], a[200:203], v[156:171]
    ds_read_b64_tr_b16 v[32:33], v15 offset:4096
    ds_read_b64_tr_b16 v[34:35], v15 offset:4608
    v_mfma_f32_32x32x16_bf16 v[172:187], v[36:39], a[204:207], v[172:187]
    ds_read_b64_tr_b16 a[96:97], v52 offset:2048
    ds_read_b64_tr_b16 a[98:99], v52 offset:3072
    s_waitcnt lgkmcnt(10)
    v_mfma_f32_32x32x16_bf16 v[188:203], v[40:43], a[200:203], v[188:203]
    ds_read_b64_tr_b16 v[36:37], v14 offset:6144
    ds_read_b64_tr_b16 v[38:39], v14 offset:6656
    s_add_u32 m0, s93, 4096
    s_add_u32 s77, s89, 311296
    buffer_load_dwordx4 v24, s[44:47], s77 offen lds
    buffer_load_dwordx4 v25, s[44:47], s77 offen offset:1024 lds
    v_mfma_f32_32x32x16_bf16 v[204:219], v[40:43], a[204:207], v[204:219]
    ds_read_b64_tr_b16 a[100:101], v53 offset:2048
    ds_read_b64_tr_b16 a[102:103], v53 offset:3072
    s_waitcnt lgkmcnt(10)
    v_mfma_f32_32x32x16_bf16 v[156:171], v[28:31], a[208:211], v[156:171]
    ds_read_b64_tr_b16 v[40:41], v15 offset:6144
    ds_read_b64_tr_b16 v[42:43], v15 offset:6656
    v_mfma_f32_32x32x16_bf16 v[172:187], v[28:31], a[212:215], v[172:187]
    ds_read_b64_tr_b16 a[104:105], v52 offset:4096
    ds_read_b64_tr_b16 a[106:107], v52 offset:5120
    s_waitcnt lgkmcnt(10)
    v_mfma_f32_32x32x16_bf16 v[188:203], v[32:35], a[208:211], v[188:203]
    ds_read_b64_tr_b16 a[108:109], v53 offset:4096
    ds_read_b64_tr_b16 a[110:111], v53 offset:5120
    v_mfma_f32_32x32x16_bf16 v[204:219], v[32:35], a[212:215], v[204:219]
    s_waitcnt lgkmcnt(0)
    s_waitcnt vmcnt(4)
    s_barrier
    s_cmp_lg_u32 s60, 0
    s_cbranch_scc1 L_fl_20
    s_lshl_b32 s79, s63, 4
    s_add_u32 s79, s79, s61
    s_lshl_b32 s79, s79, 7
    v_mov_b32 v254, s68
    s_add_u32 s79, s79, 458752
    s_mov_b64 exec, 1
    buffer_store_dword v254, off, s[40:43], s79 sc1
    s_mov_b64 exec, -1
L_fl_20:
    v_mfma_f32_32x32x16_bf16 v[156:171], v[36:39], a[216:219], v[156:171]
    ds_read_b64_tr_b16 v[28:29], v12 offset:0
    ds_read_b64_tr_b16 v[30:31], v12 offset:512
    v_mfma_f32_32x32x16_bf16 v[172:187], v[36:39], a[220:223], v[172:187]
    ds_read_b64_tr_b16 v[32:33], v13 offset:0
    ds_read_b64_tr_b16 v[34:35], v13 offset:512
    v_mfma_f32_32x32x16_bf16 v[188:203], v[40:43], a[216:219], v[188:203]
    ds_read_b64_tr_b16 v[36:37], v12 offset:2048
    ds_read_b64_tr_b16 v[38:39], v12 offset:2560
    v_mfma_f32_32x32x16_bf16 v[204:219], v[40:43], a[220:223], v[204:219]
    s_waitcnt lgkmcnt(4)
    v_mfma_f32_32x32x16_bf16 v[156:171], v[28:31], a[224:227], v[156:171]
    ds_read_b64_tr_b16 v[40:41], v13 offset:2048
    ds_read_b64_tr_b16 v[42:43], v13 offset:2560
    v_mfma_f32_32x32x16_bf16 v[172:187], v[28:31], a[228:231], v[172:187]
    ds_read_b64_tr_b16 a[112:113], v52 offset:40960
    ds_read_b64_tr_b16 a[114:115], v52 offset:41984
    s_waitcnt lgkmcnt(6)
    v_mfma_f32_32x32x16_bf16 v[188:203], v[32:35], a[224:227], v[188:203]
    ds_read_b64_tr_b16 v[28:29], v12 offset:4096
    ds_read_b64_tr_b16 v[30:31], v12 offset:4608
    v_mfma_f32_32x32x16_bf16 v[204:219], v[32:35], a[228:231], v[204:219]
    ds_read_b64_tr_b16 a[116:117], v53 offset:40960
    ds_read_b64_tr_b16 a[118:119], v53 offset:41984
    s_waitcnt lgkmcnt(8)
    v_mfma_f32_32x32x16_bf16 v[156:171], v[36:39], a[232:235], v[156:171]
    ds_read_b64_tr_b16 v[32:33], v13 offset:4096
    ds_read_b64_tr_b16 v[34:35], v13 offset:4608
    v_mfma_f32_32x32x16_bf16 v[172:187], v[36:39], a[236:239], v[172:187]
    ds_read_b64_tr_b16 a[120:121], v52 offset:43008
    ds_read_b64_tr_b16 a[122:123], v52 offset:44032
    s_waitcnt lgkmcnt(10)
    v_mfma_f32_32x32x16_bf16 v[188:203], v[40:43], a[232:235], v[188:203]
    ds_read_b64_tr_b16 v[36:37], v12 offset:6144
    ds_read_b64_tr_b16 v[38:39], v12 offset:6656
    v_mfma_f32_32x32x16_bf16 v[204:219], v[40:43], a[236:239], v[204:219]
    ds_read_b64_tr_b16 a[124:125], v53 offset:43008
    ds_read_b64_tr_b16 a[126:127], v53 offset:44032
    s_waitcnt lgkmcnt(10)
    v_mfma_f32_32x32x16_bf16 v[156:171], v[28:31], a[240:243], v[156:171]
    ds_read_b64_tr_b16 v[40:41], v13 offset:6144
    ds_read_b64_tr_b16 v[42:43], v13 offset:6656
    v_mfma_f32_32x32x16_bf16 v[172:187], v[28:31], a[244:247], v[172:187]
    ds_read_b64_tr_b16 a[128:129], v52 offset:45056
    ds_read_b64_tr_b16 a[130:131], v52 offset:46080
    s_add_u32 s70, s26, 196608
    s_add_u32 s1, s26, 262144
    v_and_b32 v250, 1, v0
    v_lshlrev_b32 v250, 8, v250
    s_lshl_b32 s78, s60, 9
    v_add_u32 v245, s78, v250
    v_add_u32 v250, 128, v245
    buffer_load_dword v253, v250, s[40:43], s70 offen sc1
    s_waitcnt lgkmcnt(10)
    v_mfma_f32_32x32x16_bf16 v[188:203], v[32:35], a[240:243], v[188:203]
    ds_read_b64_tr_b16 a[132:133], v53 offset:45056
    ds_read_b64_tr_b16 a[134:135], v53 offset:46080
    v_mfma_f32_32x32x16_bf16 v[204:219], v[32:35], a[244:247], v[204:219]
    s_waitcnt lgkmcnt(8)
    v_mfma_f32_32x32x16_bf16 v[156:171], v[36:39], a[248:251], v[156:171]
    v_mfma_f32_32x32x16_bf16 v[172:187], v[36:39], a[252:255], v[172:187]
    buffer_load_dword v251, v252, s[40:43], s0 offen sc1
    s_waitcnt lgkmcnt(4)
    v_mfma_f32_32x32x16_bf16 v[188:203], v[40:43], a[248:251], v[188:203]
    v_mfma_f32_32x32x16_bf16 v[204:219], v[40:43], a[252:255], v[204:219]
    s_add_u32 s78, s85, 147456
    s_nop 5
    v_pk_mul_f32 v[156:157], v[156:157], v[164:165]
    v_pk_mul_f32 v[158:159], v[158:159], v[166:167]
    v_pk_mul_f32 v[160:161], v[160:161], v[168:169]
    v_pk_mul_f32 v[162:163], v[162:163], v[170:171]
    v_cvt_pk_bf16_f32 v28, v156, v157
    v_cvt_pk_bf16_f32 v29, v158, v159
    v_cvt_pk_bf16_f32 v30, v160, v161
    v_cvt_pk_bf16_f32 v31, v162, v163
    buffer_store_dwordx4 v[28:31], v1, s[40:43], s85 offen offset:0 sc1
    v_pk_mul_f32 v[188:189], v[188:189], v[196:197]
    v_pk_mul_f32 v[190:191], v[190:191], v[198:199]
    v_pk_mul_f32 v[192:193], v[192:193], v[200:201]
    v_pk_mul_f32 v[194:195], v[194:195], v[202:203]
    v_cvt_pk_bf16_f32 v32, v188, v189
    v_cvt_pk_bf16_f32 v33, v190, v191
    v_cvt_pk_bf16_f32 v34, v192, v193
    v_cvt_pk_bf16_f32 v35, v194, v195
    buffer_store_dwordx4 v[32:35], v1, s[40:43], s85 offen offset:1024 sc1
    v_pk_mul_f32 v[172:173], v[172:173], v[180:181]
    v_pk_mul_f32 v[174:175], v[174:175], v[182:183]
    v_pk_mul_f32 v[176:177], v[176:177], v[184:185]
    v_pk_mul_f32 v[178:179], v[178:179], v[186:187]
    v_cvt_pk_bf16_f32 v36, v172, v173
    v_cvt_pk_bf16_f32 v37, v174, v175
    v_cvt_pk_bf16_f32 v38, v176, v177
    v_cvt_pk_bf16_f32 v39, v178, v179
    buffer_store_dwordx4 v[36:39], v1, s[40:43], s78 offen offset:0 sc1
    v_pk_mul_f32 v[204:205], v[204:205], v[212:213]
    v_pk_mul_f32 v[206:207], v[206:207], v[214:215]
    v_pk_mul_f32 v[208:209], v[208:209], v[216:217]
    v_pk_mul_f32 v[210:211], v[210:211], v[218:219]
    v_cvt_pk_bf16_f32 v40, v204, v205
    v_cvt_pk_bf16_f32 v41, v206, v207
    v_cvt_pk_bf16_f32 v42, v208, v209
    v_cvt_pk_bf16_f32 v43, v210, v211
    buffer_store_dwordx4 v[40:43], v1, s[40:43], s78 offen offset:1024 sc1
    s_waitcnt vmcnt(5)
    v_cmp_ne_u32 vcc, s68, v253
    s_cbranch_vccz L_pd_22
    s_mov_b32 s94, 0
L_pl_21:
    buffer_load_dword v253, v250, s[40:43], s70 offen sc1
    s_add_u32 s94, s94, 1
    s_waitcnt vmcnt(0)
    v_cmp_ne_u32 vcc, s68, v253
    s_cbranch_vccz L_pd_22
    s_cmp_lt_u32 s94, s97
    s_cbranch_scc1 L_pl_21
    s_mov_b32 s97, 0
L_pd_22:
    s_add_u32 s75, s91, 0
    s_add_u32 s76, s92, 0
    buffer_load_dwordx4 a[136:139], v1, s[40:43], s75 offen offset:0 sc1
    buffer_load_dwordx4 a[140:143], v1, s[40:43], s76 offen offset:0 sc1
    buffer_load_dwordx4 a[144:147], v1, s[40:43], s75 offen offset:1024 sc1
    buffer_load_dwordx4 a[148:151], v1, s[40:43], s76 offen offset:1024 sc1
    buffer_load_dwordx4 a[152:155], v1, s[40:43], s75 offen offset:2048 sc1
    buffer_load_dwordx4 a[156:159], v1, s[40:43], s76 offen offset:2048 sc1
    buffer_load_dwordx4 a[160:163], v1, s[40:43], s75 offen offset:3072 sc1
    buffer_load_dwordx4 a[164:167], v1, s[40:43], s76 offen offset:3072 sc1
    s_lshl_b32 s78, s66, 1
    s_add_u32 s78, s78, s64
    s_lshl_b32 s78, s78, 15
    s_lshl_b32 s79, s67, 1
    s_add_u32 s79, s79, s65
    s_lshl_b32 s79, s79, 6
    s_add_u32 s73, s78, s79
    s_add_u32 s74, s26, 327680
    v_and_b32 v248, 31, v0
    v_lshrrev_b32 v247, 5, v0
    v_and_b32 v249, 15, v0
    v_lshlrev_b32_e64 v249, 10, v249
    v_lshl_add_u32 v249, v247, 4, v249
    v_bfe_u32 v243, v0, 4, 1
    v_lshl_add_u32 v249, v243, 5, v249
    s_add_u32 s85, s73, 16384
    v_lshlrev_b32 v248, 10, v248
    v_lshl_add_u32 v248, v247, 3, v248
    s_xor_b32 s78, s60, 1
    s_mul_i32 s78, s78, 12288
    s_add_u32 s78, s78, 0
    v_add_u32 v239, s78, v1
    s_xor_b32 s78, s60, 2
    s_mul_i32 s78, s78, 12288
    s_add_u32 s78, s78, 4096
    v_add_u32 v240, s78, v1
    s_xor_b32 s78, s60, 3
    s_mul_i32 s78, s78, 12288
    s_add_u32 s78, s78, 8192
    v_add_u32 v241, s78, v1
    s_mul_i32 s78, s60, 12288
    v_add_u32 v238, s78, v1
    s_waitcnt vmcnt(8)
    s_barrier
    s_cmp_lg_u32 s60, 0
    s_cbranch_scc1 L_fl_23
    s_lshl_b32 s79, s61, 4
    s_add_u32 s79, s79, s62
    s_lshl_b32 s79, s79, 7
    v_mov_b32 v254, s68
    s_add_u32 s79, s79, 262144
    s_mov_b64 exec, 1
    buffer_store_dword v254, off, s[40:43], s79 sc1
    s_mov_b64 exec, -1
L_fl_23:
    v_cmp_ne_u32 vcc, s68, v251
    s_cbranch_vccz L_pd_25
    s_mov_b32 s94, 0
L_pl_24:
    buffer_load_dword v251, v252, s[40:43], s0 offen sc1
    s_add_u32 s94, s94, 1
    s_waitcnt vmcnt(0)
    v_cmp_ne_u32 vcc, s68, v251
    s_cbranch_vccz L_pd_25
    s_cmp_lt_u32 s94, s97
    s_cbranch_scc1 L_pl_24
    s_mov_b32 s97, 0
L_pd_25:
    buffer_load_dwordx4 v[220:223], v1, s[40:43], s86 offen offset:0 sc1
    buffer_load_dwordx4 v[224:227], v1, s[40:43], s86 offen offset:1024 sc1
    buffer_load_dwordx4 v[228:231], v1, s[40:43], s86 offen offset:2048 sc1
    buffer_load_dwordx4 v[232:235], v1, s[40:43], s86 offen offset:3072 sc1
    s_lshl_b32 s79, s61, 4
    s_add_u32 s79, s79, s62
    s_lshl_b32 s79, s79, 2
    s_add_u32 s79, s79, s60
    s_cmp_lg_u32 s79, 6
    s_cbranch_scc1 L_nx_26
    v_mov_b32 v254, s68
    s_mov_b64 exec, 1
    buffer_store_dword v254, off, s[40:43], 0 sc1
    s_mov_b64 exec, -1
L_nx_26:
    s_add_u32 s75, s91, 20480
    s_add_u32 s76, s92, 20480
    buffer_load_dwordx4 a[168:171], v1, s[40:43], s75 offen offset:0 sc1
    buffer_load_dwordx4 a[172:175], v1, s[40:43], s76 offen offset:0 sc1
    buffer_load_dwordx4 a[176:179], v1, s[40:43], s75 offen offset:1024 sc1
    buffer_load_dwordx4 a[180:183], v1, s[40:43], s76 offen offset:1024 sc1
    buffer_load_dwordx4 a[184:187], v1, s[40:43], s75 offen offset:2048 sc1
    buffer_load_dwordx4 a[188:191], v1, s[40:43], s76 offen offset:2048 sc1
    buffer_load_dwordx4 a[192:195], v1, s[40:43], s75 offen offset:3072 sc1
    buffer_load_dwordx4 a[196:199], v1, s[40:43], s76 offen offset:3072 sc1
    s_waitcnt vmcnt(8)
    v_mfma_f32_32x32x16_bf16 v[156:171], v[220:223], v[124:127], 0
    v_mfma_f32_32x32x16_bf16 v[156:171], v[224:227], v[128:131], v[156:171]
    v_mfma_f32_32x32x16_bf16 v[172:187], v[228:231], v[132:135], 0
    v_mfma_f32_32x32x16_bf16 v[172:187], v[232:235], v[136:139], v[172:187]
    v_mfma_f32_32x32x16_bf16 v[188:203], v[220:223], v[140:143], 0
    v_mfma_f32_32x32x16_bf16 v[188:203], v[224:227], v[144:147], v[188:203]
    v_mfma_f32_32x32x16_bf16 v[204:219], v[228:231], v[148:151], 0
    v_mfma_f32_32x32x16_bf16 v[204:219], v[232:235], v[152:155], v[204:219]
    s_nop 5
    v_add_f32 v164, 0x358637bd, v164
    v_rcp_f32 v164, v164
    s_nop 0
    v_mul_f32 v156, v156, v164
    v_mul_f32 v157, v157, v164
    v_mul_f32 v158, v158, v164
    v_mul_f32 v159, v159, v164
    v_mul_f32 v160, v160, v164
    v_mul_f32 v161, v161, v164
    v_mul_f32 v162, v162, v164
    v_mul_f32 v163, v163, v164
    v_cvt_pk_bf16_f32 v168, v156, v157
    v_cvt_pk_bf16_f32 v169, v158, v159
    v_cvt_pk_bf16_f32 v170, v160, v161
    v_cvt_pk_bf16_f32 v171, v162, v163
    buffer_store_dwordx4 v[168:171], v1, s[40:43], s71 offen offset:0 sc1
    v_add_f32 v180, 0x358637bd, v180
    v_rcp_f32 v180, v180
    s_nop 0
    v_mul_f32 v172, v172, v180
    v_mul_f32 v173, v173, v180
    v_mul_f32 v174, v174, v180
    v_mul_f32 v175, v175, v180
    v_mul_f32 v176, v176, v180
    v_mul_f32 v177, v177, v180
    v_mul_f32 v178, v178, v180
    v_mul_f32 v179, v179, v180
    v_cvt_pk_bf16_f32 v184, v172, v173
    v_cvt_pk_bf16_f32 v185, v174, v175
    v_cvt_pk_bf16_f32 v186, v176, v177
    v_cvt_pk_bf16_f32 v187, v178, v179
    buffer_store_dwordx4 v[184:187], v1, s[40:43], s71 offen offset:1024 sc1
    v_add_f32 v196, 0x358637bd, v196
    v_rcp_f32 v196, v196
    s_nop 0
    v_mul_f32 v188, v188, v196
    v_mul_f32 v189, v189, v196
    v_mul_f32 v190, v190, v196
    v_mul_f32 v191, v191, v196
    v_mul_f32 v192, v192, v196
    v_mul_f32 v193, v193, v196
    v_mul_f32 v194, v194, v196
    v_mul_f32 v195, v195, v196
    v_cvt_pk_bf16_f32 v200, v188, v189
    v_cvt_pk_bf16_f32 v201, v190, v191
    v_cvt_pk_bf16_f32 v202, v192, v193
    v_cvt_pk_bf16_f32 v203, v194, v195
    buffer_store_dwordx4 v[200:203], v1, s[40:43], s3 offen offset:0 sc1
    v_add_f32 v212, 0x358637bd, v212
    v_rcp_f32 v212, v212
    s_nop 0
    v_mul_f32 v204, v204, v212
    v_mul_f32 v205, v205, v212
    v_mul_f32 v206, v206, v212
    v_mul_f32 v207, v207, v212
    v_mul_f32 v208, v208, v212
    v_mul_f32 v209, v209, v212
    v_mul_f32 v210, v210, v212
    v_mul_f32 v211, v211, v212
    v_cvt_pk_bf16_f32 v216, v204, v205
    v_cvt_pk_bf16_f32 v217, v206, v207
    v_cvt_pk_bf16_f32 v218, v208, v209
    v_cvt_pk_bf16_f32 v219, v210, v211
    buffer_store_dwordx4 v[216:219], v1, s[40:43], s3 offen offset:1024 sc1
    buffer_load_dword v246, v250, s[40:43], s1 offen sc1
    v_mfma_f32_32x32x16_bf16 v[156:171], v[60:63], a[136:139], 0
    v_mfma_f32_32x32x16_bf16 v[172:187], v[64:67], a[136:139], 0
    ds_read_b64_tr_b16 a[200:201], v26 offset:0
    ds_read_b64_tr_b16 a[202:203], v26 offset:1024
    ds_read_b64_tr_b16 a[204:205], v27 offset:0
    ds_read_b64_tr_b16 a[206:207], v27 offset:1024
    v_mfma_f32_32x32x16_bf16 v[188:203], v[60:63], a[140:143], 0
    ds_read_b64_tr_b16 a[208:209], v26 offset:2048
    ds_read_b64_tr_b16 a[210:211], v26 offset:3072
    ds_read_b64_tr_b16 a[212:213], v27 offset:2048
    ds_read_b64_tr_b16 a[214:215], v27 offset:3072
    v_mfma_f32_32x32x16_bf16 v[204:219], v[64:67], a[140:143], 0
    v_mfma_f32_32x32x16_bf16 v[156:171], v[68:71], a[144:147], v[156:171]
    v_mfma_f32_32x32x16_bf16 v[172:187], v[72:75], a[144:147], v[172:187]
    ds_read_b64_tr_b16 a[216:217], v26 offset:4096
    ds_read_b64_tr_b16 a[218:219], v26 offset:5120
    ds_read_b64_tr_b16 a[220:221], v27 offset:4096
    ds_read_b64_tr_b16 a[222:223], v27 offset:5120
    v_mfma_f32_32x32x16_bf16 v[188:203], v[68:71], a[148:151], v[188:203]
    v_mfma_f32_32x32x16_bf16 v[204:219], v[72:75], a[148:151], v[204:219]
    v_mfma_f32_32x32x16_bf16 v[156:171], v[76:79], a[152:155], v[156:171]
    v_mfma_f32_32x32x16_bf16 v[172:187], v[80:83], a[152:155], v[172:187]
    v_mfma_f32_32x32x16_bf16 v[188:203], v[76:79], a[156:159], v[188:203]
    v_mfma_f32_32x32x16_bf16 v[204:219], v[80:83], a[156:159], v[204:219]
    s_waitcnt vmcnt(1)
    s_barrier
    s_cmp_lg_u32 s60, 0
    s_cbranch_scc1 L_fl_27
    s_lshl_b32 s79, s61, 4
    s_add_u32 s79, s79, s62
    s_lshl_b32 s79, s79, 7
    v_mov_b32 v254, s68
    s_add_u32 s79, s79, 327680
    s_mov_b64 exec, 1
    buffer_store_dword v254, off, s[40:43], s79 sc1
    s_mov_b64 exec, -1
L_fl_27:
    v_mfma_f32_32x32x16_bf16 v[156:171], v[84:87], a[160:163], v[156:171]
    v_mfma_f32_32x32x16_bf16 v[172:187], v[88:91], a[160:163], v[172:187]
    v_mfma_f32_32x32x16_bf16 v[188:203], v[84:87], a[164:167], v[188:203]
    v_mfma_f32_32x32x16_bf16 v[204:219], v[88:91], a[164:167], v[204:219]
    s_waitcnt vmcnt(0)
    v_cmp_ne_u32 vcc, s68, v246
    s_cbranch_vccz L_pd_29
    s_mov_b32 s94, 0
L_pl_28:
    buffer_load_dword v246, v250, s[40:43], s1 offen sc1
    s_add_u32 s94, s94, 1
    s_waitcnt vmcnt(0)
    v_cmp_ne_u32 vcc, s68, v246
    s_cbranch_vccz L_pd_29
    s_cmp_lt_u32 s94, s97
    s_cbranch_scc1 L_pl_28
    s_mov_b32 s97, 0
L_pd_29:
    s_add_u32 s75, s91, 4096
    s_add_u32 s76, s92, 4096
    buffer_load_dwordx4 a[224:227], v1, s[40:43], s75 offen offset:0 sc1
    buffer_load_dwordx4 a[228:231], v1, s[40:43], s76 offen offset:0 sc1
    buffer_load_dwordx4 a[232:235], v1, s[40:43], s75 offen offset:1024 sc1
    buffer_load_dwordx4 a[236:239], v1, s[40:43], s76 offen offset:1024 sc1
    buffer_load_dwordx4 a[240:243], v1, s[40:43], s75 offen offset:2048 sc1
    buffer_load_dwordx4 a[244:247], v1, s[40:43], s76 offen offset:2048 sc1
    buffer_load_dwordx4 a[248:251], v1, s[40:43], s75 offen offset:3072 sc1
    buffer_load_dwordx4 a[252:255], v1, s[40:43], s76 offen offset:3072 sc1
    v_mfma_f32_32x32x16_bf16 v[156:171], v[92:95], a[168:171], v[156:171]
    s_add_u32 s75, s91, 24576
    s_add_u32 s76, s92, 24576
    buffer_load_dwordx4 a[136:139], v1, s[40:43], s75 offen offset:0 sc1
    buffer_load_dwordx4 a[140:143], v1, s[40:43], s76 offen offset:0 sc1
    v_mfma_f32_32x32x16_bf16 v[172:187], v[96:99], a[168:171], v[172:187]
    v_mfma_f32_32x32x16_bf16 v[188:203], v[92:95], a[172:175], v[188:203]
    v_mfma_f32_32x32x16_bf16 v[204:219], v[96:99], a[172:175], v[204:219]
    s_add_u32 m0, s93, 6144
    s_add_u32 s77, s90, 0
    buffer_load_dwordx4 v24, s[48:51], s77 offen lds
    buffer_load_dwordx4 v25, s[48:51], s77 offen offset:1024 lds
    v_mfma_f32_32x32x16_bf16 v[156:171], v[100:103], a[176:179], v[156:171]
    buffer_load_dwordx4 a[144:147], v1, s[40:43], s75 offen offset:1024 sc1
    buffer_load_dwordx4 a[148:151], v1, s[40:43], s76 offen offset:1024 sc1
    v_mfma_f32_32x32x16_bf16 v[172:187], v[104:107], a[176:179], v[172:187]
    v_mfma_f32_32x32x16_bf16 v[188:203], v[100:103], a[180:183], v[188:203]
    v_mfma_f32_32x32x16_bf16 v[204:219], v[104:107], a[180:183], v[204:219]
    s_add_u32 m0, s88, 155648
    s_add_u32 s77, s90, 16384
    buffer_load_dwordx4 v24, s[48:51], s77 offen lds
    buffer_load_dwordx4 v25, s[48:51], s77 offen offset:1024 lds
    v_mfma_f32_32x32x16_bf16 v[156:171], v[108:111], a[184:187], v[156:171]
    buffer_load_dwordx4 a[152:155], v1, s[40:43], s75 offen offset:2048 sc1
    buffer_load_dwordx4 a[156:159], v1, s[40:43], s76 offen offset:2048 sc1
    v_mfma_f32_32x32x16_bf16 v[172:187], v[112:115], a[184:187], v[172:187]
    v_mfma_f32_32x32x16_bf16 v[188:203], v[108:111], a[188:191], v[188:203]
    v_mfma_f32_32x32x16_bf16 v[204:219], v[112:115], a[188:191], v[204:219]
    s_add_u32 m0, s27, 81920
    s_add_u32 s77, s90, 32768
    buffer_load_dwordx4 v24, s[48:51], s77 offen lds
    buffer_load_dwordx4 v25, s[48:51], s77 offen offset:1024 lds
    v_mfma_f32_32x32x16_bf16 v[156:171], v[116:119], a[192:195], v[156:171]
    buffer_load_dwordx4 a[160:163], v1, s[40:43], s75 offen offset:3072 sc1
    buffer_load_dwordx4 a[164:167], v1, s[40:43], s76 offen offset:3072 sc1
    v_mfma_f32_32x32x16_bf16 v[172:187], v[120:123], a[192:195], v[172:187]
    v_mfma_f32_32x32x16_bf16 v[188:203], v[116:119], a[196:199], v[188:203]
    v_mfma_f32_32x32x16_bf16 v[204:219], v[120:123], a[196:199], v[204:219]
    s_add_u32 m0, s27, 83968
    s_add_u32 s77, s90, 49152
    buffer_load_dwordx4 v24, s[48:51], s77 offen lds
    buffer_load_dwordx4 v25, s[48:51], s77 offen offset:1024 lds
    s_waitcnt vmcnt(22)
    v_mfma_f32_32x32x16_bf16 v[156:171], a[0:3], a[224:227], v[156:171]
    v_mfma_f32_32x32x16_bf16 v[172:187], a[4:7], a[224:227], v[172:187]
    s_waitcnt vmcnt(12)
    ds_read_b64_tr_b16 v[60:61], v26 offset:6144
    ds_read_b64_tr_b16 v[62:63], v26 offset:7168
    ds_read_b64_tr_b16 v[64:65], v27 offset:6144
    ds_read_b64_tr_b16 v[66:67], v27 offset:7168
    v_mfma_f32_32x32x16_bf16 v[188:203], a[0:3], a[228:231], v[188:203]
    v_mfma_f32_32x32x16_bf16 v[204:219], a[4:7], a[228:231], v[204:219]
    s_add_u32 m0, s27, 86016
    s_add_u32 s77, s90, 65536
    buffer_load_dwordx4 v24, s[48:51], s77 offen lds
    buffer_load_dwordx4 v25, s[48:51], s77 offen offset:1024 lds
    buffer_load_dword v246, v245, s[40:43], s1 offen sc1
    v_mfma_f32_32x32x16_bf16 v[156:171], a[8:11], a[232:235], v[156:171]
    v_mfma_f32_32x32x16_bf16 v[172:187], a[12:15], a[232:235], v[172:187]
    s_waitcnt vmcnt(11)
    ds_read_b64_tr_b16 v[68:69], v58 offset:0
    ds_read_b64_tr_b16 v[70:71], v58 offset:1024
    ds_read_b64_tr_b16 v[72:73], v59 offset:0
    ds_read_b64_tr_b16 v[74:75], v59 offset:1024
    v_mfma_f32_32x32x16_bf16 v[188:203], a[8:11], a[236:239], v[188:203]
    v_mfma_f32_32x32x16_bf16 v[204:219], a[12:15], a[236:239], v[204:219]
    s_add_u32 m0, s27, 40960
    s_add_u32 s77, s90, 81920
    buffer_load_dwordx4 v24, s[48:51], s77 offen lds
    buffer_load_dwordx4 v25, s[48:51], s77 offen offset:1024 lds
    v_mfma_f32_32x32x16_bf16 v[156:171], a[16:19], a[240:243], v[156:171]
    v_mfma_f32_32x32x16_bf16 v[172:187], a[20:23], a[240:243], v[172:187]
    s_waitcnt vmcnt(9)
    ds_read_b64_tr_b16 v[76:77], v54 offset:0
    ds_read_b64_tr_b16 v[78:79], v54 offset:1024
    ds_read_b64_tr_b16 v[80:81], v55 offset:0
    ds_read_b64_tr_b16 v[82:83], v55 offset:1024
    v_mfma_f32_32x32x16_bf16 v[188:203], a[16:19], a[244:247], v[188:203]
    v_mfma_f32_32x32x16_bf16 v[204:219], a[20:23], a[244:247], v[204:219]
    s_add_u32 m0, s27, 43008
    s_add_u32 s77, s90, 98304
    buffer_load_dwordx4 v24, s[48:51], s77 offen lds
    buffer_load_dwordx4 v25, s[48:51], s77 offen offset:1024 lds
    v_mfma_f32_32x32x16_bf16 v[156:171], a[24:27], a[248:251], v[156:171]
    v_mfma_f32_32x32x16_bf16 v[172:187], a[28:31], a[248:251], v[172:187]
    s_waitcnt vmcnt(7)
    ds_read_b64_tr_b16 v[84:85], v54 offset:2048
    ds_read_b64_tr_b16 v[86:87], v54 offset:3072
    ds_read_b64_tr_b16 v[88:89], v55 offset:2048
    ds_read_b64_tr_b16 v[90:91], v55 offset:3072
    v_mfma_f32_32x32x16_bf16 v[188:203], a[24:27], a[252:255], v[188:203]
    v_mfma_f32_32x32x16_bf16 v[204:219], a[28:31], a[252:255], v[204:219]
    s_waitcnt lgkmcnt(15)
    s_add_u32 m0, s27, 45056
    s_add_u32 s77, s90, 114688
    buffer_load_dwordx4 v24, s[48:51], s77 offen lds
    buffer_load_dwordx4 v25, s[48:51], s77 offen offset:1024 lds
    s_waitcnt vmcnt(6)
    v_cmp_ne_u32 vcc, s68, v246
    s_cbranch_vccz L_pd_31
    s_mov_b32 s94, 0
L_pl_30:
    buffer_load_dword v246, v245, s[40:43], s1 offen sc1
    s_add_u32 s94, s94, 1
    s_waitcnt vmcnt(0)
    v_cmp_ne_u32 vcc, s68, v246
    s_cbranch_vccz L_pd_31
    s_cmp_lt_u32 s94, s97
    s_cbranch_scc1 L_pl_30
    s_mov_b32 s97, 0
L_pd_31:
    v_mfma_f32_32x32x16_bf16 v[156:171], a[32:35], a[136:139], v[156:171]
    s_add_u32 s75, s91, 8192
    s_add_u32 s76, s92, 8192
    buffer_load_dwordx4 a[168:171], v1, s[40:43], s75 offen offset:0 sc1
    buffer_load_dwordx4 a[172:175], v1, s[40:43], s76 offen offset:0 sc1
    v_mfma_f32_32x32x16_bf16 v[172:187], a[36:39], a[136:139], v[172:187]
    ds_read_b64_tr_b16 v[92:93], v54 offset:4096
    ds_read_b64_tr_b16 v[94:95], v54 offset:5120
    ds_read_b64_tr_b16 v[96:97], v55 offset:4096
    ds_read_b64_tr_b16 v[98:99], v55 offset:5120
    v_mfma_f32_32x32x16_bf16 v[188:203], a[32:35], a[140:143], v[188:203]
    v_mfma_f32_32x32x16_bf16 v[204:219], a[36:39], a[140:143], v[204:219]
    buffer_load_dwordx4 a[176:179], v1, s[40:43], s75 offen offset:1024 sc1
    buffer_load_dwordx4 a[180:183], v1, s[40:43], s76 offen offset:1024 sc1
    v_mfma_f32_32x32x16_bf16 v[156:171], a[40:43], a[144:147], v[156:171]
    buffer_load_dwordx4 a[184:187], v1, s[40:43], s75 offen offset:2048 sc1
    buffer_load_dwordx4 a[188:191], v1, s[40:43], s76 offen offset:2048 sc1
    v_mfma_f32_32x32x16_bf16 v[172:187], a[44:47], a[144:147], v[172:187]
    s_waitcnt vmcnt(10)
    ds_read_b64_tr_b16 v[100:101], v52 offset:40960
    ds_read_b64_tr_b16 v[102:103], v52 offset:41984
    ds_read_b64_tr_b16 v[104:105], v53 offset:40960
    ds_read_b64_tr_b16 v[106:107], v53 offset:41984
    v_mfma_f32_32x32x16_bf16 v[188:203], a[40:43], a[148:151], v[188:203]
    v_mfma_f32_32x32x16_bf16 v[204:219], a[44:47], a[148:151], v[204:219]
    buffer_load_dwordx4 a[192:195], v1, s[40:43], s75 offen offset:3072 sc1
    buffer_load_dwordx4 a[196:199], v1, s[40:43], s76 offen offset:3072 sc1
    v_mfma_f32_32x32x16_bf16 v[156:171], a[48:51], a[152:155], v[156:171]
    s_add_u32 s75, s91, 12288
    s_add_u32 s76, s92, 12288
    buffer_load_dwordx4 a[0:3], v1, s[40:43], s75 offen offset:0 sc1
    buffer_load_dwordx4 a[4:7], v1, s[40:43], s76 offen offset:0 sc1
    v_mfma_f32_32x32x16_bf16 v[172:187], a[52:55], a[152:155], v[172:187]
    s_waitcnt vmcnt(12)
    ds_read_b64_tr_b16 v[108:109], v52 offset:43008
    ds_read_b64_tr_b16 v[110:111], v52 offset:44032
    ds_read_b64_tr_b16 v[112:113], v53 offset:43008
    ds_read_b64_tr_b16 v[114:115], v53 offset:44032
    v_mfma_f32_32x32x16_bf16 v[188:203], a[48:51], a[156:159], v[188:203]
    v_mfma_f32_32x32x16_bf16 v[204:219], a[52:55], a[156:159], v[204:219]
    buffer_load_dwordx4 a[224:227], v1, s[40:43], s75 offen offset:1024 sc1
    buffer_load_dwordx4 a[228:231], v1, s[40:43], s76 offen offset:1024 sc1
    v_mfma_f32_32x32x16_bf16 v[156:171], a[56:59], a[160:163], v[156:171]
    buffer_load_dwordx4 a[8:11], v1, s[40:43], s75 offen offset:2048 sc1
    buffer_load_dwordx4 a[12:15], v1, s[40:43], s76 offen offset:2048 sc1
    v_mfma_f32_32x32x16_bf16 v[172:187], a[60:63], a[160:163], v[172:187]
    s_waitcnt vmcnt(14)
    ds_read_b64_tr_b16 v[116:117], v52 offset:45056
    ds_read_b64_tr_b16 v[118:119], v52 offset:46080
    ds_read_b64_tr_b16 v[120:121], v53 offset:45056
    ds_read_b64_tr_b16 v[122:123], v53 offset:46080
    v_mfma_f32_32x32x16_bf16 v[188:203], a[56:59], a[164:167], v[188:203]
    v_mfma_f32_32x32x16_bf16 v[204:219], a[60:63], a[164:167], v[204:219]
    buffer_load_dwordx4 a[232:235], v1, s[40:43], s75 offen offset:3072 sc1
    buffer_load_dwordx4 a[236:239], v1, s[40:43], s76 offen offset:3072 sc1
    buffer_load_dword v251, v250, s[40:43], s74 offen sc1
    s_waitcnt vmcnt(15)
    v_mfma_f32_32x32x16_bf16 v[156:171], a[64:67], a[168:171], v[156:171]
    s_add_u32 s75, s91, 16384
    s_add_u32 s76, s92, 16384
    buffer_load_dwordx4 a[16:19], v1, s[40:43], s75 offen offset:0 sc1
    buffer_load_dwordx4 a[20:23], v1, s[40:43], s76 offen offset:0 sc1
    v_mfma_f32_32x32x16_bf16 v[172:187], a[68:71], a[168:171], v[172:187]
    v_mfma_f32_32x32x16_bf16 v[188:203], a[64:67], a[172:175], v[188:203]
    v_mfma_f32_32x32x16_bf16 v[204:219], a[68:71], a[172:175], v[204:219]
    buffer_load_dwordx4 a[240:243], v1, s[40:43], s75 offen offset:1024 sc1
    buffer_load_dwordx4 a[244:247], v1, s[40:43], s76 offen offset:1024 sc1
    s_waitcnt vmcnt(17)
    v_mfma_f32_32x32x16_bf16 v[156:171], a[72:75], a[176:179], v[156:171]
    buffer_load_dwordx4 a[24:27], v1, s[40:43], s75 offen offset:2048 sc1
    buffer_load_dwordx4 a[28:31], v1, s[40:43], s76 offen offset:2048 sc1
    v_mfma_f32_32x32x16_bf16 v[172:187], a[76:79], a[176:179], v[172:187]
    v_mfma_f32_32x32x16_bf16 v[188:203], a[72:75], a[180:183], v[188:203]
    v_mfma_f32_32x32x16_bf16 v[204:219], a[76:79], a[180:183], v[204:219]
    buffer_load_dwordx4 a[248:251], v1, s[40:43], s75 offen offset:3072 sc1
    buffer_load_dwordx4 a[252:255], v1, s[40:43], s76 offen offset:3072 sc1
    s_waitcnt vmcnt(19)
    v_mfma_f32_32x32x16_bf16 v[156:171], a[80:83], a[184:187], v[156:171]
    v_mfma_f32_32x32x16_bf16 v[172:187], a[84:87], a[184:187], v[172:187]
    v_mfma_f32_32x32x16_bf16 v[188:203], a[80:83], a[188:191], v[188:203]
    v_mfma_f32_32x32x16_bf16 v[204:219], a[84:87], a[188:191], v[204:219]
    s_waitcnt vmcnt(8)
    v_cmp_ne_u32 vcc, s68, v251
    s_cbranch_vccz L_pd_33
    s_mov_b32 s94, 0
L_pl_32:
    buffer_load_dword v251, v250, s[40:43], s74 offen sc1
    s_add_u32 s94, s94, 1
    s_waitcnt vmcnt(0)
    v_cmp_ne_u32 vcc, s68, v251
    s_cbranch_vccz L_pd_33
    s_cmp_lt_u32 s94, s97
    s_cbranch_scc1 L_pl_32
    s_mov_b32 s97, 0
L_pd_33:
    v_mfma_f32_32x32x16_bf16 v[156:171], a[88:91], a[192:195], v[156:171]
    s_mul_i32 s76, s60, -20480
    s_add_u32 s76, s76, 114688
    s_add_u32 s75, s91, s76
    s_add_u32 s76, s92, s76
    buffer_load_dwordx4 a[32:35], v1, s[40:43], s75 offen offset:0 sc1
    buffer_load_dwordx4 a[36:39], v1, s[40:43], s76 offen offset:0 sc1
    v_mfma_f32_32x32x16_bf16 v[172:187], a[92:95], a[192:195], v[172:187]
    v_mfma_f32_32x32x16_bf16 v[188:203], a[88:91], a[196:199], v[188:203]
    v_mfma_f32_32x32x16_bf16 v[204:219], a[92:95], a[196:199], v[204:219]
    buffer_load_dwordx4 a[136:139], v1, s[40:43], s75 offen offset:1024 sc1
    buffer_load_dwordx4 a[140:143], v1, s[40:43], s76 offen offset:1024 sc1
    v_mfma_f32_32x32x16_bf16 v[156:171], a[96:99], a[0:3], v[156:171]
    buffer_load_dwordx4 a[40:43], v1, s[40:43], s75 offen offset:2048 sc1
    buffer_load_dwordx4 a[44:47], v1, s[40:43], s76 offen offset:2048 sc1
    v_mfma_f32_32x32x16_bf16 v[172:187], a[100:103], a[0:3], v[172:187]
    v_mfma_f32_32x32x16_bf16 v[188:203], a[96:99], a[4:7], v[188:203]
    v_mfma_f32_32x32x16_bf16 v[204:219], a[100:103], a[4:7], v[204:219]
    v_mfma_f32_32x32x16_bf16 v[156:171], a[104:107], a[224:227], v[156:171]
    buffer_load_dwordx4 a[144:147], v1, s[40:43], s75 offen offset:3072 sc1
    buffer_load_dwordx4 a[148:151], v1, s[40:43], s76 offen offset:3072 sc1
    v_mfma_f32_32x32x16_bf16 v[172:187], a[108:111], a[224:227], v[172:187]
    v_mfma_f32_32x32x16_bf16 v[188:203], a[104:107], a[228:231], v[188:203]
    v_mfma_f32_32x32x16_bf16 v[204:219], a[108:111], a[228:231], v[204:219]
    s_barrier
    v_mfma_f32_32x32x16_bf16 v[156:171], a[112:115], a[8:11], v[156:171]
    s_mul_i32 s76, s60, -20480
    s_add_u32 s76, s76, 118784
    s_add_u32 s75, s91, s76
    s_add_u32 s76, s92, s76
    buffer_load_dwordx4 a[48:51], v1, s[40:43], s75 offen offset:0 sc1
    buffer_load_dwordx4 a[52:55], v1, s[40:43], s76 offen offset:0 sc1
    v_mfma_f32_32x32x16_bf16 v[172:187], a[116:119], a[8:11], v[172:187]
    v_mfma_f32_32x32x16_bf16 v[188:203], a[112:115], a[12:15], v[188:203]
    v_mfma_f32_32x32x16_bf16 v[204:219], a[116:119], a[12:15], v[204:219]
    v_mfma_f32_32x32x16_bf16 v[156:171], a[120:123], a[232:235], v[156:171]
    buffer_load_dwordx4 a[152:155], v1, s[40:43], s75 offen offset:1024 sc1
    buffer_load_dwordx4 a[156:159], v1, s[40:43], s76 offen offset:1024 sc1
    v_mfma_f32_32x32x16_bf16 v[172:187], a[124:127], a[232:235], v[172:187]
    v_mfma_f32_32x32x16_bf16 v[188:203], a[120:123], a[236:239], v[188:203]
    v_mfma_f32_32x32x16_bf16 v[204:219], a[124:127], a[236:239], v[204:219]
    s_waitcnt vmcnt(18)
    buffer_load_dwordx4 a[56:59], v1, s[40:43], s75 offen offset:2048 sc1
    buffer_load_dwordx4 a[60:63], v1, s[40:43], s76 offen offset:2048 sc1
    v_mfma_f32_32x32x16_bf16 v[172:187], a[132:135], a[16:19], v[172:187]
    v_mfma_f32_32x32x16_bf16 v[188:203], a[128:131], a[20:23], v[188:203]
    v_mfma_f32_32x32x16_bf16 v[204:219], a[132:135], a[20:23], v[204:219]
    s_waitcnt vmcnt(18)
    buffer_load_dwordx4 a[160:163], v1, s[40:43], s75 offen offset:3072 sc1
    buffer_load_dwordx4 a[164:167], v1, s[40:43], s76 offen offset:3072 sc1
    v_mfma_f32_32x32x16_bf16 v[172:187], a[204:207], a[240:243], v[172:187]
    v_mfma_f32_32x32x16_bf16 v[188:203], a[200:203], a[244:247], v[188:203]
    v_mfma_f32_32x32x16_bf16 v[204:219], a[204:207], a[244:247], v[204:219]
    s_waitcnt vmcnt(18)
    v_mfma_f32_32x32x16_bf16 v[172:187], a[212:215], a[24:27], v[172:187]
    v_mfma_f32_32x32x16_bf16 v[188:203], a[208:211], a[28:31], v[188:203]
    v_mfma_f32_32x32x16_bf16 v[204:219], a[212:215], a[28:31], v[204:219]
    s_waitcnt vmcnt(16)
    v_mfma_f32_32x32x16_bf16 v[172:187], a[220:223], a[248:251], v[172:187]
    v_mfma_f32_32x32x16_bf16 v[188:203], a[216:219], a[252:255], v[188:203]
    v_mfma_f32_32x32x16_bf16 v[204:219], a[220:223], a[252:255], v[204:219]
    buffer_load_dwordx2 v[220:221], v248, s[28:31], s73 offen offset:0
    buffer_load_dwordx2 v[222:223], v248, s[28:31], s73 offen offset:16
    buffer_load_dwordx2 v[224:225], v248, s[28:31], s73 offen offset:32
    buffer_load_dwordx2 v[226:227], v248, s[28:31], s73 offen offset:48
    s_waitcnt vmcnt(18) lgkmcnt(15)
    v_mfma_f32_32x32x16_bf16 v[172:187], v[64:67], a[32:35], v[172:187]
    v_mfma_f32_32x32x16_bf16 v[188:203], v[60:63], a[36:39], v[188:203]
    v_mfma_f32_32x32x16_bf16 v[204:219], v[64:67], a[36:39], v[204:219]
    s_waitcnt vmcnt(16)
    v_mfma_f32_32x32x16_bf16 v[172:187], v[72:75], a[136:139], v[172:187]
    v_mfma_f32_32x32x16_bf16 v[188:203], v[68:71], a[140:143], v[188:203]
    v_mfma_f32_32x32x16_bf16 v[204:219], v[72:75], a[140:143], v[204:219]
    s_waitcnt vmcnt(14)
    v_mfma_f32_32x32x16_bf16 v[172:187], v[80:83], a[40:43], v[172:187]
    v_mfma_f32_32x32x16_bf16 v[188:203], v[76:79], a[44:47], v[188:203]
    v_mfma_f32_32x32x16_bf16 v[204:219], v[80:83], a[44:47], v[204:219]
    s_waitcnt vmcnt(12)
    v_mfma_f32_32x32x16_bf16 v[172:187], v[88:91], a[144:147], v[172:187]
    v_mfma_f32_32x32x16_bf16 v[188:203], v[84:87], a[148:151], v[188:203]
    v_mfma_f32_32x32x16_bf16 v[204:219], v[88:91], a[148:151], v[204:219]
    s_waitcnt vmcnt(10) lgkmcnt(12)
    v_mfma_f32_32x32x16_bf16 v[172:187], v[96:99], a[48:51], v[172:187]
    v_mfma_f32_32x32x16_bf16 v[188:203], v[92:95], a[52:55], v[188:203]
    v_mfma_f32_32x32x16_bf16 v[204:219], v[96:99], a[52:55], v[204:219]
    s_waitcnt vmcnt(8) lgkmcnt(8)
    v_mfma_f32_32x32x16_bf16 v[172:187], v[104:107], a[152:155], v[172:187]
    v_mfma_f32_32x32x16_bf16 v[188:203], v[100:103], a[156:159], v[188:203]
    v_mfma_f32_32x32x16_bf16 v[204:219], v[104:107], a[156:159], v[204:219]
    s_waitcnt vmcnt(6) lgkmcnt(4)
    v_mfma_f32_32x32x16_bf16 v[172:187], v[112:115], a[56:59], v[172:187]
    v_mfma_f32_32x32x16_bf16 v[188:203], v[108:111], a[60:63], v[188:203]
    v_mfma_f32_32x32x16_bf16 v[204:219], v[112:115], a[60:63], v[204:219]
    s_waitcnt vmcnt(4) lgkmcnt(0)
    v_mfma_f32_32x32x16_bf16 v[172:187], v[120:123], a[160:163], v[172:187]
    v_mfma_f32_32x32x16_bf16 v[188:203], v[116:119], a[164:167], v[188:203]
    v_mfma_f32_32x32x16_bf16 v[204:219], v[120:123], a[164:167], v[204:219]
    s_nop 9
    ds_write_b128 v239, v[172:175] offset:0
    v_mfma_f32_32x32x16_bf16 v[156:171], a[128:131], a[16:19], v[156:171]
    ds_write_b128 v239, v[176:179] offset:1024
    v_mfma_f32_32x32x16_bf16 v[156:171], a[200:203], a[240:243], v[156:171]
    ds_write_b128 v239, v[180:183] offset:2048
    v_mfma_f32_32x32x16_bf16 v[156:171], a[208:211], a[24:27], v[156:171]
    ds_write_b128 v239, v[184:187] offset:3072
    v_mfma_f32_32x32x16_bf16 v[156:171], a[216:219], a[248:251], v[156:171]
    ds_write_b128 v240, v[188:191] offset:0
    v_mfma_f32_32x32x16_bf16 v[156:171], v[60:63], a[32:35], v[156:171]
    ds_write_b128 v240, v[192:195] offset:1024
    v_mfma_f32_32x32x16_bf16 v[156:171], v[68:71], a[136:139], v[156:171]
    ds_write_b128 v240, v[196:199] offset:2048
    v_mfma_f32_32x32x16_bf16 v[156:171], v[76:79], a[40:43], v[156:171]
    ds_write_b128 v240, v[200:203] offset:3072
    v_mfma_f32_32x32x16_bf16 v[156:171], v[84:87], a[144:147], v[156:171]
    ds_write_b128 v241, v[204:207] offset:0
    v_mfma_f32_32x32x16_bf16 v[156:171], v[92:95], a[48:51], v[156:171]
    ds_write_b128 v241, v[208:211] offset:1024
    v_mfma_f32_32x32x16_bf16 v[156:171], v[100:103], a[152:155], v[156:171]
    ds_write_b128 v241, v[212:215] offset:2048
    v_mfma_f32_32x32x16_bf16 v[156:171], v[108:111], a[56:59], v[156:171]
    ds_write_b128 v241, v[216:219] offset:3072
    v_mfma_f32_32x32x16_bf16 v[156:171], v[116:119], a[160:163], v[156:171]
    s_waitcnt vmcnt(0)
    v_lshlrev_b32 v228, 16, v220
    v_and_b32 v229, 0xffff0000, v220
    s_nop 8
    v_pk_add_f32 v[156:157], v[156:157], v[228:229]
    v_lshlrev_b32 v228, 16, v221
    v_and_b32 v229, 0xffff0000, v221
    v_pk_add_f32 v[158:159], v[158:159], v[228:229]
    v_lshlrev_b32 v228, 16, v222
    v_and_b32 v229, 0xffff0000, v222
    v_pk_add_f32 v[160:161], v[160:161], v[228:229]
    v_lshlrev_b32 v228, 16, v223
    v_and_b32 v229, 0xffff0000, v223
    v_pk_add_f32 v[162:163], v[162:163], v[228:229]
    v_lshlrev_b32 v228, 16, v224
    v_and_b32 v229, 0xffff0000, v224
    v_pk_add_f32 v[164:165], v[164:165], v[228:229]
    v_lshlrev_b32 v228, 16, v225
    v_and_b32 v229, 0xffff0000, v225
    v_pk_add_f32 v[166:167], v[166:167], v[228:229]
    v_lshlrev_b32 v228, 16, v226
    v_and_b32 v229, 0xffff0000, v226
    v_pk_add_f32 v[168:169], v[168:169], v[228:229]
    v_lshlrev_b32 v228, 16, v227
    v_and_b32 v229, 0xffff0000, v227
    v_pk_add_f32 v[170:171], v[170:171], v[228:229]
    s_waitcnt lgkmcnt(0)
    s_barrier
    ds_read_b128 v[60:63], v238 offset:0
    ds_read_b128 v[64:67], v238 offset:1024
    ds_read_b128 v[68:71], v238 offset:2048
    ds_read_b128 v[72:75], v238 offset:3072
    ds_read_b128 v[76:79], v238 offset:4096
    ds_read_b128 v[80:83], v238 offset:5120
    ds_read_b128 v[84:87], v238 offset:6144
    ds_read_b128 v[88:91], v238 offset:7168
    ds_read_b128 v[92:95], v238 offset:8192
    ds_read_b128 v[96:99], v238 offset:9216
    ds_read_b128 v[100:103], v238 offset:10240
    ds_read_b128 v[104:107], v238 offset:11264
    s_waitcnt lgkmcnt(11)
    v_pk_add_f32 v[156:157], v[156:157], v[60:61]
    v_pk_add_f32 v[158:159], v[158:159], v[62:63]
    s_waitcnt lgkmcnt(10)
    v_pk_add_f32 v[160:161], v[160:161], v[64:65]
    v_pk_add_f32 v[162:163], v[162:163], v[66:67]
    s_waitcnt lgkmcnt(9)
    v_pk_add_f32 v[164:165], v[164:165], v[68:69]
    v_pk_add_f32 v[166:167], v[166:167], v[70:71]
    s_waitcnt lgkmcnt(8)
    v_pk_add_f32 v[168:169], v[168:169], v[72:73]
    v_pk_add_f32 v[170:171], v[170:171], v[74:75]
    s_waitcnt lgkmcnt(7)
    v_pk_add_f32 v[156:157], v[156:157], v[76:77]
    v_pk_add_f32 v[158:159], v[158:159], v[78:79]
    s_waitcnt lgkmcnt(6)
    v_pk_add_f32 v[160:161], v[160:161], v[80:81]
    v_pk_add_f32 v[162:163], v[162:163], v[82:83]
    s_waitcnt lgkmcnt(5)
    v_pk_add_f32 v[164:165], v[164:165], v[84:85]
    v_pk_add_f32 v[166:167], v[166:167], v[86:87]
    s_waitcnt lgkmcnt(4)
    v_pk_add_f32 v[168:169], v[168:169], v[88:89]
    v_pk_add_f32 v[170:171], v[170:171], v[90:91]
    s_waitcnt lgkmcnt(3)
    v_pk_add_f32 v[156:157], v[156:157], v[92:93]
    v_pk_add_f32 v[158:159], v[158:159], v[94:95]
    s_waitcnt lgkmcnt(2)
    v_pk_add_f32 v[160:161], v[160:161], v[96:97]
    v_pk_add_f32 v[162:163], v[162:163], v[98:99]
    s_waitcnt lgkmcnt(1)
    v_pk_add_f32 v[164:165], v[164:165], v[100:101]
    v_pk_add_f32 v[166:167], v[166:167], v[102:103]
    s_waitcnt lgkmcnt(0)
    v_pk_add_f32 v[168:169], v[168:169], v[104:105]
    v_pk_add_f32 v[170:171], v[170:171], v[106:107]
    v_cvt_pk_bf16_f32 v220, v156, v157
    v_cvt_pk_bf16_f32 v221, v158, v159
    v_cvt_pk_bf16_f32 v222, v160, v161
    v_cvt_pk_bf16_f32 v223, v162, v163
    v_cvt_pk_bf16_f32 v224, v164, v165
    v_cvt_pk_bf16_f32 v225, v166, v167
    v_cvt_pk_bf16_f32 v226, v168, v169
    v_cvt_pk_bf16_f32 v227, v170, v171
    v_permlane32_swap_b32 v220, v222
    v_permlane32_swap_b32 v221, v223
    v_permlane32_swap_b32 v224, v226
    v_permlane32_swap_b32 v225, v227
    s_nop 0
    v_permlane16_swap_b32 v220, v224
    v_permlane16_swap_b32 v221, v225
    v_permlane16_swap_b32 v222, v226
    v_permlane16_swap_b32 v223, v227
    buffer_store_dwordx4 v[220:223], v249, s[52:55], s73 offen
    buffer_store_dwordx4 v[224:227], v249, s[52:55], s85 offen
    s_endpgm
L_exit:
    s_endpgm
.section .rodata,"a"
.p2align 6
.amdhsa_kernel parallel_sum__linear_kernel_hedgehog__glu_gated_bilinear__prompt_kernel
  .amdhsa_next_free_vgpr 512
  .amdhsa_next_free_sgpr 102
  .amdhsa_accum_offset 256
  .amdhsa_group_segment_fixed_size 0
  .amdhsa_kernarg_size 88
  .amdhsa_user_sgpr_count 2
  .amdhsa_user_sgpr_kernarg_segment_ptr 1
  .amdhsa_system_sgpr_workgroup_id_x 1
.end_amdhsa_kernel
```
